```python
import torch

def _softmax(x, axis=-1):
    return torch.softmax(x, dim=axis)

def _gelu(x):
    return torch.nn.functional.gelu(x, approximate='tanh')

def _silu(x):
    return torch.nn.functional.silu(x)

def _sigmoid(x):
    return torch.sigmoid(x)

def _layernorm(x, axis=-1, eps=1e-05):
    m = x.mean(dim=axis, keepdim=True)
    v = x.var(dim=axis, keepdim=True, unbiased=False)
    return (x - m) / torch.sqrt(v + eps)

def _scatter_add(tgt, idx, src, axis=0):
    return tgt.clone().index_add_(axis, idx, src)

def _segment_sum(src, seg, n):
    out = torch.zeros((n,) + src.shape[1:], dtype=src.dtype)
    return out.index_add_(0, seg, src)

def _pad(x, pw):
    flat = tuple((v for pair in reversed(pw) for v in pair))
    return torch.nn.functional.pad(x, flat)
kernel_name = 'parallel_sum__memory_aug_recurrent_mem_tr__glu_gated_swiglu__prompt'

def setup_inputs():

    _w = lambda a: (lambda t: t.to(torch.bfloat16) if t.is_floating_point() else t)(torch.as_tensor(a))

    def _A_setup():
        B, S, Dm = (1, 2048, 512)
        H, Dh = (32, 128)
        M, seg = (8, 32)
        seg = min(seg, S)
        S = S // seg * seg
        return {'x': _w((lambda *s: torch.randn(*s, dtype=torch.bfloat16) * 0.05)(B, S, Dm)), 'mem0': _w((lambda *s: torch.randn(*s, dtype=torch.bfloat16) * 0.2)(B, M, Dm)), 'Wq': _w((lambda *s: torch.randn(*s, dtype=torch.bfloat16) * 1.6)(Dm, H, Dh) * Dm ** (-0.5)), 'Wk': _w((lambda *s: torch.randn(*s, dtype=torch.bfloat16) * 1.6)(Dm, H, Dh) * Dm ** (-0.5)), 'Wv': _w((lambda *s: torch.randn(*s, dtype=torch.bfloat16) * 0.2)(Dm, H, Dh) * Dm ** (-0.5)), 'Wo': _w((lambda *s: torch.randn(*s, dtype=torch.bfloat16) * 0.2)(H, Dh, Dm) * (H * Dh) ** (-0.5)), 'seg_len': seg}
    _A_in = _A_setup()

    def _B_setup():
        B, S, D, F = (1, 2048, 512, 1376)
        return {'x': _w((lambda *s: torch.randn(*s, dtype=torch.bfloat16) * 0.05)(B, S, D)), 'w1': _w((lambda *s: torch.randn(*s, dtype=torch.bfloat16) * 0.2)(D, F) * (2.0 / D) ** 0.5), 'w3': _w((lambda *s: torch.randn(*s, dtype=torch.bfloat16) * 0.2)(D, F) * (2.0 / D) ** 0.5), 'w2': _w((lambda *s: torch.randn(*s, dtype=torch.bfloat16) * 0.2)(F, D) * (2.0 / F) ** 0.5)}
    _B_in = _B_setup()
    return {'A_x': _A_in['x'], 'A_mem0': _A_in['mem0'], 'A_Wq': _A_in['Wq'], 'A_Wk': _A_in['Wk'], 'A_Wv': _A_in['Wv'], 'A_Wo': _A_in['Wo'], 'A_seg_len': _A_in['seg_len'], 'B_x': _B_in['x'], 'B_w1': _B_in['w1'], 'B_w3': _B_in['w3'], 'B_w2': _B_in['w2']}

def reference(A_x, A_mem0, A_Wq, A_Wk, A_Wv, A_Wo, A_seg_len, B_x, B_w1, B_w3, B_w2):

    def _A_ref(x, mem0, Wq, Wk, Wv, Wo, seg_len):
        B, S, Dm = x.shape
        H, Dh = (Wq.shape[1], Wq.shape[2])
        M = mem0.shape[1]
        scale = Dh ** (-0.5)
        n_seg = S // seg_len
        L = M + seg_len
        idx = torch.arange(L)
        mask = (idx[:, None] < M) | (idx[:, None] >= idx[None, :])
        mem = mem0
        outs = []
        for s in range(n_seg):
            xs = x[:, s * seg_len:(s + 1) * seg_len, :].clone()
            h = torch.concatenate([mem, xs], axis=1)
            q = torch.einsum('btd,dhe->bhte', h, Wq)
            k = torch.einsum('btd,dhe->bhte', h, Wk)
            v = torch.einsum('btd,dhe->bhte', h, Wv)
            scores = torch.einsum('bhqe,bhke->bhqk', q, k) * scale
            scores = torch.where(mask[None, None], scores, -1000000000.0)
            p = _softmax(scores, axis=-1)
            o = torch.einsum('bhqk,bhke->bhqe', p, v)
            o = torch.einsum('bhte,hed->btd', o, Wo)
            mem = o[:, :M, :].clone()
            outs.append(o[:, M:, :])
        return torch.concatenate(outs, axis=1)

    def _B_ref(x, w1, w3, w2):
        gate = torch.einsum('bsd,df->bsf', x, w1)
        up = torch.einsum('bsd,df->bsf', x, w3)
        h = _silu(gate) * up
        out = torch.einsum('bsf,fd->bsd', h, w2)
        return out
    x = A_x
    xn = _layernorm(x, axis=-1)
    return x + _A_ref(xn, A_mem0, A_Wq, A_Wk, A_Wv, A_Wo, A_seg_len) + _B_ref(xn, B_w1, B_w3, B_w2)
```

```asm
; @launch grid=(256,1,1) block=(256,1,1) lds=163840
.amdgcn_target "amdgcn-amd-amdhsa--gfx950"
.text
.globl parallel_sum__memory_aug_recurrent_mem_tr__glu_gated_swiglu__prompt_kernel
.p2align 8
.type parallel_sum__memory_aug_recurrent_mem_tr__glu_gated_swiglu__prompt_kernel,@function
parallel_sum__memory_aug_recurrent_mem_tr__glu_gated_swiglu__prompt_kernel:
    s_cmp_ge_u32 s2, 256
    s_cbranch_scc1 L_exit
    s_load_dwordx16 s[16:31], s[0:1], 0
    s_load_dwordx8 s[32:39], s[0:1], 64
    s_load_dwordx4 s[40:43], s[0:1], 96
    v_lshrrev_b32 v1, 6, v0
    s_and_b32 s44, s2, 7
    v_readfirstlane_b32 s3, v1
    s_waitcnt lgkmcnt(0)
    s_add_u32 s42, s42, 0x1fffff
    s_addc_u32 s43, s43, 0
    s_and_b32 s42, s42, 0xffe00000
    s_mov_b32 s4, s42
    s_mov_b32 s5, s43
    s_mov_b32 s6, 0xfe00000
    s_mov_b32 s7, 0x20000
    s_lshl_b32 s44, s44, 2
    s_lshr_b32 s44, 0x43210765, s44
    s_and_b32 s44, s44, 7
    s_andn2_b32 s2, s2, 7
    s_or_b32 s2, s2, s44
    s_cmp_eq_u32 s44, 0
    s_cbranch_scc1 L_chain
    s_cmp_le_u32 s44, 4
    s_cbranch_scc1 L_attn
    s_branch L_out
L_exit:
    s_endpgm
L_attn:
    s_sub_u32 s65, s44, 1
    s_lshr_b32 s66, s2, 3
    s_and_b32 s45, s66, 3
    s_lshr_b32 s66, s66, 2
    s_lshl_b32 s65, s65, 3
    s_add_u32 s44, s65, s66
    s_mov_b32 s69, 262144
    v_and_b32 v16, 63, v0
    v_lshrrev_b32 v17, 4, v16
    v_and_b32 v18, 15, v16
    v_lshlrev_b32 v0, 4, v16
    s_lshl_b32 s54, s3, 10
    s_add_u32 s54, s54, 98304
    s_lshl_b32 s58, s44, 8
    s_and_b32 s65, s3, 1
    s_lshl_b32 s65, s65, 2
    v_add_u32 v20, s65, v17
    v_lshlrev_b32 v20, 1, v20
    v_xor_b32 v20, v20, v18
    v_lshlrev_b32 v20, 4, v20
    v_and_b32 v19, 1, v17
    v_lshlrev_b32 v19, 4, v19
    v_lshrrev_b32 v21, 1, v17
    s_lshl_b32 s65, s3, 2
    v_add3_u32 v19, v19, v21, s65
    v_mul_u32_u24 v19, 8192, v19
    v_add_u32 v104, v19, v20
    v_bfe_u32 v20, v16, 2, 3
    s_lshl_b32 s65, s3, 1
    v_xor_b32 v20, s65, v20
    v_lshrrev_b32 v19, 2, v16
    v_lshlrev_b32 v19, 8, v19
    v_lshl_add_u32 v19, v20, 5, v19
    v_and_b32 v20, 3, v16
    v_lshl_add_u32 v19, v20, 3, v19
    v_add_u32 v105, 98304, v19
    v_xor_b32 v19, 32, v19
    v_add_u32 v106, 98304, v19
    s_mov_b32 s88, s20
    s_mov_b32 s89, s21
    s_mov_b32 s90, 0x400000
    s_mov_b32 s91, 0x20000
    s_mov_b32 s92, s22
    s_mov_b32 s93, s23
    s_mov_b32 s94, 0x400000
    s_mov_b32 s95, 0x20000
    s_mov_b32 s96, s24
    s_mov_b32 s97, s25
    s_mov_b32 s98, 0x400000
    s_mov_b32 s99, 0x20000
    s_mov_b32 s8, s26
    s_mov_b32 s9, s27
    s_mov_b32 s10, 0x400000
    s_mov_b32 s11, 0x20000
    v_lshrrev_b32 v19, 1, v16
    v_lshlrev_b32 v19, 13, v19
    v_and_b32 v20, 1, v16
    v_lshl_add_u32 v30, v20, 7, v19
    s_lshl_b32 s65, s3, 2
    s_add_u32 s65, s65, s45
    s_lshl_b32 s60, s65, 18
    s_add_u32 s60, s60, s58
    s_lshl_b32 s65, s65, 13
    s_lshl_b32 s61, s44, 17
    s_add_u32 s61, s61, s65
    v_lshlrev_b32 v31, 7, v16
    v_lshlrev_b32 v19, 13, v17
    v_lshl_add_u32 v30, v18, 7, v19
    s_lshr_b32 s65, s2, 3
    s_lshl_b32 s66, s3, 5
    s_add_u32 s65, s65, s66
    s_lshl_b32 s60, s65, 15
    s_lshr_b32 s65, s44, 3
    s_lshl_b32 s65, s65, 11
    s_add_u32 s60, s60, s65
    buffer_load_dword v32, v30, s[92:95], s60 offen
    s_add_u32 s65, s58, 0x0
    s_add_u32 m0, s54, 0
    s_nop 0
    buffer_load_dwordx4 v104, s[92:95], s65 offen lds
    s_add_u32 s65, s58, 0x4000
    s_add_u32 m0, s54, 4096
    s_nop 0
    buffer_load_dwordx4 v104, s[92:95], s65 offen lds
    s_add_u32 s65, s58, 0x40000
    s_add_u32 m0, s54, 8192
    s_nop 0
    buffer_load_dwordx4 v104, s[92:95], s65 offen lds
    s_add_u32 s65, s58, 0x44000
    s_add_u32 m0, s54, 12288
    s_nop 0
    buffer_load_dwordx4 v104, s[92:95], s65 offen lds
    s_add_u32 s65, s58, 0x80000
    s_add_u32 m0, s54, 16384
    s_nop 0
    buffer_load_dwordx4 v104, s[92:95], s65 offen lds
    s_add_u32 s65, s58, 0x84000
    s_add_u32 m0, s54, 20480
    s_nop 0
    buffer_load_dwordx4 v104, s[92:95], s65 offen lds
    s_add_u32 s65, s58, 0xc0000
    s_add_u32 m0, s54, 24576
    s_nop 0
    buffer_load_dwordx4 v104, s[92:95], s65 offen lds
    s_add_u32 s65, s58, 0xc4000
    s_add_u32 m0, s54, 28672
    s_nop 0
    buffer_load_dwordx4 v104, s[92:95], s65 offen lds
    s_add_u32 s65, s58, 0x100000
    s_add_u32 m0, s54, 32768
    s_nop 0
    buffer_load_dwordx4 v104, s[92:95], s65 offen lds
    s_add_u32 s65, s58, 0x104000
    s_add_u32 m0, s54, 36864
    s_nop 0
    buffer_load_dwordx4 v104, s[92:95], s65 offen lds
    s_add_u32 s65, s58, 0x140000
    s_add_u32 m0, s54, 40960
    s_nop 0
    buffer_load_dwordx4 v104, s[92:95], s65 offen lds
    s_add_u32 s65, s58, 0x144000
    s_add_u32 m0, s54, 45056
    s_nop 0
    buffer_load_dwordx4 v104, s[92:95], s65 offen lds
    s_add_u32 s65, s58, 0x180000
    s_add_u32 m0, s54, 49152
    s_nop 0
    buffer_load_dwordx4 v104, s[92:95], s65 offen lds
    s_add_u32 s65, s58, 0x184000
    s_add_u32 m0, s54, 53248
    s_nop 0
    buffer_load_dwordx4 v104, s[92:95], s65 offen lds
    v_mov_b32 v1, v0
    s_lshl_b32 s65, s3, 10
    v_add_u32 v2, 65536, v0
    v_add_u32 v11, s65, v2
    v_mov_b32 v3, v2
    v_lshrrev_b32 v19, 2, v18
    v_mul_u32_u24 v19, 2176, v19
    v_lshrrev_b32 v20, 1, v17
    v_lshl_add_u32 v19, v20, 8, v19
    v_and_b32 v20, 3, v18
    v_lshl_add_u32 v19, v20, 5, v19
    v_and_b32 v20, 1, v17
    v_lshl_add_u32 v19, v20, 4, v19
    v_add_u32 v5, 73728, v19
    s_lshl_b32 s65, s3, 9
    v_add_u32 v4, s65, v5
    v_add_u32 v10, 115712, v0
    v_mul_u32_u24 v19, 640, v17
    v_and_b32 v20, 8, v18
    v_and_b32 v21, 1, v18
    v_lshl_add_u32 v20, v21, 2, v20
    v_bfe_u32 v21, v18, 1, 2
    v_add_u32 v20, v20, v21
    v_lshl_add_u32 v19, v20, 2, v19
    s_lshl_b32 s65, s3, 6
    s_add_u32 s65, s65, 123904
    v_add_u32 v6, s65, v19
    v_lshrrev_b32 v20, 1, v18
    v_mul_u32_u24 v19, 320, v20
    v_lshl_add_u32 v19, v17, 5, v19
    v_and_b32 v21, 1, v18
    v_lshl_add_u32 v19, v21, 4, v19
    v_add_u32 v7, 123904, v19
    v_cmp_eq_u32 vcc, 1, v21
    v_mov_b32 v19, 0x4444
    v_mov_b32 v20, 0xeeee
    v_cndmask_b32 v8, v19, v20, vcc
    v_mov_b32 v9, 0xceabfb8f
    v_mov_b32 v12, 0x3f803f80
    v_mov_b32 v13, 0x3f803f80
    v_mov_b32 v14, 0x3f803f80
    v_mov_b32 v15, 0x3f803f80
    v_lshlrev_b32 v19, 2, v17
    v_sub_u32 v19, v18, v19
    v_cmp_le_i32 s[70:71], 0, v19
    v_cmp_le_i32 s[72:73], 1, v19
    v_cmp_le_i32 s[74:75], 2, v19
    v_cmp_le_i32 s[76:77], 3, v19
    s_mov_b32 s55, 0x3e0293ee
    s_mov_b32 s56, 0xffc0ffc0
    s_mov_b32 s46, 0
    s_mov_b32 s57, 25088
    s_lshl_b32 s65, s45, 15
    s_lshl_b32 s48, s3, 13
    s_add_u32 s47, s65, s48
    s_add_u32 s47, s47, 0x200000
    s_lshl_b32 s65, s45, 19
    s_lshl_b32 s66, s44, 14
    s_add_u32 s49, s65, s66
    s_lshl_b32 s66, s3, 12
    s_add_u32 s49, s49, s66
    s_add_u32 s49, s49, 0x2000000
    s_lshl_b32 s65, s44, 7
    s_lshl_b32 s66, s45, 2
    s_add_u32 s50, s65, s66
    s_add_u32 s50, s50, 0xf0000
    s_lshl_b32 s65, s44, 9
    s_lshl_b32 s66, s45, 7
    s_add_u32 s51, s65, s66
    s_add_u32 s51, s51, 0xf1000
    s_lshl_b32 s65, s45, 14
    s_lshl_b32 s66, s3, 11
    s_add_u32 s52, s65, s66
    s_add_u32 s52, s52, 0x100000
    s_lshl_b32 s65, s45, 18
    s_lshl_b32 s66, s44, 12
    s_add_u32 s53, s65, s66
    s_lshl_b32 s66, s3, 10
    s_add_u32 s53, s53, s66
    s_add_u32 s53, s53, 0x1000000
    s_waitcnt vmcnt(12)
    s_barrier
    s_add_u32 s65, s58, 0x1c0000
    s_add_u32 m0, s54, 57344
    s_nop 0
    buffer_load_dwordx4 v104, s[92:95], s65 offen lds
    s_add_u32 s65, s58, 0x1c4000
    s_add_u32 m0, s54, 61440
    s_nop 0
    buffer_load_dwordx4 v104, s[92:95], s65 offen lds
    ds_read_b64_tr_b16 v[128:129], v105 offset:0
    ds_read_b64_tr_b16 v[130:131], v105 offset:4096
    ds_read_b64_tr_b16 v[136:137], v106 offset:0
    ds_read_b64_tr_b16 v[138:139], v106 offset:4096
    buffer_load_dword v33, v30, s[96:99], s60 offen
    s_waitcnt vmcnt(13)
    s_waitcnt lgkmcnt(0)
    s_barrier
    s_add_u32 s65, s58, 0x200000
    s_add_u32 m0, s54, 0
    s_nop 0
    buffer_load_dwordx4 v104, s[92:95], s65 offen lds
    s_add_u32 s65, s58, 0x204000
    s_add_u32 m0, s54, 4096
    s_nop 0
    buffer_load_dwordx4 v104, s[92:95], s65 offen lds
    ds_read_b64_tr_b16 v[160:161], v105 offset:8192
    ds_read_b64_tr_b16 v[162:163], v105 offset:12288
    ds_read_b64_tr_b16 v[168:169], v106 offset:8192
    ds_read_b64_tr_b16 v[170:171], v106 offset:12288
    s_waitcnt vmcnt(13)
    s_waitcnt lgkmcnt(0)
    s_barrier
    s_add_u32 s65, s58, 0x240000
    s_add_u32 m0, s54, 8192
    s_nop 0
    buffer_load_dwordx4 v104, s[92:95], s65 offen lds
    s_add_u32 s65, s58, 0x244000
    s_add_u32 m0, s54, 12288
    s_nop 0
    buffer_load_dwordx4 v104, s[92:95], s65 offen lds
    ds_read_b64_tr_b16 v[192:193], v105 offset:16384
    ds_read_b64_tr_b16 v[194:195], v105 offset:20480
    ds_read_b64_tr_b16 v[200:201], v106 offset:16384
    ds_read_b64_tr_b16 v[202:203], v106 offset:20480
    s_waitcnt vmcnt(13)
    s_waitcnt lgkmcnt(0)
    s_barrier
    s_add_u32 s65, s58, 0x280000
    s_add_u32 m0, s54, 16384
    s_nop 0
    buffer_load_dwordx4 v104, s[92:95], s65 offen lds
    s_add_u32 s65, s58, 0x284000
    s_add_u32 m0, s54, 20480
    s_nop 0
    buffer_load_dwordx4 v104, s[92:95], s65 offen lds
    ds_read_b64_tr_b16 v[224:225], v105 offset:24576
    ds_read_b64_tr_b16 v[226:227], v105 offset:28672
    ds_read_b64_tr_b16 v[232:233], v106 offset:24576
    ds_read_b64_tr_b16 v[234:235], v106 offset:28672
    s_waitcnt vmcnt(13)
    s_waitcnt lgkmcnt(0)
    s_barrier
    s_add_u32 s65, s58, 0x2c0000
    s_add_u32 m0, s54, 24576
    s_nop 0
    buffer_load_dwordx4 v104, s[92:95], s65 offen lds
    s_add_u32 s65, s58, 0x2c4000
    s_add_u32 m0, s54, 28672
    s_nop 0
    buffer_load_dwordx4 v104, s[92:95], s65 offen lds
    ds_read_b64_tr_b16 v[132:133], v105 offset:32768
    ds_read_b64_tr_b16 v[134:135], v105 offset:36864
    ds_read_b64_tr_b16 v[140:141], v106 offset:32768
    ds_read_b64_tr_b16 v[142:143], v106 offset:36864
    s_waitcnt vmcnt(13)
    s_waitcnt lgkmcnt(0)
    s_barrier
    s_add_u32 s65, s58, 0x300000
    s_add_u32 m0, s54, 32768
    s_nop 0
    buffer_load_dwordx4 v104, s[92:95], s65 offen lds
    s_add_u32 s65, s58, 0x304000
    s_add_u32 m0, s54, 36864
    s_nop 0
    buffer_load_dwordx4 v104, s[92:95], s65 offen lds
    ds_read_b64_tr_b16 v[164:165], v105 offset:40960
    ds_read_b64_tr_b16 v[166:167], v105 offset:45056
    ds_read_b64_tr_b16 v[172:173], v106 offset:40960
    ds_read_b64_tr_b16 v[174:175], v106 offset:45056
    s_waitcnt vmcnt(13)
    s_waitcnt lgkmcnt(0)
    s_barrier
    s_add_u32 s65, s58, 0x340000
    s_add_u32 m0, s54, 40960
    s_nop 0
    buffer_load_dwordx4 v104, s[92:95], s65 offen lds
    s_add_u32 s65, s58, 0x344000
    s_add_u32 m0, s54, 45056
    s_nop 0
    buffer_load_dwordx4 v104, s[92:95], s65 offen lds
    ds_read_b64_tr_b16 v[196:197], v105 offset:49152
    ds_read_b64_tr_b16 v[198:199], v105 offset:53248
    ds_read_b64_tr_b16 v[204:205], v106 offset:49152
    ds_read_b64_tr_b16 v[206:207], v106 offset:53248
    s_waitcnt vmcnt(13)
    s_waitcnt lgkmcnt(0)
    s_barrier
    s_add_u32 s65, s58, 0x380000
    s_add_u32 m0, s54, 49152
    s_nop 0
    buffer_load_dwordx4 v104, s[92:95], s65 offen lds
    s_add_u32 s65, s58, 0x384000
    s_add_u32 m0, s54, 53248
    s_nop 0
    buffer_load_dwordx4 v104, s[92:95], s65 offen lds
    ds_read_b64_tr_b16 v[228:229], v105 offset:57344
    ds_read_b64_tr_b16 v[230:231], v105 offset:61440
    ds_read_b64_tr_b16 v[236:237], v106 offset:57344
    ds_read_b64_tr_b16 v[238:239], v106 offset:61440
    s_waitcnt vmcnt(12)
    s_waitcnt lgkmcnt(0)
    s_barrier
    s_add_u32 s65, s58, 0x3c0000
    s_add_u32 m0, s54, 57344
    s_nop 0
    buffer_load_dwordx4 v104, s[92:95], s65 offen lds
    s_add_u32 s65, s58, 0x3c4000
    s_add_u32 m0, s54, 61440
    s_nop 0
    buffer_load_dwordx4 v104, s[92:95], s65 offen lds
    ds_read_b64_tr_b16 v[144:145], v105 offset:0
    ds_read_b64_tr_b16 v[146:147], v105 offset:4096
    ds_read_b64_tr_b16 v[152:153], v106 offset:0
    ds_read_b64_tr_b16 v[154:155], v106 offset:4096
    buffer_load_dword v34, v30, s[88:91], s60 offen
    s_waitcnt vmcnt(13)
    s_waitcnt lgkmcnt(0)
    s_barrier
    s_add_u32 s65, s58, 0x0
    s_add_u32 m0, s54, 0
    s_nop 0
    buffer_load_dwordx4 v104, s[96:99], s65 offen lds
    s_add_u32 s65, s58, 0x4000
    s_add_u32 m0, s54, 4096
    s_nop 0
    buffer_load_dwordx4 v104, s[96:99], s65 offen lds
    ds_read_b64_tr_b16 v[176:177], v105 offset:8192
    ds_read_b64_tr_b16 v[178:179], v105 offset:12288
    ds_read_b64_tr_b16 v[184:185], v106 offset:8192
    ds_read_b64_tr_b16 v[186:187], v106 offset:12288
    s_waitcnt vmcnt(13)
    s_waitcnt lgkmcnt(0)
    s_barrier
    s_add_u32 s65, s58, 0x40000
    s_add_u32 m0, s54, 8192
    s_nop 0
    buffer_load_dwordx4 v104, s[96:99], s65 offen lds
    s_add_u32 s65, s58, 0x44000
    s_add_u32 m0, s54, 12288
    s_nop 0
    buffer_load_dwordx4 v104, s[96:99], s65 offen lds
    ds_read_b64_tr_b16 v[208:209], v105 offset:16384
    ds_read_b64_tr_b16 v[210:211], v105 offset:20480
    ds_read_b64_tr_b16 v[216:217], v106 offset:16384
    ds_read_b64_tr_b16 v[218:219], v106 offset:20480
    s_waitcnt vmcnt(13)
    s_waitcnt lgkmcnt(0)
    s_barrier
    s_add_u32 s65, s58, 0x80000
    s_add_u32 m0, s54, 16384
    s_nop 0
    buffer_load_dwordx4 v104, s[96:99], s65 offen lds
    s_add_u32 s65, s58, 0x84000
    s_add_u32 m0, s54, 20480
    s_nop 0
    buffer_load_dwordx4 v104, s[96:99], s65 offen lds
    ds_read_b64_tr_b16 v[240:241], v105 offset:24576
    ds_read_b64_tr_b16 v[242:243], v105 offset:28672
    ds_read_b64_tr_b16 v[248:249], v106 offset:24576
    ds_read_b64_tr_b16 v[250:251], v106 offset:28672
    s_waitcnt vmcnt(13)
    s_waitcnt lgkmcnt(0)
    s_barrier
    s_add_u32 s65, s58, 0xc0000
    s_add_u32 m0, s54, 24576
    s_nop 0
    buffer_load_dwordx4 v104, s[96:99], s65 offen lds
    s_add_u32 s65, s58, 0xc4000
    s_add_u32 m0, s54, 28672
    s_nop 0
    buffer_load_dwordx4 v104, s[96:99], s65 offen lds
    ds_read_b64_tr_b16 v[148:149], v105 offset:32768
    ds_read_b64_tr_b16 v[150:151], v105 offset:36864
    ds_read_b64_tr_b16 v[156:157], v106 offset:32768
    ds_read_b64_tr_b16 v[158:159], v106 offset:36864
    s_waitcnt vmcnt(13)
    s_waitcnt lgkmcnt(0)
    s_barrier
    s_add_u32 s65, s58, 0x100000
    s_add_u32 m0, s54, 32768
    s_nop 0
    buffer_load_dwordx4 v104, s[96:99], s65 offen lds
    s_add_u32 s65, s58, 0x104000
    s_add_u32 m0, s54, 36864
    s_nop 0
    buffer_load_dwordx4 v104, s[96:99], s65 offen lds
    ds_read_b64_tr_b16 v[180:181], v105 offset:40960
    ds_read_b64_tr_b16 v[182:183], v105 offset:45056
    ds_read_b64_tr_b16 v[188:189], v106 offset:40960
    ds_read_b64_tr_b16 v[190:191], v106 offset:45056
    s_waitcnt vmcnt(13)
    s_waitcnt lgkmcnt(0)
    s_barrier
    s_add_u32 s65, s58, 0x140000
    s_add_u32 m0, s54, 40960
    s_nop 0
    buffer_load_dwordx4 v104, s[96:99], s65 offen lds
    s_add_u32 s65, s58, 0x144000
    s_add_u32 m0, s54, 45056
    s_nop 0
    buffer_load_dwordx4 v104, s[96:99], s65 offen lds
    ds_read_b64_tr_b16 v[212:213], v105 offset:49152
    ds_read_b64_tr_b16 v[214:215], v105 offset:53248
    ds_read_b64_tr_b16 v[220:221], v106 offset:49152
    ds_read_b64_tr_b16 v[222:223], v106 offset:53248
    s_waitcnt vmcnt(13)
    s_waitcnt lgkmcnt(0)
    s_barrier
    s_add_u32 s65, s58, 0x180000
    s_add_u32 m0, s54, 49152
    s_nop 0
    buffer_load_dwordx4 v104, s[96:99], s65 offen lds
    s_add_u32 s65, s58, 0x184000
    s_add_u32 m0, s54, 53248
    s_nop 0
    buffer_load_dwordx4 v104, s[96:99], s65 offen lds
    ds_read_b64_tr_b16 v[244:245], v105 offset:57344
    ds_read_b64_tr_b16 v[246:247], v105 offset:61440
    ds_read_b64_tr_b16 v[252:253], v106 offset:57344
    ds_read_b64_tr_b16 v[254:255], v106 offset:61440
    s_waitcnt vmcnt(12)
    s_waitcnt lgkmcnt(0)
    s_barrier
    s_add_u32 s65, s58, 0x1c0000
    s_add_u32 m0, s54, 57344
    s_nop 0
    buffer_load_dwordx4 v104, s[96:99], s65 offen lds
    s_add_u32 s65, s58, 0x1c4000
    s_add_u32 m0, s54, 61440
    s_nop 0
    buffer_load_dwordx4 v104, s[96:99], s65 offen lds
    ds_read_b64_tr_b16 a[0:1], v105 offset:0
    ds_read_b64_tr_b16 a[2:3], v105 offset:4096
    ds_read_b64_tr_b16 a[8:9], v106 offset:0
    ds_read_b64_tr_b16 a[10:11], v106 offset:4096
    s_waitcnt vmcnt(12)
    s_waitcnt lgkmcnt(0)
    s_barrier
    s_add_u32 s65, s58, 0x200000
    s_add_u32 m0, s54, 0
    s_nop 0
    buffer_load_dwordx4 v104, s[96:99], s65 offen lds
    s_add_u32 s65, s58, 0x204000
    s_add_u32 m0, s54, 4096
    s_nop 0
    buffer_load_dwordx4 v104, s[96:99], s65 offen lds
    ds_read_b64_tr_b16 a[32:33], v105 offset:8192
    ds_read_b64_tr_b16 a[34:35], v105 offset:12288
    ds_read_b64_tr_b16 a[40:41], v106 offset:8192
    ds_read_b64_tr_b16 a[42:43], v106 offset:12288
    s_waitcnt vmcnt(12)
    s_waitcnt lgkmcnt(0)
    s_barrier
    s_add_u32 s65, s58, 0x240000
    s_add_u32 m0, s54, 8192
    s_nop 0
    buffer_load_dwordx4 v104, s[96:99], s65 offen lds
    s_add_u32 s65, s58, 0x244000
    s_add_u32 m0, s54, 12288
    s_nop 0
    buffer_load_dwordx4 v104, s[96:99], s65 offen lds
    ds_read_b64_tr_b16 a[64:65], v105 offset:16384
    ds_read_b64_tr_b16 a[66:67], v105 offset:20480
    ds_read_b64_tr_b16 a[72:73], v106 offset:16384
    ds_read_b64_tr_b16 a[74:75], v106 offset:20480
    s_waitcnt vmcnt(12)
    s_waitcnt lgkmcnt(0)
    s_barrier
    s_add_u32 s65, s58, 0x280000
    s_add_u32 m0, s54, 16384
    s_nop 0
    buffer_load_dwordx4 v104, s[96:99], s65 offen lds
    s_add_u32 s65, s58, 0x284000
    s_add_u32 m0, s54, 20480
    s_nop 0
    buffer_load_dwordx4 v104, s[96:99], s65 offen lds
    ds_read_b64_tr_b16 a[96:97], v105 offset:24576
    ds_read_b64_tr_b16 a[98:99], v105 offset:28672
    ds_read_b64_tr_b16 a[104:105], v106 offset:24576
    ds_read_b64_tr_b16 a[106:107], v106 offset:28672
    s_waitcnt vmcnt(12)
    s_waitcnt lgkmcnt(0)
    s_barrier
    s_add_u32 s65, s58, 0x2c0000
    s_add_u32 m0, s54, 24576
    s_nop 0
    buffer_load_dwordx4 v104, s[96:99], s65 offen lds
    s_add_u32 s65, s58, 0x2c4000
    s_add_u32 m0, s54, 28672
    s_nop 0
    buffer_load_dwordx4 v104, s[96:99], s65 offen lds
    ds_read_b64_tr_b16 a[4:5], v105 offset:32768
    ds_read_b64_tr_b16 a[6:7], v105 offset:36864
    ds_read_b64_tr_b16 a[12:13], v106 offset:32768
    ds_read_b64_tr_b16 a[14:15], v106 offset:36864
    s_waitcnt vmcnt(12)
    s_waitcnt lgkmcnt(0)
    s_barrier
    s_add_u32 s65, s58, 0x300000
    s_add_u32 m0, s54, 32768
    s_nop 0
    buffer_load_dwordx4 v104, s[96:99], s65 offen lds
    s_add_u32 s65, s58, 0x304000
    s_add_u32 m0, s54, 36864
    s_nop 0
    buffer_load_dwordx4 v104, s[96:99], s65 offen lds
    ds_read_b64_tr_b16 a[36:37], v105 offset:40960
    ds_read_b64_tr_b16 a[38:39], v105 offset:45056
    ds_read_b64_tr_b16 a[44:45], v106 offset:40960
    ds_read_b64_tr_b16 a[46:47], v106 offset:45056
    s_waitcnt vmcnt(12)
    s_waitcnt lgkmcnt(0)
    s_barrier
    s_add_u32 s65, s58, 0x340000
    s_add_u32 m0, s54, 40960
    s_nop 0
    buffer_load_dwordx4 v104, s[96:99], s65 offen lds
    s_add_u32 s65, s58, 0x344000
    s_add_u32 m0, s54, 45056
    s_nop 0
    buffer_load_dwordx4 v104, s[96:99], s65 offen lds
    ds_read_b64_tr_b16 a[68:69], v105 offset:49152
    ds_read_b64_tr_b16 a[70:71], v105 offset:53248
    ds_read_b64_tr_b16 a[76:77], v106 offset:49152
    ds_read_b64_tr_b16 a[78:79], v106 offset:53248
    s_waitcnt vmcnt(12)
    s_waitcnt lgkmcnt(0)
    s_barrier
    s_add_u32 s65, s58, 0x380000
    s_add_u32 m0, s54, 49152
    s_nop 0
    buffer_load_dwordx4 v104, s[96:99], s65 offen lds
    s_add_u32 s65, s58, 0x384000
    s_add_u32 m0, s54, 53248
    s_nop 0
    buffer_load_dwordx4 v104, s[96:99], s65 offen lds
    ds_read_b64_tr_b16 a[100:101], v105 offset:57344
    ds_read_b64_tr_b16 a[102:103], v105 offset:61440
    ds_read_b64_tr_b16 a[108:109], v106 offset:57344
    ds_read_b64_tr_b16 a[110:111], v106 offset:61440
    s_waitcnt vmcnt(12)
    s_waitcnt lgkmcnt(0)
    s_barrier
    s_add_u32 s65, s58, 0x3c0000
    s_add_u32 m0, s54, 57344
    s_nop 0
    buffer_load_dwordx4 v104, s[96:99], s65 offen lds
    s_add_u32 s65, s58, 0x3c4000
    s_add_u32 m0, s54, 61440
    s_nop 0
    buffer_load_dwordx4 v104, s[96:99], s65 offen lds
    ds_read_b64_tr_b16 a[16:17], v105 offset:0
    ds_read_b64_tr_b16 a[18:19], v105 offset:4096
    ds_read_b64_tr_b16 a[24:25], v106 offset:0
    ds_read_b64_tr_b16 a[26:27], v106 offset:4096
    buffer_load_dword v35, v31, s[8:11], s61 offen
    s_waitcnt vmcnt(13)
    s_waitcnt lgkmcnt(0)
    s_barrier
    ds_read_b64_tr_b16 a[48:49], v105 offset:8192
    ds_read_b64_tr_b16 a[50:51], v105 offset:12288
    ds_read_b64_tr_b16 a[56:57], v106 offset:8192
    ds_read_b64_tr_b16 a[58:59], v106 offset:12288
    s_waitcnt vmcnt(11)
    s_waitcnt lgkmcnt(0)
    s_barrier
    ds_read_b64_tr_b16 a[80:81], v105 offset:16384
    ds_read_b64_tr_b16 a[82:83], v105 offset:20480
    ds_read_b64_tr_b16 a[88:89], v106 offset:16384
    ds_read_b64_tr_b16 a[90:91], v106 offset:20480
    s_waitcnt vmcnt(9)
    s_waitcnt lgkmcnt(0)
    s_barrier
    ds_read_b64_tr_b16 a[112:113], v105 offset:24576
    ds_read_b64_tr_b16 a[114:115], v105 offset:28672
    ds_read_b64_tr_b16 a[120:121], v106 offset:24576
    ds_read_b64_tr_b16 a[122:123], v106 offset:28672
    s_waitcnt vmcnt(7)
    s_waitcnt lgkmcnt(0)
    s_barrier
    ds_read_b64_tr_b16 a[20:21], v105 offset:32768
    ds_read_b64_tr_b16 a[22:23], v105 offset:36864
    ds_read_b64_tr_b16 a[28:29], v106 offset:32768
    ds_read_b64_tr_b16 a[30:31], v106 offset:36864
    s_waitcnt vmcnt(5)
    s_waitcnt lgkmcnt(0)
    s_barrier
    ds_read_b64_tr_b16 a[52:53], v105 offset:40960
    ds_read_b64_tr_b16 a[54:55], v105 offset:45056
    ds_read_b64_tr_b16 a[60:61], v106 offset:40960
    ds_read_b64_tr_b16 a[62:63], v106 offset:45056
    s_waitcnt vmcnt(3)
    s_waitcnt lgkmcnt(0)
    s_barrier
    ds_read_b64_tr_b16 a[84:85], v105 offset:49152
    ds_read_b64_tr_b16 a[86:87], v105 offset:53248
    ds_read_b64_tr_b16 a[92:93], v106 offset:49152
    ds_read_b64_tr_b16 a[94:95], v106 offset:53248
    s_waitcnt vmcnt(1)
    s_waitcnt lgkmcnt(0)
    s_barrier
    ds_read_b64_tr_b16 a[116:117], v105 offset:57344
    ds_read_b64_tr_b16 a[118:119], v105 offset:61440
    ds_read_b64_tr_b16 a[124:125], v106 offset:57344
    ds_read_b64_tr_b16 a[126:127], v106 offset:61440
    s_waitcnt vmcnt(0) lgkmcnt(0)
    s_mov_b32 s12, s40
    s_mov_b32 s13, s41
    s_mov_b32 s14, 0x100
    s_mov_b32 s15, 0x20000
    v_and_b32 v20, 15, v16
    v_lshlrev_b32 v20, 2, v20
    s_mov_b32 s65, 0x80808080
    s_cmp_lg_u32 s3, 0
    s_cbranch_scc1 A_init_ok
A_init:
    buffer_load_dword v19, v20, s[12:15], 0 offen sc1
    s_sub_u32 s69, s69, 1
    s_cbranch_scc1 L_exit
    s_waitcnt vmcnt(0)
    v_and_b32 v21, s65, v19
    v_cmp_ne_u32 vcc, s65, v21
    s_cbranch_vccz A_init_ok
    s_sleep 8
    s_branch A_init
A_init_ok:
    s_barrier
    s_add_u32 m0, s48, 0
    s_add_u32 s65, s47, 0
    buffer_load_dwordx4 v0, s[4:7], s65 offen offset:0 sc1 lds
    buffer_load_dwordx4 v0, s[4:7], s65 offen offset:1024 sc1 lds
    buffer_load_dwordx4 v0, s[4:7], s65 offen offset:2048 sc1 lds
    buffer_load_dwordx4 v0, s[4:7], s65 offen offset:3072 sc1 lds
    s_add_u32 m0, s48, 4096
    s_add_u32 s65, s47, 4096
    buffer_load_dwordx4 v0, s[4:7], s65 offen offset:0 sc1 lds
    buffer_load_dwordx4 v0, s[4:7], s65 offen offset:1024 sc1 lds
    buffer_load_dwordx4 v0, s[4:7], s65 offen offset:2048 sc1 lds
    buffer_load_dwordx4 v0, s[4:7], s65 offen offset:3072 sc1 lds
    s_xor_b32 s48, s48, 32768
    s_add_u32 s47, s47, 131072
A_loop:
    s_cmp_eq_u32 s46, 16
    s_cbranch_scc1 A_att
    s_waitcnt vmcnt(0)
    s_barrier
    ds_read_b128 v[64:67], v1 offset:0
    ds_read_b128 v[68:71], v1 offset:16384
    s_add_u32 m0, s48, 0
    s_add_u32 s65, s47, 0
    buffer_load_dwordx4 v0, s[4:7], s65 offen offset:0 sc1 lds
    buffer_load_dwordx4 v0, s[4:7], s65 offen offset:1024 sc1 lds
    buffer_load_dwordx4 v0, s[4:7], s65 offen offset:2048 sc1 lds
    buffer_load_dwordx4 v0, s[4:7], s65 offen offset:3072 sc1 lds
    s_add_u32 m0, s48, 4096
    s_add_u32 s65, s47, 4096
    buffer_load_dwordx4 v0, s[4:7], s65 offen offset:0 sc1 lds
    buffer_load_dwordx4 v0, s[4:7], s65 offen offset:1024 sc1 lds
    buffer_load_dwordx4 v0, s[4:7], s65 offen offset:2048 sc1 lds
    buffer_load_dwordx4 v0, s[4:7], s65 offen offset:3072 sc1 lds
    s_xor_b32 s48, s48, 32768
    s_add_u32 s47, s47, 131072
    s_waitcnt lgkmcnt(1)
    v_mfma_f32_16x16x32_bf16 v[16:19], v[128:131], v[64:67], 0
    ds_read_b128 v[72:75], v1 offset:1024
    v_mfma_f32_16x16x32_bf16 v[24:27], v[136:139], v[64:67], 0
    ds_read_b128 v[76:79], v1 offset:17408
    v_mfma_f32_16x16x32_bf16 v[32:35], v[64:67], a[0:3], 0
    v_mfma_f32_16x16x32_bf16 v[40:43], v[64:67], a[8:11], 0
    s_waitcnt lgkmcnt(2)
    v_mfma_f32_16x16x32_bf16 v[20:23], v[128:131], v[68:71], 0
    v_mfma_f32_16x16x32_bf16 v[28:31], v[136:139], v[68:71], 0
    v_mfma_f32_16x16x32_bf16 v[36:39], v[68:71], a[0:3], 0
    v_mfma_f32_16x16x32_bf16 v[44:47], v[68:71], a[8:11], 0
    s_waitcnt lgkmcnt(1)
    v_mfma_f32_16x16x32_bf16 v[16:19], v[160:163], v[72:75], v[16:19]
    ds_read_b128 v[64:67], v1 offset:2048
    v_mfma_f32_16x16x32_bf16 v[24:27], v[168:171], v[72:75], v[24:27]
    ds_read_b128 v[68:71], v1 offset:18432
    v_mfma_f32_16x16x32_bf16 v[32:35], v[72:75], a[32:35], v[32:35]
    v_mfma_f32_16x16x32_bf16 v[40:43], v[72:75], a[40:43], v[40:43]
    s_waitcnt lgkmcnt(2)
    v_mfma_f32_16x16x32_bf16 v[20:23], v[160:163], v[76:79], v[20:23]
    v_mfma_f32_16x16x32_bf16 v[28:31], v[168:171], v[76:79], v[28:31]
    v_mfma_f32_16x16x32_bf16 v[36:39], v[76:79], a[32:35], v[36:39]
    v_mfma_f32_16x16x32_bf16 v[44:47], v[76:79], a[40:43], v[44:47]
    s_waitcnt lgkmcnt(1)
    v_mfma_f32_16x16x32_bf16 v[16:19], v[192:195], v[64:67], v[16:19]
    ds_read_b128 v[72:75], v1 offset:3072
    v_mfma_f32_16x16x32_bf16 v[24:27], v[200:203], v[64:67], v[24:27]
    ds_read_b128 v[76:79], v1 offset:19456
    v_mfma_f32_16x16x32_bf16 v[32:35], v[64:67], a[64:67], v[32:35]
    v_mfma_f32_16x16x32_bf16 v[40:43], v[64:67], a[72:75], v[40:43]
    s_waitcnt lgkmcnt(2)
    v_mfma_f32_16x16x32_bf16 v[20:23], v[192:195], v[68:71], v[20:23]
    v_mfma_f32_16x16x32_bf16 v[28:31], v[200:203], v[68:71], v[28:31]
    v_mfma_f32_16x16x32_bf16 v[36:39], v[68:71], a[64:67], v[36:39]
    v_mfma_f32_16x16x32_bf16 v[44:47], v[68:71], a[72:75], v[44:47]
    s_waitcnt lgkmcnt(1)
    v_mfma_f32_16x16x32_bf16 v[16:19], v[224:227], v[72:75], v[16:19]
    ds_read_b128 v[64:67], v1 offset:4096
    v_mfma_f32_16x16x32_bf16 v[24:27], v[232:235], v[72:75], v[24:27]
    ds_read_b128 v[68:71], v1 offset:20480
    v_mfma_f32_16x16x32_bf16 v[32:35], v[72:75], a[96:99], v[32:35]
    v_mfma_f32_16x16x32_bf16 v[40:43], v[72:75], a[104:107], v[40:43]
    s_waitcnt lgkmcnt(2)
    v_mfma_f32_16x16x32_bf16 v[20:23], v[224:227], v[76:79], v[20:23]
    v_mfma_f32_16x16x32_bf16 v[28:31], v[232:235], v[76:79], v[28:31]
    v_mfma_f32_16x16x32_bf16 v[36:39], v[76:79], a[96:99], v[36:39]
    v_mfma_f32_16x16x32_bf16 v[44:47], v[76:79], a[104:107], v[44:47]
    s_waitcnt lgkmcnt(1)
    v_mfma_f32_16x16x32_bf16 v[16:19], v[132:135], v[64:67], v[16:19]
    ds_read_b128 v[72:75], v1 offset:5120
    v_mfma_f32_16x16x32_bf16 v[24:27], v[140:143], v[64:67], v[24:27]
    ds_read_b128 v[76:79], v1 offset:21504
    v_mfma_f32_16x16x32_bf16 v[32:35], v[64:67], a[4:7], v[32:35]
    v_mfma_f32_16x16x32_bf16 v[40:43], v[64:67], a[12:15], v[40:43]
    s_waitcnt lgkmcnt(2)
    v_mfma_f32_16x16x32_bf16 v[20:23], v[132:135], v[68:71], v[20:23]
    v_mfma_f32_16x16x32_bf16 v[28:31], v[140:143], v[68:71], v[28:31]
    v_mfma_f32_16x16x32_bf16 v[36:39], v[68:71], a[4:7], v[36:39]
    v_mfma_f32_16x16x32_bf16 v[44:47], v[68:71], a[12:15], v[44:47]
    s_waitcnt lgkmcnt(1)
    v_mfma_f32_16x16x32_bf16 v[16:19], v[164:167], v[72:75], v[16:19]
    ds_read_b128 v[64:67], v1 offset:6144
    v_mfma_f32_16x16x32_bf16 v[24:27], v[172:175], v[72:75], v[24:27]
    ds_read_b128 v[68:71], v1 offset:22528
    v_mfma_f32_16x16x32_bf16 v[32:35], v[72:75], a[36:39], v[32:35]
    v_mfma_f32_16x16x32_bf16 v[40:43], v[72:75], a[44:47], v[40:43]
    s_waitcnt lgkmcnt(2)
    v_mfma_f32_16x16x32_bf16 v[20:23], v[164:167], v[76:79], v[20:23]
    v_mfma_f32_16x16x32_bf16 v[28:31], v[172:175], v[76:79], v[28:31]
    v_mfma_f32_16x16x32_bf16 v[36:39], v[76:79], a[36:39], v[36:39]
    v_mfma_f32_16x16x32_bf16 v[44:47], v[76:79], a[44:47], v[44:47]
    s_waitcnt lgkmcnt(1)
    v_mfma_f32_16x16x32_bf16 v[16:19], v[196:199], v[64:67], v[16:19]
    ds_read_b128 v[72:75], v1 offset:7168
    v_mfma_f32_16x16x32_bf16 v[24:27], v[204:207], v[64:67], v[24:27]
    ds_read_b128 v[76:79], v1 offset:23552
    v_mfma_f32_16x16x32_bf16 v[32:35], v[64:67], a[68:71], v[32:35]
    v_mfma_f32_16x16x32_bf16 v[40:43], v[64:67], a[76:79], v[40:43]
    s_waitcnt lgkmcnt(2)
    v_mfma_f32_16x16x32_bf16 v[20:23], v[196:199], v[68:71], v[20:23]
    v_mfma_f32_16x16x32_bf16 v[28:31], v[204:207], v[68:71], v[28:31]
    v_mfma_f32_16x16x32_bf16 v[36:39], v[68:71], a[68:71], v[36:39]
    v_mfma_f32_16x16x32_bf16 v[44:47], v[68:71], a[76:79], v[44:47]
    s_waitcnt lgkmcnt(1)
    v_mfma_f32_16x16x32_bf16 v[16:19], v[228:231], v[72:75], v[16:19]
    ds_read_b128 v[64:67], v1 offset:8192
    v_mfma_f32_16x16x32_bf16 v[24:27], v[236:239], v[72:75], v[24:27]
    ds_read_b128 v[68:71], v1 offset:24576
    v_mfma_f32_16x16x32_bf16 v[32:35], v[72:75], a[100:103], v[32:35]
    v_mfma_f32_16x16x32_bf16 v[40:43], v[72:75], a[108:111], v[40:43]
    s_waitcnt lgkmcnt(2)
    v_mfma_f32_16x16x32_bf16 v[20:23], v[228:231], v[76:79], v[20:23]
    v_mfma_f32_16x16x32_bf16 v[28:31], v[236:239], v[76:79], v[28:31]
    v_mfma_f32_16x16x32_bf16 v[36:39], v[76:79], a[100:103], v[36:39]
    v_mfma_f32_16x16x32_bf16 v[44:47], v[76:79], a[108:111], v[44:47]
    s_waitcnt lgkmcnt(1)
    v_mfma_f32_16x16x32_bf16 v[16:19], v[144:147], v[64:67], v[16:19]
    ds_read_b128 v[72:75], v1 offset:9216
    v_mfma_f32_16x16x32_bf16 v[24:27], v[152:155], v[64:67], v[24:27]
    ds_read_b128 v[76:79], v1 offset:25600
    v_mfma_f32_16x16x32_bf16 v[32:35], v[64:67], a[16:19], v[32:35]
    v_mfma_f32_16x16x32_bf16 v[40:43], v[64:67], a[24:27], v[40:43]
    s_waitcnt lgkmcnt(2)
    v_mfma_f32_16x16x32_bf16 v[20:23], v[144:147], v[68:71], v[20:23]
    v_mfma_f32_16x16x32_bf16 v[28:31], v[152:155], v[68:71], v[28:31]
    v_mfma_f32_16x16x32_bf16 v[36:39], v[68:71], a[16:19], v[36:39]
    v_mfma_f32_16x16x32_bf16 v[44:47], v[68:71], a[24:27], v[44:47]
    s_waitcnt lgkmcnt(1)
    v_mfma_f32_16x16x32_bf16 v[16:19], v[176:179], v[72:75], v[16:19]
    ds_read_b128 v[64:67], v1 offset:10240
    v_mfma_f32_16x16x32_bf16 v[24:27], v[184:187], v[72:75], v[24:27]
    ds_read_b128 v[68:71], v1 offset:26624
    v_mfma_f32_16x16x32_bf16 v[32:35], v[72:75], a[48:51], v[32:35]
    v_mfma_f32_16x16x32_bf16 v[40:43], v[72:75], a[56:59], v[40:43]
    s_waitcnt lgkmcnt(2)
    v_mfma_f32_16x16x32_bf16 v[20:23], v[176:179], v[76:79], v[20:23]
    v_mfma_f32_16x16x32_bf16 v[28:31], v[184:187], v[76:79], v[28:31]
    v_mfma_f32_16x16x32_bf16 v[36:39], v[76:79], a[48:51], v[36:39]
    v_mfma_f32_16x16x32_bf16 v[44:47], v[76:79], a[56:59], v[44:47]
    s_waitcnt lgkmcnt(1)
    v_mfma_f32_16x16x32_bf16 v[16:19], v[208:211], v[64:67], v[16:19]
    ds_read_b128 v[72:75], v1 offset:11264
    v_mfma_f32_16x16x32_bf16 v[24:27], v[216:219], v[64:67], v[24:27]
    ds_read_b128 v[76:79], v1 offset:27648
    v_mfma_f32_16x16x32_bf16 v[32:35], v[64:67], a[80:83], v[32:35]
    v_mfma_f32_16x16x32_bf16 v[40:43], v[64:67], a[88:91], v[40:43]
    s_waitcnt lgkmcnt(2)
    v_mfma_f32_16x16x32_bf16 v[20:23], v[208:211], v[68:71], v[20:23]
    v_mfma_f32_16x16x32_bf16 v[28:31], v[216:219], v[68:71], v[28:31]
    v_mfma_f32_16x16x32_bf16 v[36:39], v[68:71], a[80:83], v[36:39]
    v_mfma_f32_16x16x32_bf16 v[44:47], v[68:71], a[88:91], v[44:47]
    s_waitcnt lgkmcnt(1)
    v_mfma_f32_16x16x32_bf16 v[16:19], v[240:243], v[72:75], v[16:19]
    ds_read_b128 v[64:67], v1 offset:12288
    v_mfma_f32_16x16x32_bf16 v[24:27], v[248:251], v[72:75], v[24:27]
    ds_read_b128 v[68:71], v1 offset:28672
    v_mfma_f32_16x16x32_bf16 v[32:35], v[72:75], a[112:115], v[32:35]
    v_mfma_f32_16x16x32_bf16 v[40:43], v[72:75], a[120:123], v[40:43]
    s_waitcnt lgkmcnt(2)
    v_mfma_f32_16x16x32_bf16 v[20:23], v[240:243], v[76:79], v[20:23]
    v_mfma_f32_16x16x32_bf16 v[28:31], v[248:251], v[76:79], v[28:31]
    v_mfma_f32_16x16x32_bf16 v[36:39], v[76:79], a[112:115], v[36:39]
    v_mfma_f32_16x16x32_bf16 v[44:47], v[76:79], a[120:123], v[44:47]
    s_waitcnt lgkmcnt(1)
    v_mfma_f32_16x16x32_bf16 v[16:19], v[148:151], v[64:67], v[16:19]
    ds_read_b128 v[72:75], v1 offset:13312
    v_mfma_f32_16x16x32_bf16 v[24:27], v[156:159], v[64:67], v[24:27]
    ds_read_b128 v[76:79], v1 offset:29696
    v_mfma_f32_16x16x32_bf16 v[32:35], v[64:67], a[20:23], v[32:35]
    v_mfma_f32_16x16x32_bf16 v[40:43], v[64:67], a[28:31], v[40:43]
    s_waitcnt lgkmcnt(2)
    v_mfma_f32_16x16x32_bf16 v[20:23], v[148:151], v[68:71], v[20:23]
    v_mfma_f32_16x16x32_bf16 v[28:31], v[156:159], v[68:71], v[28:31]
    v_mfma_f32_16x16x32_bf16 v[36:39], v[68:71], a[20:23], v[36:39]
    v_mfma_f32_16x16x32_bf16 v[44:47], v[68:71], a[28:31], v[44:47]
    s_waitcnt lgkmcnt(1)
    v_mfma_f32_16x16x32_bf16 v[16:19], v[180:183], v[72:75], v[16:19]
    ds_read_b128 v[64:67], v1 offset:14336
    v_mfma_f32_16x16x32_bf16 v[24:27], v[188:191], v[72:75], v[24:27]
    ds_read_b128 v[68:71], v1 offset:30720
    v_mfma_f32_16x16x32_bf16 v[32:35], v[72:75], a[52:55], v[32:35]
    v_mfma_f32_16x16x32_bf16 v[40:43], v[72:75], a[60:63], v[40:43]
    s_waitcnt lgkmcnt(2)
    v_mfma_f32_16x16x32_bf16 v[20:23], v[180:183], v[76:79], v[20:23]
    v_mfma_f32_16x16x32_bf16 v[28:31], v[188:191], v[76:79], v[28:31]
    v_mfma_f32_16x16x32_bf16 v[36:39], v[76:79], a[52:55], v[36:39]
    v_mfma_f32_16x16x32_bf16 v[44:47], v[76:79], a[60:63], v[44:47]
    s_waitcnt lgkmcnt(1)
    v_mfma_f32_16x16x32_bf16 v[16:19], v[212:215], v[64:67], v[16:19]
    ds_read_b128 v[72:75], v1 offset:15360
    v_mfma_f32_16x16x32_bf16 v[24:27], v[220:223], v[64:67], v[24:27]
    ds_read_b128 v[76:79], v1 offset:31744
    v_mfma_f32_16x16x32_bf16 v[32:35], v[64:67], a[84:87], v[32:35]
    v_mfma_f32_16x16x32_bf16 v[40:43], v[64:67], a[92:95], v[40:43]
    s_waitcnt lgkmcnt(2)
    v_mfma_f32_16x16x32_bf16 v[20:23], v[212:215], v[68:71], v[20:23]
    v_mfma_f32_16x16x32_bf16 v[28:31], v[220:223], v[68:71], v[28:31]
    v_mfma_f32_16x16x32_bf16 v[36:39], v[68:71], a[84:87], v[36:39]
    v_mfma_f32_16x16x32_bf16 v[44:47], v[68:71], a[92:95], v[44:47]
    s_waitcnt lgkmcnt(1)
    v_mfma_f32_16x16x32_bf16 v[16:19], v[244:247], v[72:75], v[16:19]
    v_mfma_f32_16x16x32_bf16 v[24:27], v[252:255], v[72:75], v[24:27]
    v_mfma_f32_16x16x32_bf16 v[32:35], v[72:75], a[116:119], v[32:35]
    v_mfma_f32_16x16x32_bf16 v[40:43], v[72:75], a[124:127], v[40:43]
    s_waitcnt lgkmcnt(0)
    v_mfma_f32_16x16x32_bf16 v[20:23], v[244:247], v[76:79], v[20:23]
    v_mfma_f32_16x16x32_bf16 v[28:31], v[252:255], v[76:79], v[28:31]
    v_mfma_f32_16x16x32_bf16 v[36:39], v[76:79], a[116:119], v[36:39]
    v_mfma_f32_16x16x32_bf16 v[44:47], v[76:79], a[124:127], v[44:47]
    s_mul_i32 s65, s3, 2176
    v_add_u32 v96, s65, v2
    v_cvt_pk_bf16_f32 v80, v16, v24
    v_cvt_pk_bf16_f32 v81, v17, v25
    v_cvt_pk_bf16_f32 v82, v18, v26
    v_cvt_pk_bf16_f32 v83, v19, v27
    v_cvt_pk_bf16_f32 v84, v20, v28
    v_cvt_pk_bf16_f32 v85, v21, v29
    v_cvt_pk_bf16_f32 v86, v22, v30
    v_cvt_pk_bf16_f32 v87, v23, v31
    ds_write_b128 v4, v[80:83] offset:0
    ds_write_b128 v4, v[84:87] offset:128
    v_cvt_pk_bf16_f32 v88, v32, v33
    v_cvt_pk_bf16_f32 v89, v34, v35
    v_cvt_pk_bf16_f32 v90, v36, v37
    v_cvt_pk_bf16_f32 v91, v38, v39
    v_cvt_pk_bf16_f32 v92, v40, v41
    v_cvt_pk_bf16_f32 v93, v42, v43
    v_cvt_pk_bf16_f32 v94, v44, v45
    v_cvt_pk_bf16_f32 v95, v46, v47
    buffer_store_dwordx4 v[88:91], v0, s[4:7], s49 offen offset:2048 sc1
    buffer_store_dwordx4 v[92:95], v0, s[4:7], s49 offen offset:3072 sc1
    s_waitcnt lgkmcnt(0)
    s_barrier
    ds_read_b128 v[80:83], v96 offset:8192
    ds_read_b128 v[84:87], v96 offset:9216
    ds_write_b128 v11, v[88:91] offset:16896
    ds_write_b128 v11, v[92:95] offset:20992
    s_waitcnt lgkmcnt(3)
    buffer_store_dwordx4 v[80:83], v0, s[4:7], s49 offen offset:0 sc1
    s_waitcnt lgkmcnt(2)
    buffer_store_dwordx4 v[84:87], v0, s[4:7], s49 offen offset:1024 sc1
    s_add_u32 s49, s49, 2097152
    s_add_u32 s66, s46, 1
    v_mov_b32 v97, s66
    s_cmp_eq_u32 s46, 0
    s_cbranch_scc1 A_first
A_q:
    ds_read_b128 v[64:67], v1 offset:0
    ds_read_b128 v[68:71], v1 offset:16384
    s_waitcnt lgkmcnt(1)
    v_mfma_f32_16x16x32_bf16 v[48:51], a[128:131], v[64:67], 0
    ds_read_b128 v[72:75], v1 offset:1024
    v_mfma_f32_16x16x32_bf16 v[56:59], a[136:139], v[64:67], 0
    ds_read_b128 v[76:79], v1 offset:17408
    s_waitcnt lgkmcnt(2)
    v_mfma_f32_16x16x32_bf16 v[52:55], a[128:131], v[68:71], 0
    v_mfma_f32_16x16x32_bf16 v[60:63], a[136:139], v[68:71], 0
    s_waitcnt lgkmcnt(1)
    v_mfma_f32_16x16x32_bf16 v[48:51], a[160:163], v[72:75], v[48:51]
    ds_read_b128 v[64:67], v1 offset:2048
    v_mfma_f32_16x16x32_bf16 v[56:59], a[168:171], v[72:75], v[56:59]
    ds_read_b128 v[68:71], v1 offset:18432
    s_waitcnt lgkmcnt(2)
    v_mfma_f32_16x16x32_bf16 v[52:55], a[160:163], v[76:79], v[52:55]
    v_mfma_f32_16x16x32_bf16 v[60:63], a[168:171], v[76:79], v[60:63]
    s_waitcnt lgkmcnt(1)
    v_mfma_f32_16x16x32_bf16 v[48:51], a[192:195], v[64:67], v[48:51]
    ds_read_b128 v[72:75], v1 offset:3072
    v_mfma_f32_16x16x32_bf16 v[56:59], a[200:203], v[64:67], v[56:59]
    ds_read_b128 v[76:79], v1 offset:19456
    s_waitcnt lgkmcnt(2)
    v_mfma_f32_16x16x32_bf16 v[52:55], a[192:195], v[68:71], v[52:55]
    v_mfma_f32_16x16x32_bf16 v[60:63], a[200:203], v[68:71], v[60:63]
    s_waitcnt lgkmcnt(1)
    v_mfma_f32_16x16x32_bf16 v[48:51], a[224:227], v[72:75], v[48:51]
    ds_read_b128 v[64:67], v1 offset:4096
    v_mfma_f32_16x16x32_bf16 v[56:59], a[232:235], v[72:75], v[56:59]
    ds_read_b128 v[68:71], v1 offset:20480
    s_waitcnt lgkmcnt(2)
    v_mfma_f32_16x16x32_bf16 v[52:55], a[224:227], v[76:79], v[52:55]
    v_mfma_f32_16x16x32_bf16 v[60:63], a[232:235], v[76:79], v[60:63]
    s_waitcnt lgkmcnt(1)
    v_mfma_f32_16x16x32_bf16 v[48:51], a[132:135], v[64:67], v[48:51]
    ds_read_b128 v[72:75], v1 offset:5120
    v_mfma_f32_16x16x32_bf16 v[56:59], a[140:143], v[64:67], v[56:59]
    ds_read_b128 v[76:79], v1 offset:21504
    s_waitcnt lgkmcnt(2)
    v_mfma_f32_16x16x32_bf16 v[52:55], a[132:135], v[68:71], v[52:55]
    v_mfma_f32_16x16x32_bf16 v[60:63], a[140:143], v[68:71], v[60:63]
    s_waitcnt lgkmcnt(1)
    v_mfma_f32_16x16x32_bf16 v[48:51], a[164:167], v[72:75], v[48:51]
    ds_read_b128 v[64:67], v1 offset:6144
    v_mfma_f32_16x16x32_bf16 v[56:59], a[172:175], v[72:75], v[56:59]
    ds_read_b128 v[68:71], v1 offset:22528
    s_waitcnt lgkmcnt(2)
    v_mfma_f32_16x16x32_bf16 v[52:55], a[164:167], v[76:79], v[52:55]
    v_mfma_f32_16x16x32_bf16 v[60:63], a[172:175], v[76:79], v[60:63]
    s_waitcnt lgkmcnt(1)
    v_mfma_f32_16x16x32_bf16 v[48:51], a[196:199], v[64:67], v[48:51]
    ds_read_b128 v[72:75], v1 offset:7168
    v_mfma_f32_16x16x32_bf16 v[56:59], a[204:207], v[64:67], v[56:59]
    ds_read_b128 v[76:79], v1 offset:23552
    s_waitcnt lgkmcnt(2)
    v_mfma_f32_16x16x32_bf16 v[52:55], a[196:199], v[68:71], v[52:55]
    v_mfma_f32_16x16x32_bf16 v[60:63], a[204:207], v[68:71], v[60:63]
    s_waitcnt lgkmcnt(1)
    v_mfma_f32_16x16x32_bf16 v[48:51], a[228:231], v[72:75], v[48:51]
    ds_read_b128 v[64:67], v1 offset:8192
    v_mfma_f32_16x16x32_bf16 v[56:59], a[236:239], v[72:75], v[56:59]
    ds_read_b128 v[68:71], v1 offset:24576
    s_waitcnt lgkmcnt(2)
    v_mfma_f32_16x16x32_bf16 v[52:55], a[228:231], v[76:79], v[52:55]
    v_mfma_f32_16x16x32_bf16 v[60:63], a[236:239], v[76:79], v[60:63]
    s_waitcnt lgkmcnt(1)
    v_mfma_f32_16x16x32_bf16 v[48:51], a[144:147], v[64:67], v[48:51]
    ds_read_b128 v[72:75], v1 offset:9216
    v_mfma_f32_16x16x32_bf16 v[56:59], a[152:155], v[64:67], v[56:59]
    ds_read_b128 v[76:79], v1 offset:25600
    s_waitcnt lgkmcnt(2)
    v_mfma_f32_16x16x32_bf16 v[52:55], a[144:147], v[68:71], v[52:55]
    v_mfma_f32_16x16x32_bf16 v[60:63], a[152:155], v[68:71], v[60:63]
    s_waitcnt lgkmcnt(1)
    v_mfma_f32_16x16x32_bf16 v[48:51], a[176:179], v[72:75], v[48:51]
    ds_read_b128 v[64:67], v1 offset:10240
    v_mfma_f32_16x16x32_bf16 v[56:59], a[184:187], v[72:75], v[56:59]
    ds_read_b128 v[68:71], v1 offset:26624
    s_waitcnt lgkmcnt(2)
    v_mfma_f32_16x16x32_bf16 v[52:55], a[176:179], v[76:79], v[52:55]
    v_mfma_f32_16x16x32_bf16 v[60:63], a[184:187], v[76:79], v[60:63]
    s_waitcnt lgkmcnt(1)
    v_mfma_f32_16x16x32_bf16 v[48:51], a[208:211], v[64:67], v[48:51]
    ds_read_b128 v[72:75], v1 offset:11264
    v_mfma_f32_16x16x32_bf16 v[56:59], a[216:219], v[64:67], v[56:59]
    ds_read_b128 v[76:79], v1 offset:27648
    s_waitcnt lgkmcnt(2)
    v_mfma_f32_16x16x32_bf16 v[52:55], a[208:211], v[68:71], v[52:55]
    v_mfma_f32_16x16x32_bf16 v[60:63], a[216:219], v[68:71], v[60:63]
    s_waitcnt lgkmcnt(1)
    v_mfma_f32_16x16x32_bf16 v[48:51], a[240:243], v[72:75], v[48:51]
    ds_read_b128 v[64:67], v1 offset:12288
    v_mfma_f32_16x16x32_bf16 v[56:59], a[248:251], v[72:75], v[56:59]
    ds_read_b128 v[68:71], v1 offset:28672
    s_waitcnt lgkmcnt(2)
    v_mfma_f32_16x16x32_bf16 v[52:55], a[240:243], v[76:79], v[52:55]
    v_mfma_f32_16x16x32_bf16 v[60:63], a[248:251], v[76:79], v[60:63]
    s_waitcnt lgkmcnt(1)
    v_mfma_f32_16x16x32_bf16 v[48:51], a[148:151], v[64:67], v[48:51]
    ds_read_b128 v[72:75], v1 offset:13312
    v_mfma_f32_16x16x32_bf16 v[56:59], a[156:159], v[64:67], v[56:59]
    ds_read_b128 v[76:79], v1 offset:29696
    s_waitcnt lgkmcnt(2)
    v_mfma_f32_16x16x32_bf16 v[52:55], a[148:151], v[68:71], v[52:55]
    v_mfma_f32_16x16x32_bf16 v[60:63], a[156:159], v[68:71], v[60:63]
    s_waitcnt lgkmcnt(1)
    v_mfma_f32_16x16x32_bf16 v[48:51], a[180:183], v[72:75], v[48:51]
    ds_read_b128 v[64:67], v1 offset:14336
    v_mfma_f32_16x16x32_bf16 v[56:59], a[188:191], v[72:75], v[56:59]
    ds_read_b128 v[68:71], v1 offset:30720
    s_waitcnt lgkmcnt(2)
    v_mfma_f32_16x16x32_bf16 v[52:55], a[180:183], v[76:79], v[52:55]
    v_mfma_f32_16x16x32_bf16 v[60:63], a[188:191], v[76:79], v[60:63]
    s_waitcnt lgkmcnt(1)
    v_mfma_f32_16x16x32_bf16 v[48:51], a[212:215], v[64:67], v[48:51]
    ds_read_b128 v[72:75], v1 offset:15360
    v_mfma_f32_16x16x32_bf16 v[56:59], a[220:223], v[64:67], v[56:59]
    ds_read_b128 v[76:79], v1 offset:31744
    s_waitcnt lgkmcnt(2)
    v_mfma_f32_16x16x32_bf16 v[52:55], a[212:215], v[68:71], v[52:55]
    v_mfma_f32_16x16x32_bf16 v[60:63], a[220:223], v[68:71], v[60:63]
    s_waitcnt lgkmcnt(1)
    v_mfma_f32_16x16x32_bf16 v[48:51], a[244:247], v[72:75], v[48:51]
    v_mfma_f32_16x16x32_bf16 v[56:59], a[252:255], v[72:75], v[56:59]
    s_waitcnt lgkmcnt(0)
    v_mfma_f32_16x16x32_bf16 v[52:55], a[244:247], v[76:79], v[52:55]
    v_mfma_f32_16x16x32_bf16 v[60:63], a[252:255], v[76:79], v[60:63]
    v_xor_b32 v1, 0x8000, v1
    s_waitcnt vmcnt(0)
    s_barrier
    s_cmp_eq_u32 s3, 0
    s_cselect_b32 s65, s50, 0x40000000
    buffer_store_dword v97, off, s[4:7], s65 sc1
    v_mul_f32 v48, s55, v48
    v_mul_f32 v49, s55, v49
    v_mul_f32 v50, s55, v50
    v_mul_f32 v51, s55, v51
    v_mul_f32 v56, s55, v56
    v_mul_f32 v57, s55, v57
    v_mul_f32 v58, s55, v58
    v_mul_f32 v59, s55, v59
    v_cvt_pk_bf16_f32 v80, v48, v56
    v_cvt_pk_bf16_f32 v81, v49, v57
    v_cvt_pk_bf16_f32 v82, v50, v58
    v_cvt_pk_bf16_f32 v83, v51, v59
    v_mul_f32 v52, s55, v52
    v_mul_f32 v53, s55, v53
    v_mul_f32 v54, s55, v54
    v_mul_f32 v55, s55, v55
    v_mul_f32 v60, s55, v60
    v_mul_f32 v61, s55, v61
    v_mul_f32 v62, s55, v62
    v_mul_f32 v63, s55, v63
    v_cvt_pk_bf16_f32 v84, v52, v60
    v_cvt_pk_bf16_f32 v85, v53, v61
    v_cvt_pk_bf16_f32 v86, v54, v62
    v_cvt_pk_bf16_f32 v87, v55, v63
    ds_write_b128 v11, v[80:83] offset:0
    ds_write_b128 v11, v[84:87] offset:4096
    v_add_u32 v2, s57, v2
    v_add_u32 v11, s57, v11
    v_add_u32 v4, s57, v4
    s_waitcnt lgkmcnt(0)
A_nf1:
    s_cmp_eq_u32 s46, 0
    s_cbranch_scc1 A_next
A_att:
    ds_read_b128 v[16:19], v3 offset:0
    ds_read_b128 v[32:35], v3 offset:4096
    ds_read_b128 v[68:71], v5 offset:0
    ds_read_b128 v[72:75], v5 offset:128
    ds_read_b128 v[20:23], v3 offset:1024
    ds_read_b128 v[36:39], v3 offset:5120
    ds_read_b128 v[76:79], v5 offset:512
    ds_read_b128 v[80:83], v5 offset:640
    ds_read_b128 v[24:27], v3 offset:2048
    ds_read_b128 v[40:43], v3 offset:6144
    ds_read_b128 v[84:87], v5 offset:1024
    ds_read_b128 v[88:91], v5 offset:1152
    ds_read_b128 v[28:31], v3 offset:3072
    ds_read_b128 v[44:47], v3 offset:7168
    ds_read_b128 v[92:95], v5 offset:1536
    ds_read_b128 v[96:99], v5 offset:1664
    s_lshl_b32 s65, s3, 10
    v_add_u32 v124, s65, v3
    v_mov_b64 v[100:101], 0
    v_mov_b64 v[102:103], 0
    v_mov_b64 v[104:105], 0
    v_mov_b64 v[106:107], 0
    v_mov_b64 v[108:109], 0
    v_mov_b64 v[110:111], 0
    v_mov_b64 v[112:113], 0
    v_mov_b64 v[114:115], 0
    v_mov_b64 v[116:117], 0
    v_mov_b64 v[118:119], 0
    v_mov_b64 v[120:121], 0
    v_mov_b64 v[122:123], 0
    s_waitcnt lgkmcnt(13)
    v_mfma_f32_16x16x32_bf16 v[48:51], v[68:71], v[16:19], 0
    v_mfma_f32_16x16x32_bf16 v[52:55], v[68:71], v[32:35], 0
    s_waitcnt lgkmcnt(12)
    v_mfma_f32_16x16x32_bf16 v[56:59], v[72:75], v[32:35], 0
    s_waitcnt lgkmcnt(9)
    v_mfma_f32_16x16x32_bf16 v[48:51], v[76:79], v[20:23], v[48:51]
    v_mfma_f32_16x16x32_bf16 v[52:55], v[76:79], v[36:39], v[52:55]
    s_waitcnt lgkmcnt(8)
    v_mfma_f32_16x16x32_bf16 v[56:59], v[80:83], v[36:39], v[56:59]
    s_waitcnt lgkmcnt(5)
    v_mfma_f32_16x16x32_bf16 v[48:51], v[84:87], v[24:27], v[48:51]
    v_mfma_f32_16x16x32_bf16 v[52:55], v[84:87], v[40:43], v[52:55]
    s_waitcnt lgkmcnt(4)
    v_mfma_f32_16x16x32_bf16 v[56:59], v[88:91], v[40:43], v[56:59]
    s_waitcnt lgkmcnt(1)
    v_mfma_f32_16x16x32_bf16 v[48:51], v[92:95], v[28:31], v[48:51]
    v_mfma_f32_16x16x32_bf16 v[52:55], v[92:95], v[44:47], v[52:55]
    s_waitcnt lgkmcnt(0)
    v_mfma_f32_16x16x32_bf16 v[56:59], v[96:99], v[44:47], v[56:59]
    ds_read_b128 v[60:63], v124 offset:16896
    ds_read_b128 v[64:67], v124 offset:20992
    s_lshl_b32 s65, s3, 11
    v_add_u32 v125, s65, v10
    v_subrev_u32 v3, s57, v3
    v_subrev_u32 v5, s57, v5
    s_nop 4
    v_cndmask_b32 v48, v9, v48, s[70:71]
    v_cndmask_b32 v49, v9, v49, s[72:73]
    v_cndmask_b32 v50, v9, v50, s[74:75]
    v_cndmask_b32 v51, v9, v51, s[76:77]
    v_cndmask_b32 v56, v9, v56, s[70:71]
    v_cndmask_b32 v57, v9, v57, s[72:73]
    v_cndmask_b32 v58, v9, v58, s[74:75]
    v_cndmask_b32 v59, v9, v59, s[76:77]
    s_waitcnt lgkmcnt(0)
A_poll:
    buffer_load_dwordx4 v[68:71], v0, s[4:7], s52 offen offset:0 sc1
    buffer_load_dwordx4 v[72:75], v0, s[4:7], s52 offen offset:1024 sc1
    s_sub_u32 s69, s69, 1
    s_cbranch_scc1 L_exit
    s_waitcnt vmcnt(0)
    v_max3_u32 v124, v68, v69, v70
    v_max3_u32 v126, v71, v72, v73
    v_max3_u32 v124, v124, v74, v75
    v_max_u32 v124, v124, v126
    v_cmp_le_u32 vcc, s56, v124
    s_cbranch_vccz A_got
    s_sleep 2
    s_cmp_eq_u32 s46, 16
    s_cbranch_scc1 A_poll
    s_sleep 3
    s_branch A_poll
A_got:
    ds_write_b128 v125, v[68:71] offset:0
    ds_write_b128 v125, v[72:75] offset:1024
    s_add_u32 s52, s52, 65536
    s_waitcnt lgkmcnt(0)
    s_barrier
    ds_read_b128 v[68:71], v10 offset:0
    ds_read_b128 v[72:75], v10 offset:1024
    ds_read_b128 v[76:79], v10 offset:2048
    ds_read_b128 v[80:83], v10 offset:3072
    ds_read_b128 v[84:87], v10 offset:4096
    ds_read_b128 v[88:91], v10 offset:5120
    ds_read_b128 v[92:95], v10 offset:6144
    ds_read_b128 v[96:99], v10 offset:7168
    s_waitcnt lgkmcnt(7)
    v_smfmac_f32_16x16x64_bf16 v[100:103], v[68:71], v[128:135], v8
    v_smfmac_f32_16x16x64_bf16 v[104:107], v[68:71], v[136:143], v8
    s_waitcnt lgkmcnt(6)
    v_smfmac_f32_16x16x64_bf16 v[100:103], v[72:75], v[144:151], v8
    v_smfmac_f32_16x16x64_bf16 v[104:107], v[72:75], v[152:159], v8
    s_waitcnt lgkmcnt(5)
    v_smfmac_f32_16x16x64_bf16 v[100:103], v[76:79], v[160:167], v8
    v_smfmac_f32_16x16x64_bf16 v[104:107], v[76:79], v[168:175], v8
    s_waitcnt lgkmcnt(4)
    v_smfmac_f32_16x16x64_bf16 v[100:103], v[80:83], v[176:183], v8
    v_smfmac_f32_16x16x64_bf16 v[104:107], v[80:83], v[184:191], v8
    s_waitcnt lgkmcnt(3)
    v_smfmac_f32_16x16x64_bf16 v[100:103], v[84:87], v[192:199], v8
    v_smfmac_f32_16x16x64_bf16 v[104:107], v[84:87], v[200:207], v8
    s_waitcnt lgkmcnt(2)
    v_smfmac_f32_16x16x64_bf16 v[100:103], v[88:91], v[208:215], v8
    v_smfmac_f32_16x16x64_bf16 v[104:107], v[88:91], v[216:223], v8
    s_waitcnt lgkmcnt(1)
    v_smfmac_f32_16x16x64_bf16 v[100:103], v[92:95], v[224:231], v8
    v_smfmac_f32_16x16x64_bf16 v[104:107], v[92:95], v[232:239], v8
    s_waitcnt lgkmcnt(0)
    v_smfmac_f32_16x16x64_bf16 v[100:103], v[96:99], v[240:247], v8
    v_smfmac_f32_16x16x64_bf16 v[104:107], v[96:99], v[248:255], v8
    v_smfmac_f32_16x16x64_bf16 v[108:111], v[68:71], a[0:7], v8
    v_smfmac_f32_16x16x64_bf16 v[112:115], v[68:71], a[8:15], v8
    v_add_f32 v100, v100, v101
    v_add_f32 v102, v102, v103
    v_smfmac_f32_16x16x64_bf16 v[108:111], v[72:75], a[16:23], v8
    v_add_f32 v104, v104, v105
    v_add_f32 v106, v106, v107
    v_smfmac_f32_16x16x64_bf16 v[112:115], v[72:75], a[24:31], v8
    v_cvt_pk_bf16_f32 v100, v100, v104
    v_cvt_pk_bf16_f32 v101, v102, v106
    v_smfmac_f32_16x16x64_bf16 v[108:111], v[76:79], a[32:39], v8
    ds_write2_b32 v6, v100, v101 offset0:0 offset1:80
    v_smfmac_f32_16x16x64_bf16 v[112:115], v[76:79], a[40:47], v8
    v_max3_f32 v124, v48, v49, v50
    v_smfmac_f32_16x16x64_bf16 v[108:111], v[80:83], a[48:55], v8
    v_max_f32 v124, v124, v51
    v_smfmac_f32_16x16x64_bf16 v[112:115], v[80:83], a[56:63], v8
    v_max3_f32 v125, v52, v53, v54
    v_smfmac_f32_16x16x64_bf16 v[108:111], v[84:87], a[64:71], v8
    v_max3_f32 v125, v125, v55, v56
    v_smfmac_f32_16x16x64_bf16 v[112:115], v[84:87], a[72:79], v8
    v_max3_f32 v125, v125, v57, v58
    v_smfmac_f32_16x16x64_bf16 v[108:111], v[88:91], a[80:87], v8
    s_waitcnt lgkmcnt(0)
    s_barrier
    ds_read_b128 v[100:103], v7
    ds_read_b128 v[104:107], v7 offset:128
    v_smfmac_f32_16x16x64_bf16 v[112:115], v[88:91], a[88:95], v8
    v_max_f32 v125, v125, v59
    v_smfmac_f32_16x16x64_bf16 v[108:111], v[92:95], a[96:103], v8
    v_smfmac_f32_16x16x64_bf16 v[112:115], v[92:95], a[104:111], v8
    v_smfmac_f32_16x16x64_bf16 v[108:111], v[96:99], a[112:119], v8
    v_smfmac_f32_16x16x64_bf16 v[112:115], v[96:99], a[120:127], v8
    s_waitcnt lgkmcnt(1)
    v_smfmac_f32_16x16x64_bf16 v[116:119], v[100:103], v[16:23], v8
    s_waitcnt lgkmcnt(0)
    v_smfmac_f32_16x16x64_bf16 v[116:119], v[104:107], v[24:31], v8
    v_smfmac_f32_16x16x64_bf16 v[120:123], v[100:103], v[32:39], v8
    v_smfmac_f32_16x16x64_bf16 v[120:123], v[104:107], v[40:47], v8
    v_cvt_pk_bf16_f32 v108, v108, v110
    v_cvt_pk_bf16_f32 v109, v109, v111
    v_cvt_pk_bf16_f32 v112, v112, v114
    v_cvt_pk_bf16_f32 v113, v113, v115
    v_mov_b64 v[70:71], 0
    v_mov_b32 v79, 0
    v_mov_b32 v83, 0
    v_add_f32 v116, v116, v117
    v_add_f32 v117, v118, v119
    v_max3_f32 v124, v124, v116, v117
    v_add_f32 v120, v120, v121
    v_add_f32 v121, v122, v123
    v_max3_f32 v125, v125, v120, v121
    v_mov_b32 v126, v124
    v_mov_b32 v127, v125
    s_nop 0
    v_permlane32_swap_b32 v124, v126
    v_permlane32_swap_b32 v125, v127
    v_max_f32 v124, v124, v126
    v_max_f32 v125, v125, v127
    v_mov_b32 v126, v124
    v_mov_b32 v127, v125
    s_nop 0
    v_permlane16_swap_b32 v124, v126
    v_permlane16_swap_b32 v125, v127
    v_max_f32 v124, v124, v126
    v_max_f32 v125, v125, v127
    v_sub_f32 v48, v48, v124
    v_sub_f32 v49, v49, v124
    v_sub_f32 v50, v50, v124
    v_sub_f32 v51, v51, v124
    v_sub_f32 v116, v116, v124
    v_sub_f32 v117, v117, v124
    v_exp_f32 v48, v48
    v_exp_f32 v49, v49
    v_exp_f32 v50, v50
    v_exp_f32 v51, v51
    v_exp_f32 v116, v116
    v_exp_f32 v117, v117
    v_cvt_pk_bf16_f32 v68, v48, v49
    v_cvt_pk_bf16_f32 v69, v50, v51
    v_cvt_pk_bf16_f32 v76, v116, v117
    v_cvt_pk_bf16_f32 v77, v116, v117
    v_cvt_pk_bf16_f32 v78, v116, v117
    v_mfma_f32_16x16x32_bf16 v[100:103], v[12:15], v[68:71], 0
    v_mfma_f32_16x16x32_bf16 v[84:87], v[60:63], v[68:71], 0
    v_mfma_f32_16x16x32_bf16 v[88:91], v[64:67], v[68:71], 0
    v_mfma_f32_16x16x16_bf16 v[100:103], v[12:13], v[78:79], v[100:103]
    v_mfma_f32_16x16x16_bf16 v[84:87], v[108:109], v[76:77], v[84:87]
    v_mfma_f32_16x16x16_bf16 v[88:91], v[112:113], v[76:77], v[88:91]
    v_sub_f32 v52, v52, v125
    v_sub_f32 v53, v53, v125
    v_sub_f32 v54, v54, v125
    v_sub_f32 v55, v55, v125
    v_sub_f32 v56, v56, v125
    v_sub_f32 v57, v57, v125
    v_sub_f32 v58, v58, v125
    v_sub_f32 v59, v59, v125
    v_sub_f32 v120, v120, v125
    v_sub_f32 v121, v121, v125
    v_exp_f32 v52, v52
    v_exp_f32 v53, v53
    v_exp_f32 v54, v54
    v_exp_f32 v55, v55
    v_exp_f32 v56, v56
    v_exp_f32 v57, v57
    v_exp_f32 v58, v58
    v_exp_f32 v59, v59
    v_exp_f32 v120, v120
    v_exp_f32 v121, v121
    v_cvt_pk_bf16_f32 v72, v52, v53
    v_cvt_pk_bf16_f32 v73, v54, v55
    v_cvt_pk_bf16_f32 v74, v56, v57
    v_cvt_pk_bf16_f32 v75, v58, v59
    v_cvt_pk_bf16_f32 v80, v120, v121
    v_cvt_pk_bf16_f32 v81, v120, v121
    v_cvt_pk_bf16_f32 v82, v120, v121
    v_mfma_f32_16x16x32_bf16 v[104:107], v[12:15], v[72:75], 0
    v_mfma_f32_16x16x32_bf16 v[92:95], v[60:63], v[72:75], 0
    v_mfma_f32_16x16x32_bf16 v[96:99], v[64:67], v[72:75], 0
    v_mfma_f32_16x16x16_bf16 v[104:107], v[12:13], v[82:83], v[104:107]
    v_mfma_f32_16x16x16_bf16 v[92:95], v[108:109], v[80:81], v[92:95]
    v_mfma_f32_16x16x16_bf16 v[96:99], v[112:113], v[80:81], v[96:99]
    s_lshl2_add_u32 s65, s46, s45
    s_lshl_b32 s66, s3, 8
    s_sub_i32 s65, s65, s66
    s_cmp_ge_i32 s65, 65
    s_cselect_b32 s65, s51, 0x40000000
    v_mov_b32 v127, s46
    buffer_store_dword v127, off, s[4:7], s65 sc1
    v_rcp_f32 v126, v100
    s_nop 0
    v_mul_f32 v84, v84, v126
    v_mul_f32 v85, v85, v126
    v_mul_f32 v86, v86, v126
    v_mul_f32 v87, v87, v126
    v_mul_f32 v88, v88, v126
    v_mul_f32 v89, v89, v126
    v_mul_f32 v90, v90, v126
    v_mul_f32 v91, v91, v126
    v_cvt_pk_bf16_f32 v16, v84, v85
    v_cvt_pk_bf16_f32 v17, v86, v87
    v_cvt_pk_bf16_f32 v18, v88, v89
    v_cvt_pk_bf16_f32 v19, v90, v91
    buffer_store_dwordx4 v[16:19], v0, s[4:7], s53 offen sc1
    v_rcp_f32 v127, v104
    s_nop 0
    v_mul_f32 v92, v92, v127
    v_mul_f32 v93, v93, v127
    v_mul_f32 v94, v94, v127
    v_mul_f32 v95, v95, v127
    v_mul_f32 v96, v96, v127
    v_mul_f32 v97, v97, v127
    v_mul_f32 v98, v98, v127
    v_mul_f32 v99, v99, v127
    v_cvt_pk_bf16_f32 v32, v92, v93
    v_cvt_pk_bf16_f32 v33, v94, v95
    v_cvt_pk_bf16_f32 v34, v96, v97
    v_cvt_pk_bf16_f32 v35, v98, v99
    s_add_u32 s53, s53, 0x20000
    buffer_store_dwordx4 v[32:35], v0, s[4:7], s53 offen sc1
    s_add_u32 s53, s53, 917504
    v_mov_b32 v124, s46
    s_lshl2_add_u32 s65, s46, s45
    s_cmp_ge_u32 s65, 65
    s_cbranch_scc1 A_noack
    s_waitcnt vmcnt(0)
A_noack:
    s_barrier
    s_cmp_lg_u32 s3, 0
    s_cbranch_scc1 A_next
    buffer_store_dword v124, off, s[4:7], s51 sc1
A_next:
    s_sub_u32 s57, 0, s57
    s_add_u32 s46, s46, 1
    s_cmp_le_u32 s46, 16
    s_cbranch_scc1 A_loop
    s_endpgm
A_first:
    s_waitcnt vmcnt(0) lgkmcnt(0)
    s_barrier
    s_cmp_eq_u32 s3, 0
    s_cselect_b32 s65, s50, 0x40000000
    buffer_store_dword v97, off, s[4:7], s65 sc1
    s_add_u32 s65, s58, 0x0
    s_add_u32 m0, s54, 0
    s_nop 0
    buffer_load_dwordx4 v104, s[88:91], s65 offen lds
    s_add_u32 s65, s58, 0x4000
    s_add_u32 m0, s54, 4096
    s_nop 0
    buffer_load_dwordx4 v104, s[88:91], s65 offen lds
    s_add_u32 s65, s58, 0x40000
    s_add_u32 m0, s54, 8192
    s_nop 0
    buffer_load_dwordx4 v104, s[88:91], s65 offen lds
    s_add_u32 s65, s58, 0x44000
    s_add_u32 m0, s54, 12288
    s_nop 0
    buffer_load_dwordx4 v104, s[88:91], s65 offen lds
    s_add_u32 s65, s58, 0x80000
    s_add_u32 m0, s54, 16384
    s_nop 0
    buffer_load_dwordx4 v104, s[88:91], s65 offen lds
    s_add_u32 s65, s58, 0x84000
    s_add_u32 m0, s54, 20480
    s_nop 0
    buffer_load_dwordx4 v104, s[88:91], s65 offen lds
    s_add_u32 s65, s58, 0xc0000
    s_add_u32 m0, s54, 24576
    s_nop 0
    buffer_load_dwordx4 v104, s[88:91], s65 offen lds
    s_add_u32 s65, s58, 0xc4000
    s_add_u32 m0, s54, 28672
    s_nop 0
    buffer_load_dwordx4 v104, s[88:91], s65 offen lds
    s_add_u32 s65, s58, 0x100000
    s_add_u32 m0, s54, 32768
    s_nop 0
    buffer_load_dwordx4 v104, s[88:91], s65 offen lds
    s_add_u32 s65, s58, 0x104000
    s_add_u32 m0, s54, 36864
    s_nop 0
    buffer_load_dwordx4 v104, s[88:91], s65 offen lds
    s_add_u32 s65, s58, 0x140000
    s_add_u32 m0, s54, 40960
    s_nop 0
    buffer_load_dwordx4 v104, s[88:91], s65 offen lds
    s_add_u32 s65, s58, 0x144000
    s_add_u32 m0, s54, 45056
    s_nop 0
    buffer_load_dwordx4 v104, s[88:91], s65 offen lds
    s_add_u32 s65, s58, 0x180000
    s_add_u32 m0, s54, 49152
    s_nop 0
    buffer_load_dwordx4 v104, s[88:91], s65 offen lds
    s_add_u32 s65, s58, 0x184000
    s_add_u32 m0, s54, 53248
    s_nop 0
    buffer_load_dwordx4 v104, s[88:91], s65 offen lds
    s_waitcnt vmcnt(12)
    s_barrier
    s_add_u32 s65, s58, 0x1c0000
    s_add_u32 m0, s54, 57344
    s_nop 0
    buffer_load_dwordx4 v104, s[88:91], s65 offen lds
    s_add_u32 s65, s58, 0x1c4000
    s_add_u32 m0, s54, 61440
    s_nop 0
    buffer_load_dwordx4 v104, s[88:91], s65 offen lds
    ds_read_b64_tr_b16 a[128:129], v105 offset:0
    ds_read_b64_tr_b16 a[130:131], v105 offset:4096
    ds_read_b64_tr_b16 a[136:137], v106 offset:0
    ds_read_b64_tr_b16 a[138:139], v106 offset:4096
    s_waitcnt vmcnt(12)
    s_waitcnt lgkmcnt(0)
    s_barrier
    s_add_u32 s65, s58, 0x200000
    s_add_u32 m0, s54, 0
    s_nop 0
    buffer_load_dwordx4 v104, s[88:91], s65 offen lds
    s_add_u32 s65, s58, 0x204000
    s_add_u32 m0, s54, 4096
    s_nop 0
    buffer_load_dwordx4 v104, s[88:91], s65 offen lds
    ds_read_b64_tr_b16 a[160:161], v105 offset:8192
    ds_read_b64_tr_b16 a[162:163], v105 offset:12288
    ds_read_b64_tr_b16 a[168:169], v106 offset:8192
    ds_read_b64_tr_b16 a[170:171], v106 offset:12288
    s_waitcnt vmcnt(12)
    s_waitcnt lgkmcnt(0)
    s_barrier
    s_add_u32 s65, s58, 0x240000
    s_add_u32 m0, s54, 8192
    s_nop 0
    buffer_load_dwordx4 v104, s[88:91], s65 offen lds
    s_add_u32 s65, s58, 0x244000
    s_add_u32 m0, s54, 12288
    s_nop 0
    buffer_load_dwordx4 v104, s[88:91], s65 offen lds
    ds_read_b64_tr_b16 a[192:193], v105 offset:16384
    ds_read_b64_tr_b16 a[194:195], v105 offset:20480
    ds_read_b64_tr_b16 a[200:201], v106 offset:16384
    ds_read_b64_tr_b16 a[202:203], v106 offset:20480
    s_waitcnt vmcnt(12)
    s_waitcnt lgkmcnt(0)
    s_barrier
    s_add_u32 s65, s58, 0x280000
    s_add_u32 m0, s54, 16384
    s_nop 0
    buffer_load_dwordx4 v104, s[88:91], s65 offen lds
    s_add_u32 s65, s58, 0x284000
    s_add_u32 m0, s54, 20480
    s_nop 0
    buffer_load_dwordx4 v104, s[88:91], s65 offen lds
    ds_read_b64_tr_b16 a[224:225], v105 offset:24576
    ds_read_b64_tr_b16 a[226:227], v105 offset:28672
    ds_read_b64_tr_b16 a[232:233], v106 offset:24576
    ds_read_b64_tr_b16 a[234:235], v106 offset:28672
    s_waitcnt vmcnt(12)
    s_waitcnt lgkmcnt(0)
    s_barrier
    s_add_u32 s65, s58, 0x2c0000
    s_add_u32 m0, s54, 24576
    s_nop 0
    buffer_load_dwordx4 v104, s[88:91], s65 offen lds
    s_add_u32 s65, s58, 0x2c4000
    s_add_u32 m0, s54, 28672
    s_nop 0
    buffer_load_dwordx4 v104, s[88:91], s65 offen lds
    ds_read_b64_tr_b16 a[132:133], v105 offset:32768
    ds_read_b64_tr_b16 a[134:135], v105 offset:36864
    ds_read_b64_tr_b16 a[140:141], v106 offset:32768
    ds_read_b64_tr_b16 a[142:143], v106 offset:36864
    s_waitcnt vmcnt(12)
    s_waitcnt lgkmcnt(0)
    s_barrier
    s_add_u32 s65, s58, 0x300000
    s_add_u32 m0, s54, 32768
    s_nop 0
    buffer_load_dwordx4 v104, s[88:91], s65 offen lds
    s_add_u32 s65, s58, 0x304000
    s_add_u32 m0, s54, 36864
    s_nop 0
    buffer_load_dwordx4 v104, s[88:91], s65 offen lds
    ds_read_b64_tr_b16 a[164:165], v105 offset:40960
    ds_read_b64_tr_b16 a[166:167], v105 offset:45056
    ds_read_b64_tr_b16 a[172:173], v106 offset:40960
    ds_read_b64_tr_b16 a[174:175], v106 offset:45056
    s_waitcnt vmcnt(12)
    s_waitcnt lgkmcnt(0)
    s_barrier
    s_add_u32 s65, s58, 0x340000
    s_add_u32 m0, s54, 40960
    s_nop 0
    buffer_load_dwordx4 v104, s[88:91], s65 offen lds
    s_add_u32 s65, s58, 0x344000
    s_add_u32 m0, s54, 45056
    s_nop 0
    buffer_load_dwordx4 v104, s[88:91], s65 offen lds
    ds_read_b64_tr_b16 a[196:197], v105 offset:49152
    ds_read_b64_tr_b16 a[198:199], v105 offset:53248
    ds_read_b64_tr_b16 a[204:205], v106 offset:49152
    ds_read_b64_tr_b16 a[206:207], v106 offset:53248
    s_waitcnt vmcnt(12)
    s_waitcnt lgkmcnt(0)
    s_barrier
    s_add_u32 s65, s58, 0x380000
    s_add_u32 m0, s54, 49152
    s_nop 0
    buffer_load_dwordx4 v104, s[88:91], s65 offen lds
    s_add_u32 s65, s58, 0x384000
    s_add_u32 m0, s54, 53248
    s_nop 0
    buffer_load_dwordx4 v104, s[88:91], s65 offen lds
    ds_read_b64_tr_b16 a[228:229], v105 offset:57344
    ds_read_b64_tr_b16 a[230:231], v105 offset:61440
    ds_read_b64_tr_b16 a[236:237], v106 offset:57344
    ds_read_b64_tr_b16 a[238:239], v106 offset:61440
    s_waitcnt vmcnt(12)
    s_waitcnt lgkmcnt(0)
    s_barrier
    s_add_u32 s65, s58, 0x3c0000
    s_add_u32 m0, s54, 57344
    s_nop 0
    buffer_load_dwordx4 v104, s[88:91], s65 offen lds
    s_add_u32 s65, s58, 0x3c4000
    s_add_u32 m0, s54, 61440
    s_nop 0
    buffer_load_dwordx4 v104, s[88:91], s65 offen lds
    ds_read_b64_tr_b16 a[144:145], v105 offset:0
    ds_read_b64_tr_b16 a[146:147], v105 offset:4096
    ds_read_b64_tr_b16 a[152:153], v106 offset:0
    ds_read_b64_tr_b16 a[154:155], v106 offset:4096
    s_waitcnt vmcnt(12)
    s_waitcnt lgkmcnt(0)
    s_barrier
    ds_read_b64_tr_b16 a[176:177], v105 offset:8192
    ds_read_b64_tr_b16 a[178:179], v105 offset:12288
    ds_read_b64_tr_b16 a[184:185], v106 offset:8192
    ds_read_b64_tr_b16 a[186:187], v106 offset:12288
    s_waitcnt vmcnt(10)
    s_waitcnt lgkmcnt(0)
    s_barrier
    ds_read_b64_tr_b16 a[208:209], v105 offset:16384
    ds_read_b64_tr_b16 a[210:211], v105 offset:20480
    ds_read_b64_tr_b16 a[216:217], v106 offset:16384
    ds_read_b64_tr_b16 a[218:219], v106 offset:20480
    s_waitcnt vmcnt(8)
    s_waitcnt lgkmcnt(0)
    s_barrier
    ds_read_b64_tr_b16 a[240:241], v105 offset:24576
    ds_read_b64_tr_b16 a[242:243], v105 offset:28672
    ds_read_b64_tr_b16 a[248:249], v106 offset:24576
    ds_read_b64_tr_b16 a[250:251], v106 offset:28672
    s_waitcnt vmcnt(6)
    s_waitcnt lgkmcnt(0)
    s_barrier
    ds_read_b64_tr_b16 a[148:149], v105 offset:32768
    ds_read_b64_tr_b16 a[150:151], v105 offset:36864
    ds_read_b64_tr_b16 a[156:157], v106 offset:32768
    ds_read_b64_tr_b16 a[158:159], v106 offset:36864
    s_waitcnt vmcnt(4)
    s_waitcnt lgkmcnt(0)
    s_barrier
    ds_read_b64_tr_b16 a[180:181], v105 offset:40960
    ds_read_b64_tr_b16 a[182:183], v105 offset:45056
    ds_read_b64_tr_b16 a[188:189], v106 offset:40960
    ds_read_b64_tr_b16 a[190:191], v106 offset:45056
    s_waitcnt vmcnt(2)
    s_waitcnt lgkmcnt(0)
    s_barrier
    ds_read_b64_tr_b16 a[212:213], v105 offset:49152
    ds_read_b64_tr_b16 a[214:215], v105 offset:53248
    ds_read_b64_tr_b16 a[220:221], v106 offset:49152
    ds_read_b64_tr_b16 a[222:223], v106 offset:53248
    s_waitcnt vmcnt(0)
    s_waitcnt lgkmcnt(0)
    s_barrier
    ds_read_b64_tr_b16 a[244:245], v105 offset:57344
    ds_read_b64_tr_b16 a[246:247], v105 offset:61440
    ds_read_b64_tr_b16 a[252:253], v106 offset:57344
    ds_read_b64_tr_b16 a[254:255], v106 offset:61440
    s_waitcnt vmcnt(0) lgkmcnt(0)
    s_branch A_q
L_out:
    s_sub_u32 s65, s44, 5
    s_lshl_b32 s65, s65, 5
    s_lshr_b32 s66, s2, 3
    s_add_u32 s44, s65, s66
    s_mov_b32 s69, 262144
    v_and_b32 v2, 63, v0
    v_lshrrev_b32 v3, 4, v2
    v_and_b32 v4, 15, v2
    v_lshlrev_b32 v0, 4, v2
    s_lshl_b32 s45, s3, 10
    s_add_u32 s45, s45, 65536
    s_mov_b32 s8, s16
    s_mov_b32 s9, s17
    s_mov_b32 s10, 0x200000
    s_mov_b32 s11, 0x20000
    s_sub_u32 s59, s44, 32
    s_cbranch_scc1 O_noln
    v_lshrrev_b32 v18, 3, v2
    v_and_b32 v17, 7, v2
    v_lshrrev_b32 v14, 2, v17
    v_lshlrev_b32 v15, 10, v18
    v_lshl_add_u32 v15, v14, 6, v15
    v_and_b32 v16, 3, v17
    v_lshl_add_u32 v15, v16, 3, v15
    s_lshl_b32 s65, s59, 15
    s_lshl_b32 s66, s3, 13
    s_add_u32 s65, s65, s66
    buffer_load_dwordx2 v[24:25], v15, s[8:11], s65 offen offset:0
    buffer_load_dwordx2 v[26:27], v15, s[8:11], s65 offen offset:32
    buffer_load_dwordx2 v[28:29], v15, s[8:11], s65 offen offset:128
    buffer_load_dwordx2 v[30:31], v15, s[8:11], s65 offen offset:160
    buffer_load_dwordx2 v[32:33], v15, s[8:11], s65 offen offset:256
    buffer_load_dwordx2 v[34:35], v15, s[8:11], s65 offen offset:288
    buffer_load_dwordx2 v[36:37], v15, s[8:11], s65 offen offset:384
    buffer_load_dwordx2 v[38:39], v15, s[8:11], s65 offen offset:416
    buffer_load_dwordx2 v[40:41], v15, s[8:11], s65 offen offset:512
    buffer_load_dwordx2 v[42:43], v15, s[8:11], s65 offen offset:544
    buffer_load_dwordx2 v[44:45], v15, s[8:11], s65 offen offset:640
    buffer_load_dwordx2 v[46:47], v15, s[8:11], s65 offen offset:672
    buffer_load_dwordx2 v[48:49], v15, s[8:11], s65 offen offset:768
    buffer_load_dwordx2 v[50:51], v15, s[8:11], s65 offen offset:800
    buffer_load_dwordx2 v[52:53], v15, s[8:11], s65 offen offset:896
    buffer_load_dwordx2 v[54:55], v15, s[8:11], s65 offen offset:928
    v_mov_b64 v[120:121], -1
    v_mov_b64 v[122:123], -1
    s_lshl_b32 s66, s59, 14
    s_lshl_b32 s67, s3, 11
    s_add_u32 s66, s66, s67
    s_add_u32 s66, s66, 0x100000
    buffer_store_dwordx4 v[120:123], v0, s[4:7], s66 offen sc1
    buffer_store_dwordx4 v[120:123], v0, s[4:7], s66 offen offset:1024 sc1
    s_mul_i32 s66, s59, 12288
    s_mul_i32 s67, s3, 3072
    s_add_u32 s66, s66, s67
    s_add_u32 s66, s66, 0x1f40000
    buffer_store_dwordx4 v[120:123], v0, s[4:7], s66 offen sc1
    buffer_store_dwordx4 v[120:123], v0, s[4:7], s66 offen offset:1024 sc1
    buffer_store_dwordx4 v[120:123], v0, s[4:7], s66 offen offset:2048 sc1
    s_lshl_b32 s66, s59, 9
    s_lshl_b32 s67, s3, 7
    s_add_u32 s66, s66, s67
    s_add_u32 s66, s66, 0xf0000
    v_mov_b64 v[124:125], 0
    v_mov_b64 v[126:127], 0
    s_mov_b64 exec, 0xff
    buffer_store_dwordx4 v[124:127], v0, s[4:7], s66 offen sc1
    s_mov_b64 exec, -1
    s_lshr_b32 s66, s3, 1
    s_lshl_b32 s66, s66, 14
    s_and_b32 s67, s3, 1
    s_lshl_b32 s67, s67, 7
    s_add_u32 s66, s66, s67
    v_lshlrev_b32 v14, 10, v14
    v_lshl_add_u32 v14, v16, 8, v14
    v_lshl_add_u32 v14, v18, 4, v14
    v_add_u32 v14, s66, v14
    s_waitcnt vmcnt(21)
    v_lshlrev_b32 v56, 16, v24
    v_and_b32 v57, 0xffff0000, v24
    v_lshlrev_b32 v58, 16, v25
    v_and_b32 v59, 0xffff0000, v25
    s_waitcnt vmcnt(20)
    v_lshlrev_b32 v60, 16, v26
    v_and_b32 v61, 0xffff0000, v26
    v_lshlrev_b32 v62, 16, v27
    v_and_b32 v63, 0xffff0000, v27
    s_waitcnt vmcnt(19)
    v_lshlrev_b32 v64, 16, v28
    v_and_b32 v65, 0xffff0000, v28
    v_lshlrev_b32 v66, 16, v29
    v_and_b32 v67, 0xffff0000, v29
    s_waitcnt vmcnt(18)
    v_lshlrev_b32 v68, 16, v30
    v_and_b32 v69, 0xffff0000, v30
    v_lshlrev_b32 v70, 16, v31
    v_and_b32 v71, 0xffff0000, v31
    s_waitcnt vmcnt(17)
    v_lshlrev_b32 v72, 16, v32
    v_and_b32 v73, 0xffff0000, v32
    v_lshlrev_b32 v74, 16, v33
    v_and_b32 v75, 0xffff0000, v33
    s_waitcnt vmcnt(16)
    v_lshlrev_b32 v76, 16, v34
    v_and_b32 v77, 0xffff0000, v34
    v_lshlrev_b32 v78, 16, v35
    v_and_b32 v79, 0xffff0000, v35
    s_waitcnt vmcnt(15)
    v_lshlrev_b32 v80, 16, v36
    v_and_b32 v81, 0xffff0000, v36
    v_lshlrev_b32 v82, 16, v37
    v_and_b32 v83, 0xffff0000, v37
    s_waitcnt vmcnt(14)
    v_lshlrev_b32 v84, 16, v38
    v_and_b32 v85, 0xffff0000, v38
    v_lshlrev_b32 v86, 16, v39
    v_and_b32 v87, 0xffff0000, v39
    s_waitcnt vmcnt(13)
    v_lshlrev_b32 v88, 16, v40
    v_and_b32 v89, 0xffff0000, v40
    v_lshlrev_b32 v90, 16, v41
    v_and_b32 v91, 0xffff0000, v41
    s_waitcnt vmcnt(12)
    v_lshlrev_b32 v92, 16, v42
    v_and_b32 v93, 0xffff0000, v42
    v_lshlrev_b32 v94, 16, v43
    v_and_b32 v95, 0xffff0000, v43
    s_waitcnt vmcnt(11)
    v_lshlrev_b32 v96, 16, v44
    v_and_b32 v97, 0xffff0000, v44
    v_lshlrev_b32 v98, 16, v45
    v_and_b32 v99, 0xffff0000, v45
    s_waitcnt vmcnt(10)
    v_lshlrev_b32 v100, 16, v46
    v_and_b32 v101, 0xffff0000, v46
    v_lshlrev_b32 v102, 16, v47
    v_and_b32 v103, 0xffff0000, v47
    s_waitcnt vmcnt(9)
    v_lshlrev_b32 v104, 16, v48
    v_and_b32 v105, 0xffff0000, v48
    v_lshlrev_b32 v106, 16, v49
    v_and_b32 v107, 0xffff0000, v49
    s_waitcnt vmcnt(8)
    v_lshlrev_b32 v108, 16, v50
    v_and_b32 v109, 0xffff0000, v50
    v_lshlrev_b32 v110, 16, v51
    v_and_b32 v111, 0xffff0000, v51
    s_waitcnt vmcnt(7)
    v_lshlrev_b32 v112, 16, v52
    v_and_b32 v113, 0xffff0000, v52
    v_lshlrev_b32 v114, 16, v53
    v_and_b32 v115, 0xffff0000, v53
    s_waitcnt vmcnt(6)
    v_lshlrev_b32 v116, 16, v54
    v_and_b32 v117, 0xffff0000, v54
    v_lshlrev_b32 v118, 16, v55
    v_and_b32 v119, 0xffff0000, v55
    v_add_f32 v19, v56, v57
    v_add_f32 v20, v58, v59
    v_add_f32 v19, v19, v60
    v_add_f32 v20, v20, v61
    v_add_f32 v19, v19, v62
    v_add_f32 v20, v20, v63
    v_add_f32 v19, v19, v64
    v_add_f32 v20, v20, v65
    v_add_f32 v19, v19, v66
    v_add_f32 v20, v20, v67
    v_add_f32 v19, v19, v68
    v_add_f32 v20, v20, v69
    v_add_f32 v19, v19, v70
    v_add_f32 v20, v20, v71
    v_add_f32 v19, v19, v72
    v_add_f32 v20, v20, v73
    v_add_f32 v19, v19, v74
    v_add_f32 v20, v20, v75
    v_add_f32 v19, v19, v76
    v_add_f32 v20, v20, v77
    v_add_f32 v19, v19, v78
    v_add_f32 v20, v20, v79
    v_add_f32 v19, v19, v80
    v_add_f32 v20, v20, v81
    v_add_f32 v19, v19, v82
    v_add_f32 v20, v20, v83
    v_add_f32 v19, v19, v84
    v_add_f32 v20, v20, v85
    v_add_f32 v19, v19, v86
    v_add_f32 v20, v20, v87
    v_add_f32 v19, v19, v88
    v_add_f32 v20, v20, v89
    v_add_f32 v19, v19, v90
    v_add_f32 v20, v20, v91
    v_add_f32 v19, v19, v92
    v_add_f32 v20, v20, v93
    v_add_f32 v19, v19, v94
    v_add_f32 v20, v20, v95
    v_add_f32 v19, v19, v96
    v_add_f32 v20, v20, v97
    v_add_f32 v19, v19, v98
    v_add_f32 v20, v20, v99
    v_add_f32 v19, v19, v100
    v_add_f32 v20, v20, v101
    v_add_f32 v19, v19, v102
    v_add_f32 v20, v20, v103
    v_add_f32 v19, v19, v104
    v_add_f32 v20, v20, v105
    v_add_f32 v19, v19, v106
    v_add_f32 v20, v20, v107
    v_add_f32 v19, v19, v108
    v_add_f32 v20, v20, v109
    v_add_f32 v19, v19, v110
    v_add_f32 v20, v20, v111
    v_add_f32 v19, v19, v112
    v_add_f32 v20, v20, v113
    v_add_f32 v19, v19, v114
    v_add_f32 v20, v20, v115
    v_add_f32 v19, v19, v116
    v_add_f32 v20, v20, v117
    v_add_f32 v19, v19, v118
    v_add_f32 v20, v20, v119
    v_add_f32 v19, v19, v20
    s_nop 1
    v_add_f32_dpp v19, v19, v19 quad_perm:[1,0,3,2] row_mask:0xf bank_mask:0xf
    s_nop 1
    v_add_f32_dpp v19, v19, v19 quad_perm:[2,3,0,1] row_mask:0xf bank_mask:0xf
    s_nop 1
    v_add_f32_dpp v19, v19, v19 row_half_mirror row_mask:0xf bank_mask:0xf
    v_mul_f32 v21, 0x3b000000, v19
    v_mov_b32 v19, 0
    v_mov_b32 v20, 0
    v_sub_f32 v15, v56, v21
    v_sub_f32 v16, v57, v21
    v_fmac_f32 v19, v15, v15
    v_fmac_f32 v20, v16, v16
    v_sub_f32 v15, v58, v21
    v_sub_f32 v16, v59, v21
    v_fmac_f32 v19, v15, v15
    v_fmac_f32 v20, v16, v16
    v_sub_f32 v15, v60, v21
    v_sub_f32 v16, v61, v21
    v_fmac_f32 v19, v15, v15
    v_fmac_f32 v20, v16, v16
    v_sub_f32 v15, v62, v21
    v_sub_f32 v16, v63, v21
    v_fmac_f32 v19, v15, v15
    v_fmac_f32 v20, v16, v16
    v_sub_f32 v15, v64, v21
    v_sub_f32 v16, v65, v21
    v_fmac_f32 v19, v15, v15
    v_fmac_f32 v20, v16, v16
    v_sub_f32 v15, v66, v21
    v_sub_f32 v16, v67, v21
    v_fmac_f32 v19, v15, v15
    v_fmac_f32 v20, v16, v16
    v_sub_f32 v15, v68, v21
    v_sub_f32 v16, v69, v21
    v_fmac_f32 v19, v15, v15
    v_fmac_f32 v20, v16, v16
    v_sub_f32 v15, v70, v21
    v_sub_f32 v16, v71, v21
    v_fmac_f32 v19, v15, v15
    v_fmac_f32 v20, v16, v16
    v_sub_f32 v15, v72, v21
    v_sub_f32 v16, v73, v21
    v_fmac_f32 v19, v15, v15
    v_fmac_f32 v20, v16, v16
    v_sub_f32 v15, v74, v21
    v_sub_f32 v16, v75, v21
    v_fmac_f32 v19, v15, v15
    v_fmac_f32 v20, v16, v16
    v_sub_f32 v15, v76, v21
    v_sub_f32 v16, v77, v21
    v_fmac_f32 v19, v15, v15
    v_fmac_f32 v20, v16, v16
    v_sub_f32 v15, v78, v21
    v_sub_f32 v16, v79, v21
    v_fmac_f32 v19, v15, v15
    v_fmac_f32 v20, v16, v16
    v_sub_f32 v15, v80, v21
    v_sub_f32 v16, v81, v21
    v_fmac_f32 v19, v15, v15
    v_fmac_f32 v20, v16, v16
    v_sub_f32 v15, v82, v21
    v_sub_f32 v16, v83, v21
    v_fmac_f32 v19, v15, v15
    v_fmac_f32 v20, v16, v16
    v_sub_f32 v15, v84, v21
    v_sub_f32 v16, v85, v21
    v_fmac_f32 v19, v15, v15
    v_fmac_f32 v20, v16, v16
    v_sub_f32 v15, v86, v21
    v_sub_f32 v16, v87, v21
    v_fmac_f32 v19, v15, v15
    v_fmac_f32 v20, v16, v16
    v_sub_f32 v15, v88, v21
    v_sub_f32 v16, v89, v21
    v_fmac_f32 v19, v15, v15
    v_fmac_f32 v20, v16, v16
    v_sub_f32 v15, v90, v21
    v_sub_f32 v16, v91, v21
    v_fmac_f32 v19, v15, v15
    v_fmac_f32 v20, v16, v16
    v_sub_f32 v15, v92, v21
    v_sub_f32 v16, v93, v21
    v_fmac_f32 v19, v15, v15
    v_fmac_f32 v20, v16, v16
    v_sub_f32 v15, v94, v21
    v_sub_f32 v16, v95, v21
    v_fmac_f32 v19, v15, v15
    v_fmac_f32 v20, v16, v16
    v_sub_f32 v15, v96, v21
    v_sub_f32 v16, v97, v21
    v_fmac_f32 v19, v15, v15
    v_fmac_f32 v20, v16, v16
    v_sub_f32 v15, v98, v21
    v_sub_f32 v16, v99, v21
    v_fmac_f32 v19, v15, v15
    v_fmac_f32 v20, v16, v16
    v_sub_f32 v15, v100, v21
    v_sub_f32 v16, v101, v21
    v_fmac_f32 v19, v15, v15
    v_fmac_f32 v20, v16, v16
    v_sub_f32 v15, v102, v21
    v_sub_f32 v16, v103, v21
    v_fmac_f32 v19, v15, v15
    v_fmac_f32 v20, v16, v16
    v_sub_f32 v15, v104, v21
    v_sub_f32 v16, v105, v21
    v_fmac_f32 v19, v15, v15
    v_fmac_f32 v20, v16, v16
    v_sub_f32 v15, v106, v21
    v_sub_f32 v16, v107, v21
    v_fmac_f32 v19, v15, v15
    v_fmac_f32 v20, v16, v16
    v_sub_f32 v15, v108, v21
    v_sub_f32 v16, v109, v21
    v_fmac_f32 v19, v15, v15
    v_fmac_f32 v20, v16, v16
    v_sub_f32 v15, v110, v21
    v_sub_f32 v16, v111, v21
    v_fmac_f32 v19, v15, v15
    v_fmac_f32 v20, v16, v16
    v_sub_f32 v15, v112, v21
    v_sub_f32 v16, v113, v21
    v_fmac_f32 v19, v15, v15
    v_fmac_f32 v20, v16, v16
    v_sub_f32 v15, v114, v21
    v_sub_f32 v16, v115, v21
    v_fmac_f32 v19, v15, v15
    v_fmac_f32 v20, v16, v16
    v_sub_f32 v15, v116, v21
    v_sub_f32 v16, v117, v21
    v_fmac_f32 v19, v15, v15
    v_fmac_f32 v20, v16, v16
    v_sub_f32 v15, v118, v21
    v_sub_f32 v16, v119, v21
    v_fmac_f32 v19, v15, v15
    v_fmac_f32 v20, v16, v16
    v_add_f32 v19, v19, v20
    s_nop 1
    v_add_f32_dpp v19, v19, v19 quad_perm:[1,0,3,2] row_mask:0xf bank_mask:0xf
    s_nop 1
    v_add_f32_dpp v19, v19, v19 quad_perm:[2,3,0,1] row_mask:0xf bank_mask:0xf
    s_nop 1
    v_add_f32_dpp v19, v19, v19 row_half_mirror row_mask:0xf bank_mask:0xf
    v_mul_f32 v23, 0x3b000000, v19
    v_cvt_pk_bf16_f32 v23, v23, v23
    v_and_b32 v23, 0xffff0000, v23
    v_add_f32 v23, 0x3727c5ac, v23
    v_cvt_pk_bf16_f32 v23, v23, v23
    v_and_b32 v23, 0xffff0000, v23
    v_sqrt_f32 v23, v23
    v_mov_b32 v22, v21
    v_cvt_pk_bf16_f32 v23, v23, v23
    v_and_b32 v23, 0xffff0000, v23
    v_cvt_pk_bf16_f32 v22, v22, v22
    v_and_b32 v22, 0xffff0000, v22
    v_rcp_f32 v23, v23
    v_sub_f32 v56, v56, v22
    v_sub_f32 v60, v60, v22
    v_cvt_pk_bf16_f32 v60, v56, v60
    v_lshlrev_b32 v56, 16, v60
    v_and_b32 v60, 0xffff0000, v60
    v_mul_f32 v56, v56, v23
    v_mul_f32 v60, v60, v23
    v_cvt_pk_bf16_f32 v24, v56, v60
    v_sub_f32 v57, v57, v22
    v_sub_f32 v61, v61, v22
    v_cvt_pk_bf16_f32 v61, v57, v61
    v_lshlrev_b32 v57, 16, v61
    v_and_b32 v61, 0xffff0000, v61
    v_mul_f32 v57, v57, v23
    v_mul_f32 v61, v61, v23
    v_cvt_pk_bf16_f32 v25, v57, v61
    v_sub_f32 v58, v58, v22
    v_sub_f32 v62, v62, v22
    v_cvt_pk_bf16_f32 v62, v58, v62
    v_lshlrev_b32 v58, 16, v62
    v_and_b32 v62, 0xffff0000, v62
    v_mul_f32 v58, v58, v23
    v_mul_f32 v62, v62, v23
    v_cvt_pk_bf16_f32 v26, v58, v62
    v_sub_f32 v59, v59, v22
    v_sub_f32 v63, v63, v22
    v_cvt_pk_bf16_f32 v63, v59, v63
    v_lshlrev_b32 v59, 16, v63
    v_and_b32 v63, 0xffff0000, v63
    v_mul_f32 v59, v59, v23
    v_mul_f32 v63, v63, v23
    v_cvt_pk_bf16_f32 v27, v59, v63
    ds_write_b128 v14, v[24:27] offset:0
    v_sub_f32 v64, v64, v22
    v_sub_f32 v68, v68, v22
    v_cvt_pk_bf16_f32 v68, v64, v68
    v_lshlrev_b32 v64, 16, v68
    v_and_b32 v68, 0xffff0000, v68
    v_mul_f32 v64, v64, v23
    v_mul_f32 v68, v68, v23
    v_cvt_pk_bf16_f32 v28, v64, v68
    v_sub_f32 v65, v65, v22
    v_sub_f32 v69, v69, v22
    v_cvt_pk_bf16_f32 v69, v65, v69
    v_lshlrev_b32 v65, 16, v69
    v_and_b32 v69, 0xffff0000, v69
    v_mul_f32 v65, v65, v23
    v_mul_f32 v69, v69, v23
    v_cvt_pk_bf16_f32 v29, v65, v69
    v_sub_f32 v66, v66, v22
    v_sub_f32 v70, v70, v22
    v_cvt_pk_bf16_f32 v70, v66, v70
    v_lshlrev_b32 v66, 16, v70
    v_and_b32 v70, 0xffff0000, v70
    v_mul_f32 v66, v66, v23
    v_mul_f32 v70, v70, v23
    v_cvt_pk_bf16_f32 v30, v66, v70
    v_sub_f32 v67, v67, v22
    v_sub_f32 v71, v71, v22
    v_cvt_pk_bf16_f32 v71, v67, v71
    v_lshlrev_b32 v67, 16, v71
    v_and_b32 v71, 0xffff0000, v71
    v_mul_f32 v67, v67, v23
    v_mul_f32 v71, v71, v23
    v_cvt_pk_bf16_f32 v31, v67, v71
    ds_write_b128 v14, v[28:31] offset:2048
    v_sub_f32 v72, v72, v22
    v_sub_f32 v76, v76, v22
    v_cvt_pk_bf16_f32 v76, v72, v76
    v_lshlrev_b32 v72, 16, v76
    v_and_b32 v76, 0xffff0000, v76
    v_mul_f32 v72, v72, v23
    v_mul_f32 v76, v76, v23
    v_cvt_pk_bf16_f32 v32, v72, v76
    v_sub_f32 v73, v73, v22
    v_sub_f32 v77, v77, v22
    v_cvt_pk_bf16_f32 v77, v73, v77
    v_lshlrev_b32 v73, 16, v77
    v_and_b32 v77, 0xffff0000, v77
    v_mul_f32 v73, v73, v23
    v_mul_f32 v77, v77, v23
    v_cvt_pk_bf16_f32 v33, v73, v77
    v_sub_f32 v74, v74, v22
    v_sub_f32 v78, v78, v22
    v_cvt_pk_bf16_f32 v78, v74, v78
    v_lshlrev_b32 v74, 16, v78
    v_and_b32 v78, 0xffff0000, v78
    v_mul_f32 v74, v74, v23
    v_mul_f32 v78, v78, v23
    v_cvt_pk_bf16_f32 v34, v74, v78
    v_sub_f32 v75, v75, v22
    v_sub_f32 v79, v79, v22
    v_cvt_pk_bf16_f32 v79, v75, v79
    v_lshlrev_b32 v75, 16, v79
    v_and_b32 v79, 0xffff0000, v79
    v_mul_f32 v75, v75, v23
    v_mul_f32 v79, v79, v23
    v_cvt_pk_bf16_f32 v35, v75, v79
    ds_write_b128 v14, v[32:35] offset:4096
    v_sub_f32 v80, v80, v22
    v_sub_f32 v84, v84, v22
    v_cvt_pk_bf16_f32 v84, v80, v84
    v_lshlrev_b32 v80, 16, v84
    v_and_b32 v84, 0xffff0000, v84
    v_mul_f32 v80, v80, v23
    v_mul_f32 v84, v84, v23
    v_cvt_pk_bf16_f32 v36, v80, v84
    v_sub_f32 v81, v81, v22
    v_sub_f32 v85, v85, v22
    v_cvt_pk_bf16_f32 v85, v81, v85
    v_lshlrev_b32 v81, 16, v85
    v_and_b32 v85, 0xffff0000, v85
    v_mul_f32 v81, v81, v23
    v_mul_f32 v85, v85, v23
    v_cvt_pk_bf16_f32 v37, v81, v85
    v_sub_f32 v82, v82, v22
    v_sub_f32 v86, v86, v22
    v_cvt_pk_bf16_f32 v86, v82, v86
    v_lshlrev_b32 v82, 16, v86
    v_and_b32 v86, 0xffff0000, v86
    v_mul_f32 v82, v82, v23
    v_mul_f32 v86, v86, v23
    v_cvt_pk_bf16_f32 v38, v82, v86
    v_sub_f32 v83, v83, v22
    v_sub_f32 v87, v87, v22
    v_cvt_pk_bf16_f32 v87, v83, v87
    v_lshlrev_b32 v83, 16, v87
    v_and_b32 v87, 0xffff0000, v87
    v_mul_f32 v83, v83, v23
    v_mul_f32 v87, v87, v23
    v_cvt_pk_bf16_f32 v39, v83, v87
    ds_write_b128 v14, v[36:39] offset:6144
    v_sub_f32 v88, v88, v22
    v_sub_f32 v92, v92, v22
    v_cvt_pk_bf16_f32 v92, v88, v92
    v_lshlrev_b32 v88, 16, v92
    v_and_b32 v92, 0xffff0000, v92
    v_mul_f32 v88, v88, v23
    v_mul_f32 v92, v92, v23
    v_cvt_pk_bf16_f32 v40, v88, v92
    v_sub_f32 v89, v89, v22
    v_sub_f32 v93, v93, v22
    v_cvt_pk_bf16_f32 v93, v89, v93
    v_lshlrev_b32 v89, 16, v93
    v_and_b32 v93, 0xffff0000, v93
    v_mul_f32 v89, v89, v23
    v_mul_f32 v93, v93, v23
    v_cvt_pk_bf16_f32 v41, v89, v93
    v_sub_f32 v90, v90, v22
    v_sub_f32 v94, v94, v22
    v_cvt_pk_bf16_f32 v94, v90, v94
    v_lshlrev_b32 v90, 16, v94
    v_and_b32 v94, 0xffff0000, v94
    v_mul_f32 v90, v90, v23
    v_mul_f32 v94, v94, v23
    v_cvt_pk_bf16_f32 v42, v90, v94
    v_sub_f32 v91, v91, v22
    v_sub_f32 v95, v95, v22
    v_cvt_pk_bf16_f32 v95, v91, v95
    v_lshlrev_b32 v91, 16, v95
    v_and_b32 v95, 0xffff0000, v95
    v_mul_f32 v91, v91, v23
    v_mul_f32 v95, v95, v23
    v_cvt_pk_bf16_f32 v43, v91, v95
    ds_write_b128 v14, v[40:43] offset:8192
    v_sub_f32 v96, v96, v22
    v_sub_f32 v100, v100, v22
    v_cvt_pk_bf16_f32 v100, v96, v100
    v_lshlrev_b32 v96, 16, v100
    v_and_b32 v100, 0xffff0000, v100
    v_mul_f32 v96, v96, v23
    v_mul_f32 v100, v100, v23
    v_cvt_pk_bf16_f32 v44, v96, v100
    v_sub_f32 v97, v97, v22
    v_sub_f32 v101, v101, v22
    v_cvt_pk_bf16_f32 v101, v97, v101
    v_lshlrev_b32 v97, 16, v101
    v_and_b32 v101, 0xffff0000, v101
    v_mul_f32 v97, v97, v23
    v_mul_f32 v101, v101, v23
    v_cvt_pk_bf16_f32 v45, v97, v101
    v_sub_f32 v98, v98, v22
    v_sub_f32 v102, v102, v22
    v_cvt_pk_bf16_f32 v102, v98, v102
    v_lshlrev_b32 v98, 16, v102
    v_and_b32 v102, 0xffff0000, v102
    v_mul_f32 v98, v98, v23
    v_mul_f32 v102, v102, v23
    v_cvt_pk_bf16_f32 v46, v98, v102
    v_sub_f32 v99, v99, v22
    v_sub_f32 v103, v103, v22
    v_cvt_pk_bf16_f32 v103, v99, v103
    v_lshlrev_b32 v99, 16, v103
    v_and_b32 v103, 0xffff0000, v103
    v_mul_f32 v99, v99, v23
    v_mul_f32 v103, v103, v23
    v_cvt_pk_bf16_f32 v47, v99, v103
    ds_write_b128 v14, v[44:47] offset:10240
    v_sub_f32 v104, v104, v22
    v_sub_f32 v108, v108, v22
    v_cvt_pk_bf16_f32 v108, v104, v108
    v_lshlrev_b32 v104, 16, v108
    v_and_b32 v108, 0xffff0000, v108
    v_mul_f32 v104, v104, v23
    v_mul_f32 v108, v108, v23
    v_cvt_pk_bf16_f32 v48, v104, v108
    v_sub_f32 v105, v105, v22
    v_sub_f32 v109, v109, v22
    v_cvt_pk_bf16_f32 v109, v105, v109
    v_lshlrev_b32 v105, 16, v109
    v_and_b32 v109, 0xffff0000, v109
    v_mul_f32 v105, v105, v23
    v_mul_f32 v109, v109, v23
    v_cvt_pk_bf16_f32 v49, v105, v109
    v_sub_f32 v106, v106, v22
    v_sub_f32 v110, v110, v22
    v_cvt_pk_bf16_f32 v110, v106, v110
    v_lshlrev_b32 v106, 16, v110
    v_and_b32 v110, 0xffff0000, v110
    v_mul_f32 v106, v106, v23
    v_mul_f32 v110, v110, v23
    v_cvt_pk_bf16_f32 v50, v106, v110
    v_sub_f32 v107, v107, v22
    v_sub_f32 v111, v111, v22
    v_cvt_pk_bf16_f32 v111, v107, v111
    v_lshlrev_b32 v107, 16, v111
    v_and_b32 v111, 0xffff0000, v111
    v_mul_f32 v107, v107, v23
    v_mul_f32 v111, v111, v23
    v_cvt_pk_bf16_f32 v51, v107, v111
    ds_write_b128 v14, v[48:51] offset:12288
    v_sub_f32 v112, v112, v22
    v_sub_f32 v116, v116, v22
    v_cvt_pk_bf16_f32 v116, v112, v116
    v_lshlrev_b32 v112, 16, v116
    v_and_b32 v116, 0xffff0000, v116
    v_mul_f32 v112, v112, v23
    v_mul_f32 v116, v116, v23
    v_cvt_pk_bf16_f32 v52, v112, v116
    v_sub_f32 v113, v113, v22
    v_sub_f32 v117, v117, v22
    v_cvt_pk_bf16_f32 v117, v113, v117
    v_lshlrev_b32 v113, 16, v117
    v_and_b32 v117, 0xffff0000, v117
    v_mul_f32 v113, v113, v23
    v_mul_f32 v117, v117, v23
    v_cvt_pk_bf16_f32 v53, v113, v117
    v_sub_f32 v114, v114, v22
    v_sub_f32 v118, v118, v22
    v_cvt_pk_bf16_f32 v118, v114, v118
    v_lshlrev_b32 v114, 16, v118
    v_and_b32 v118, 0xffff0000, v118
    v_mul_f32 v114, v114, v23
    v_mul_f32 v118, v118, v23
    v_cvt_pk_bf16_f32 v54, v114, v118
    v_sub_f32 v115, v115, v22
    v_sub_f32 v119, v119, v22
    v_cvt_pk_bf16_f32 v119, v115, v119
    v_lshlrev_b32 v115, 16, v119
    v_and_b32 v119, 0xffff0000, v119
    v_mul_f32 v115, v115, v23
    v_mul_f32 v119, v119, v23
    v_cvt_pk_bf16_f32 v55, v115, v119
    ds_write_b128 v14, v[52:55] offset:14336
    s_lshl_b32 s66, s3, 13
    v_add_u32 v15, s66, v0
    s_add_u32 s65, s65, 0x200000
    s_add_u32 s66, s65, 4096
    s_waitcnt lgkmcnt(0)
    s_barrier
    ds_read_b128 v[56:59], v15 offset:0
    ds_read_b128 v[60:63], v15 offset:1024
    ds_read_b128 v[64:67], v15 offset:2048
    ds_read_b128 v[68:71], v15 offset:3072
    ds_read_b128 v[72:75], v15 offset:4096
    ds_read_b128 v[76:79], v15 offset:5120
    ds_read_b128 v[80:83], v15 offset:6144
    ds_read_b128 v[84:87], v15 offset:7168
    s_waitcnt lgkmcnt(7)
    buffer_store_dwordx4 v[56:59], v0, s[4:7], s65 offen offset:0 sc1
    s_waitcnt lgkmcnt(6)
    buffer_store_dwordx4 v[60:63], v0, s[4:7], s65 offen offset:1024 sc1
    s_waitcnt lgkmcnt(5)
    buffer_store_dwordx4 v[64:67], v0, s[4:7], s65 offen offset:2048 sc1
    s_waitcnt lgkmcnt(4)
    buffer_store_dwordx4 v[68:71], v0, s[4:7], s65 offen offset:3072 sc1
    s_waitcnt lgkmcnt(3)
    buffer_store_dwordx4 v[72:75], v0, s[4:7], s66 offen offset:0 sc1
    s_waitcnt lgkmcnt(2)
    buffer_store_dwordx4 v[76:79], v0, s[4:7], s66 offen offset:1024 sc1
    s_waitcnt lgkmcnt(1)
    buffer_store_dwordx4 v[80:83], v0, s[4:7], s66 offen offset:2048 sc1
    s_waitcnt lgkmcnt(0)
    buffer_store_dwordx4 v[84:87], v0, s[4:7], s66 offen offset:3072 sc1
    s_mov_b32 s12, s40
    s_mov_b32 s13, s41
    s_mov_b32 s14, 0x100
    s_mov_b32 s15, 0x20000
    v_mov_b32 v15, 0x80
    s_waitcnt vmcnt(0)
    s_barrier
    s_cmp_eq_u32 s3, 0
    s_cselect_b32 s65, s59, 0x40000000
    buffer_store_byte v15, off, s[12:15], s65 sc1
    s_cmp_ge_u32 s44, 86
    s_cbranch_scc1 L_exit
O_noln:
    s_and_b32 s65, s3, 1
    s_lshl_b32 s65, s65, 2
    v_add_u32 v15, s65, v3
    v_lshlrev_b32 v15, 1, v15
    v_xor_b32 v15, v15, v4
    v_lshlrev_b32 v15, 4, v15
    v_and_b32 v14, 1, v3
    v_lshlrev_b32 v14, 4, v14
    v_lshrrev_b32 v16, 1, v3
    s_lshl_b32 s65, s3, 2
    v_add3_u32 v14, v14, v16, s65
    v_mul_u32_u24 v14, 2752, v14
    v_add_u32 v5, v14, v15
    v_bfe_u32 v15, v2, 2, 3
    s_lshl_b32 s65, s3, 1
    v_xor_b32 v15, s65, v15
    v_lshrrev_b32 v14, 2, v2
    v_lshlrev_b32 v14, 8, v14
    v_lshl_add_u32 v14, v15, 5, v14
    v_and_b32 v15, 3, v2
    v_lshl_add_u32 v14, v15, 3, v14
    v_add_u32 v7, 65536, v14
    v_xor_b32 v14, 32, v14
    v_add_u32 v8, 65536, v14
    s_mov_b32 s88, s32
    s_mov_b32 s89, s33
    s_mov_b32 s90, 0x158000
    s_mov_b32 s91, 0x20000
    s_mov_b32 s92, s34
    s_mov_b32 s93, s35
    s_mov_b32 s94, 0x158000
    s_mov_b32 s95, 0x20000
    s_mov_b32 s96, s36
    s_mov_b32 s97, s37
    s_mov_b32 s98, 0x158000
    s_mov_b32 s99, 0x20000
    s_and_b32 s67, s44, 63
    s_mul_i32 s65, s67, 373
    s_lshr_b32 s65, s65, 12
    s_mul_i32 s66, s65, 11
    s_sub_u32 s66, s67, s66
    s_cmp_ge_u32 s44, 64
    s_cselect_b32 s72, 2, 5
    s_cselect_b32 s73, 64, 56
    s_cselect_b32 s74, 55, 0
    s_cselect_b32 s68, 56, 0
    s_add_u32 s74, s74, s67
    s_add_u32 s65, s65, s68
    s_lshl_b32 s70, s72, 15
    s_mul_i32 s71, s72, 90112
    s_lshl_b32 s61, s66, 2
    s_add_u32 s61, s61, s3
    s_lshl_b32 s50, s66, 8
    s_lshl_b32 s47, s3, 13
    s_mov_b32 s49, s65
    s_lshl_b32 s67, s65, 15
    s_add_u32 s46, s67, s47
    s_add_u32 s46, s46, 0x200000
    s_mul_i32 s48, s65, 90112
    s_lshl_b32 s67, s61, 10
    s_add_u32 s48, s48, s67
    s_add_u32 s48, s48, 0x400000
    s_and_b32 s65, s44, 15
    s_lshl_b32 s58, s65, 6
    s_mul_i32 s51, s3, 360448
    s_add_u32 s51, s51, s58
    s_lshl_b32 s52, s3, 20
    s_add_u32 s52, s52, s58
    v_mov_b32 v1, v0
    s_sub_u32 s65, s44, 55
    s_cmp_lt_u32 s65, 9
    s_cbranch_scc1 O_noffn
    s_add_u32 s65, s50, 0x0
    s_add_u32 m0, s45, 0
    s_nop 0
    buffer_load_dwordx4 v5, s[88:91], s65 offen lds
    s_add_u32 s65, s50, 0x1580
    s_add_u32 m0, s45, 4096
    s_nop 0
    buffer_load_dwordx4 v5, s[88:91], s65 offen lds
    s_add_u32 s65, s50, 0x0
    s_add_u32 m0, s45, 8192
    s_nop 0
    buffer_load_dwordx4 v5, s[92:95], s65 offen lds
    s_add_u32 s65, s50, 0x1580
    s_add_u32 m0, s45, 12288
    s_nop 0
    buffer_load_dwordx4 v5, s[92:95], s65 offen lds
    s_add_u32 s65, s50, 0x15800
    s_add_u32 m0, s45, 16384
    s_nop 0
    buffer_load_dwordx4 v5, s[88:91], s65 offen lds
    s_add_u32 s65, s50, 0x16d80
    s_add_u32 m0, s45, 20480
    s_nop 0
    buffer_load_dwordx4 v5, s[88:91], s65 offen lds
    s_add_u32 s65, s50, 0x15800
    s_add_u32 m0, s45, 24576
    s_nop 0
    buffer_load_dwordx4 v5, s[92:95], s65 offen lds
    s_add_u32 s65, s50, 0x16d80
    s_add_u32 m0, s45, 28672
    s_nop 0
    buffer_load_dwordx4 v5, s[92:95], s65 offen lds
    s_add_u32 s65, s50, 0x2b000
    s_add_u32 m0, s45, 32768
    s_nop 0
    buffer_load_dwordx4 v5, s[88:91], s65 offen lds
    s_add_u32 s65, s50, 0x2c580
    s_add_u32 m0, s45, 36864
    s_nop 0
    buffer_load_dwordx4 v5, s[88:91], s65 offen lds
    s_add_u32 s65, s50, 0x2b000
    s_add_u32 m0, s45, 40960
    s_nop 0
    buffer_load_dwordx4 v5, s[92:95], s65 offen lds
    s_add_u32 s65, s50, 0x2c580
    s_add_u32 m0, s45, 45056
    s_nop 0
    buffer_load_dwordx4 v5, s[92:95], s65 offen lds
    s_add_u32 s65, s50, 0x40800
    s_add_u32 m0, s45, 49152
    s_nop 0
    buffer_load_dwordx4 v5, s[88:91], s65 offen lds
    s_add_u32 s65, s50, 0x41d80
    s_add_u32 m0, s45, 53248
    s_nop 0
    buffer_load_dwordx4 v5, s[88:91], s65 offen lds
    s_waitcnt vmcnt(12)
    s_barrier
    s_add_u32 s65, s50, 0x40800
    s_add_u32 m0, s45, 57344
    s_nop 0
    buffer_load_dwordx4 v5, s[92:95], s65 offen lds
    s_add_u32 s65, s50, 0x41d80
    s_add_u32 m0, s45, 61440
    s_nop 0
    buffer_load_dwordx4 v5, s[92:95], s65 offen lds
    ds_read_b64_tr_b16 a[0:1], v7 offset:0
    ds_read_b64_tr_b16 a[2:3], v7 offset:4096
    ds_read_b64_tr_b16 a[4:5], v8 offset:0
    ds_read_b64_tr_b16 a[6:7], v8 offset:4096
    s_waitcnt vmcnt(12)
    s_waitcnt lgkmcnt(0)
    s_barrier
    s_add_u32 s65, s50, 0x56000
    s_add_u32 m0, s45, 0
    s_nop 0
    buffer_load_dwordx4 v5, s[88:91], s65 offen lds
    s_add_u32 s65, s50, 0x57580
    s_add_u32 m0, s45, 4096
    s_nop 0
    buffer_load_dwordx4 v5, s[88:91], s65 offen lds
    ds_read_b64_tr_b16 a[128:129], v7 offset:8192
    ds_read_b64_tr_b16 a[130:131], v7 offset:12288
    ds_read_b64_tr_b16 a[132:133], v8 offset:8192
    ds_read_b64_tr_b16 a[134:135], v8 offset:12288
    s_waitcnt vmcnt(12)
    s_waitcnt lgkmcnt(0)
    s_barrier
    s_add_u32 s65, s50, 0x56000
    s_add_u32 m0, s45, 8192
    s_nop 0
    buffer_load_dwordx4 v5, s[92:95], s65 offen lds
    s_add_u32 s65, s50, 0x57580
    s_add_u32 m0, s45, 12288
    s_nop 0
    buffer_load_dwordx4 v5, s[92:95], s65 offen lds
    ds_read_b64_tr_b16 a[8:9], v7 offset:16384
    ds_read_b64_tr_b16 a[10:11], v7 offset:20480
    ds_read_b64_tr_b16 a[12:13], v8 offset:16384
    ds_read_b64_tr_b16 a[14:15], v8 offset:20480
    s_waitcnt vmcnt(12)
    s_waitcnt lgkmcnt(0)
    s_barrier
    s_add_u32 s65, s50, 0x6b800
    s_add_u32 m0, s45, 16384
    s_nop 0
    buffer_load_dwordx4 v5, s[88:91], s65 offen lds
    s_add_u32 s65, s50, 0x6cd80
    s_add_u32 m0, s45, 20480
    s_nop 0
    buffer_load_dwordx4 v5, s[88:91], s65 offen lds
    ds_read_b64_tr_b16 a[136:137], v7 offset:24576
    ds_read_b64_tr_b16 a[138:139], v7 offset:28672
    ds_read_b64_tr_b16 a[140:141], v8 offset:24576
    ds_read_b64_tr_b16 a[142:143], v8 offset:28672
    s_waitcnt vmcnt(12)
    s_waitcnt lgkmcnt(0)
    s_barrier
    s_add_u32 s65, s50, 0x6b800
    s_add_u32 m0, s45, 24576
    s_nop 0
    buffer_load_dwordx4 v5, s[92:95], s65 offen lds
    s_add_u32 s65, s50, 0x6cd80
    s_add_u32 m0, s45, 28672
    s_nop 0
    buffer_load_dwordx4 v5, s[92:95], s65 offen lds
    ds_read_b64_tr_b16 a[16:17], v7 offset:32768
    ds_read_b64_tr_b16 a[18:19], v7 offset:36864
    ds_read_b64_tr_b16 a[20:21], v8 offset:32768
    ds_read_b64_tr_b16 a[22:23], v8 offset:36864
    s_waitcnt vmcnt(12)
    s_waitcnt lgkmcnt(0)
    s_barrier
    s_add_u32 s65, s50, 0x81000
    s_add_u32 m0, s45, 32768
    s_nop 0
    buffer_load_dwordx4 v5, s[88:91], s65 offen lds
    s_add_u32 s65, s50, 0x82580
    s_add_u32 m0, s45, 36864
    s_nop 0
    buffer_load_dwordx4 v5, s[88:91], s65 offen lds
    ds_read_b64_tr_b16 a[144:145], v7 offset:40960
    ds_read_b64_tr_b16 a[146:147], v7 offset:45056
    ds_read_b64_tr_b16 a[148:149], v8 offset:40960
    ds_read_b64_tr_b16 a[150:151], v8 offset:45056
    s_waitcnt vmcnt(12)
    s_waitcnt lgkmcnt(0)
    s_barrier
    s_add_u32 s65, s50, 0x81000
    s_add_u32 m0, s45, 40960
    s_nop 0
    buffer_load_dwordx4 v5, s[92:95], s65 offen lds
    s_add_u32 s65, s50, 0x82580
    s_add_u32 m0, s45, 45056
    s_nop 0
    buffer_load_dwordx4 v5, s[92:95], s65 offen lds
    ds_read_b64_tr_b16 a[24:25], v7 offset:49152
    ds_read_b64_tr_b16 a[26:27], v7 offset:53248
    ds_read_b64_tr_b16 a[28:29], v8 offset:49152
    ds_read_b64_tr_b16 a[30:31], v8 offset:53248
    s_waitcnt vmcnt(12)
    s_waitcnt lgkmcnt(0)
    s_barrier
    s_add_u32 s65, s50, 0x96800
    s_add_u32 m0, s45, 49152
    s_nop 0
    buffer_load_dwordx4 v5, s[88:91], s65 offen lds
    s_add_u32 s65, s50, 0x97d80
    s_add_u32 m0, s45, 53248
    s_nop 0
    buffer_load_dwordx4 v5, s[88:91], s65 offen lds
    ds_read_b64_tr_b16 a[152:153], v7 offset:57344
    ds_read_b64_tr_b16 a[154:155], v7 offset:61440
    ds_read_b64_tr_b16 a[156:157], v8 offset:57344
    ds_read_b64_tr_b16 a[158:159], v8 offset:61440
    s_waitcnt vmcnt(12)
    s_waitcnt lgkmcnt(0)
    s_barrier
    s_add_u32 s65, s50, 0x96800
    s_add_u32 m0, s45, 57344
    s_nop 0
    buffer_load_dwordx4 v5, s[92:95], s65 offen lds
    s_add_u32 s65, s50, 0x97d80
    s_add_u32 m0, s45, 61440
    s_nop 0
    buffer_load_dwordx4 v5, s[92:95], s65 offen lds
    ds_read_b64_tr_b16 a[32:33], v7 offset:0
    ds_read_b64_tr_b16 a[34:35], v7 offset:4096
    ds_read_b64_tr_b16 a[36:37], v8 offset:0
    ds_read_b64_tr_b16 a[38:39], v8 offset:4096
    s_waitcnt vmcnt(12)
    s_waitcnt lgkmcnt(0)
    s_barrier
    s_add_u32 s65, s50, 0xac000
    s_add_u32 m0, s45, 0
    s_nop 0
    buffer_load_dwordx4 v5, s[88:91], s65 offen lds
    s_add_u32 s65, s50, 0xad580
    s_add_u32 m0, s45, 4096
    s_nop 0
    buffer_load_dwordx4 v5, s[88:91], s65 offen lds
    ds_read_b64_tr_b16 a[160:161], v7 offset:8192
    ds_read_b64_tr_b16 a[162:163], v7 offset:12288
    ds_read_b64_tr_b16 a[164:165], v8 offset:8192
    ds_read_b64_tr_b16 a[166:167], v8 offset:12288
    s_waitcnt vmcnt(12)
    s_waitcnt lgkmcnt(0)
    s_barrier
    s_add_u32 s65, s50, 0xac000
    s_add_u32 m0, s45, 8192
    s_nop 0
    buffer_load_dwordx4 v5, s[92:95], s65 offen lds
    s_add_u32 s65, s50, 0xad580
    s_add_u32 m0, s45, 12288
    s_nop 0
    buffer_load_dwordx4 v5, s[92:95], s65 offen lds
    ds_read_b64_tr_b16 a[40:41], v7 offset:16384
    ds_read_b64_tr_b16 a[42:43], v7 offset:20480
    ds_read_b64_tr_b16 a[44:45], v8 offset:16384
    ds_read_b64_tr_b16 a[46:47], v8 offset:20480
    s_waitcnt vmcnt(12)
    s_waitcnt lgkmcnt(0)
    s_barrier
    s_add_u32 s65, s50, 0xc1800
    s_add_u32 m0, s45, 16384
    s_nop 0
    buffer_load_dwordx4 v5, s[88:91], s65 offen lds
    s_add_u32 s65, s50, 0xc2d80
    s_add_u32 m0, s45, 20480
    s_nop 0
    buffer_load_dwordx4 v5, s[88:91], s65 offen lds
    ds_read_b64_tr_b16 a[168:169], v7 offset:24576
    ds_read_b64_tr_b16 a[170:171], v7 offset:28672
    ds_read_b64_tr_b16 a[172:173], v8 offset:24576
    ds_read_b64_tr_b16 a[174:175], v8 offset:28672
    s_waitcnt vmcnt(12)
    s_waitcnt lgkmcnt(0)
    s_barrier
    s_add_u32 s65, s50, 0xc1800
    s_add_u32 m0, s45, 24576
    s_nop 0
    buffer_load_dwordx4 v5, s[92:95], s65 offen lds
    s_add_u32 s65, s50, 0xc2d80
    s_add_u32 m0, s45, 28672
    s_nop 0
    buffer_load_dwordx4 v5, s[92:95], s65 offen lds
    ds_read_b64_tr_b16 a[48:49], v7 offset:32768
    ds_read_b64_tr_b16 a[50:51], v7 offset:36864
    ds_read_b64_tr_b16 a[52:53], v8 offset:32768
    ds_read_b64_tr_b16 a[54:55], v8 offset:36864
    s_waitcnt vmcnt(12)
    s_waitcnt lgkmcnt(0)
    s_barrier
    s_add_u32 s65, s50, 0xd7000
    s_add_u32 m0, s45, 32768
    s_nop 0
    buffer_load_dwordx4 v5, s[88:91], s65 offen lds
    s_add_u32 s65, s50, 0xd8580
    s_add_u32 m0, s45, 36864
    s_nop 0
    buffer_load_dwordx4 v5, s[88:91], s65 offen lds
    ds_read_b64_tr_b16 a[176:177], v7 offset:40960
    ds_read_b64_tr_b16 a[178:179], v7 offset:45056
    ds_read_b64_tr_b16 a[180:181], v8 offset:40960
    ds_read_b64_tr_b16 a[182:183], v8 offset:45056
    s_waitcnt vmcnt(12)
    s_waitcnt lgkmcnt(0)
    s_barrier
    s_add_u32 s65, s50, 0xd7000
    s_add_u32 m0, s45, 40960
    s_nop 0
    buffer_load_dwordx4 v5, s[92:95], s65 offen lds
    s_add_u32 s65, s50, 0xd8580
    s_add_u32 m0, s45, 45056
    s_nop 0
    buffer_load_dwordx4 v5, s[92:95], s65 offen lds
    ds_read_b64_tr_b16 a[56:57], v7 offset:49152
    ds_read_b64_tr_b16 a[58:59], v7 offset:53248
    ds_read_b64_tr_b16 a[60:61], v8 offset:49152
    ds_read_b64_tr_b16 a[62:63], v8 offset:53248
    s_waitcnt vmcnt(12)
    s_waitcnt lgkmcnt(0)
    s_barrier
    s_add_u32 s65, s50, 0xec800
    s_add_u32 m0, s45, 49152
    s_nop 0
    buffer_load_dwordx4 v5, s[88:91], s65 offen lds
    s_add_u32 s65, s50, 0xedd80
    s_add_u32 m0, s45, 53248
    s_nop 0
    buffer_load_dwordx4 v5, s[88:91], s65 offen lds
    ds_read_b64_tr_b16 a[184:185], v7 offset:57344
    ds_read_b64_tr_b16 a[186:187], v7 offset:61440
    ds_read_b64_tr_b16 a[188:189], v8 offset:57344
    ds_read_b64_tr_b16 a[190:191], v8 offset:61440
    s_waitcnt vmcnt(12)
    s_waitcnt lgkmcnt(0)
    s_barrier
    s_add_u32 s65, s50, 0xec800
    s_add_u32 m0, s45, 57344
    s_nop 0
    buffer_load_dwordx4 v5, s[92:95], s65 offen lds
    s_add_u32 s65, s50, 0xedd80
    s_add_u32 m0, s45, 61440
    s_nop 0
    buffer_load_dwordx4 v5, s[92:95], s65 offen lds
    ds_read_b64_tr_b16 a[64:65], v7 offset:0
    ds_read_b64_tr_b16 a[66:67], v7 offset:4096
    ds_read_b64_tr_b16 a[68:69], v8 offset:0
    ds_read_b64_tr_b16 a[70:71], v8 offset:4096
    s_waitcnt vmcnt(12)
    s_waitcnt lgkmcnt(0)
    s_barrier
    s_add_u32 s65, s50, 0x102000
    s_add_u32 m0, s45, 0
    s_nop 0
    buffer_load_dwordx4 v5, s[88:91], s65 offen lds
    s_add_u32 s65, s50, 0x103580
    s_add_u32 m0, s45, 4096
    s_nop 0
    buffer_load_dwordx4 v5, s[88:91], s65 offen lds
    ds_read_b64_tr_b16 a[192:193], v7 offset:8192
    ds_read_b64_tr_b16 a[194:195], v7 offset:12288
    ds_read_b64_tr_b16 a[196:197], v8 offset:8192
    ds_read_b64_tr_b16 a[198:199], v8 offset:12288
    s_waitcnt vmcnt(12)
    s_waitcnt lgkmcnt(0)
    s_barrier
    s_add_u32 s65, s50, 0x102000
    s_add_u32 m0, s45, 8192
    s_nop 0
    buffer_load_dwordx4 v5, s[92:95], s65 offen lds
    s_add_u32 s65, s50, 0x103580
    s_add_u32 m0, s45, 12288
    s_nop 0
    buffer_load_dwordx4 v5, s[92:95], s65 offen lds
    ds_read_b64_tr_b16 a[72:73], v7 offset:16384
    ds_read_b64_tr_b16 a[74:75], v7 offset:20480
    ds_read_b64_tr_b16 a[76:77], v8 offset:16384
    ds_read_b64_tr_b16 a[78:79], v8 offset:20480
    s_waitcnt vmcnt(12)
    s_waitcnt lgkmcnt(0)
    s_barrier
    s_add_u32 s65, s50, 0x117800
    s_add_u32 m0, s45, 16384
    s_nop 0
    buffer_load_dwordx4 v5, s[88:91], s65 offen lds
    s_add_u32 s65, s50, 0x118d80
    s_add_u32 m0, s45, 20480
    s_nop 0
    buffer_load_dwordx4 v5, s[88:91], s65 offen lds
    ds_read_b64_tr_b16 a[200:201], v7 offset:24576
    ds_read_b64_tr_b16 a[202:203], v7 offset:28672
    ds_read_b64_tr_b16 a[204:205], v8 offset:24576
    ds_read_b64_tr_b16 a[206:207], v8 offset:28672
    s_waitcnt vmcnt(12)
    s_waitcnt lgkmcnt(0)
    s_barrier
    s_add_u32 s65, s50, 0x117800
    s_add_u32 m0, s45, 24576
    s_nop 0
    buffer_load_dwordx4 v5, s[92:95], s65 offen lds
    s_add_u32 s65, s50, 0x118d80
    s_add_u32 m0, s45, 28672
    s_nop 0
    buffer_load_dwordx4 v5, s[92:95], s65 offen lds
    ds_read_b64_tr_b16 a[80:81], v7 offset:32768
    ds_read_b64_tr_b16 a[82:83], v7 offset:36864
    ds_read_b64_tr_b16 a[84:85], v8 offset:32768
    ds_read_b64_tr_b16 a[86:87], v8 offset:36864
    s_waitcnt vmcnt(12)
    s_waitcnt lgkmcnt(0)
    s_barrier
    s_add_u32 s65, s50, 0x12d000
    s_add_u32 m0, s45, 32768
    s_nop 0
    buffer_load_dwordx4 v5, s[88:91], s65 offen lds
    s_add_u32 s65, s50, 0x12e580
    s_add_u32 m0, s45, 36864
    s_nop 0
    buffer_load_dwordx4 v5, s[88:91], s65 offen lds
    ds_read_b64_tr_b16 a[208:209], v7 offset:40960
    ds_read_b64_tr_b16 a[210:211], v7 offset:45056
    ds_read_b64_tr_b16 a[212:213], v8 offset:40960
    ds_read_b64_tr_b16 a[214:215], v8 offset:45056
    s_waitcnt vmcnt(12)
    s_waitcnt lgkmcnt(0)
    s_barrier
    s_add_u32 s65, s50, 0x12d000
    s_add_u32 m0, s45, 40960
    s_nop 0
    buffer_load_dwordx4 v5, s[92:95], s65 offen lds
    s_add_u32 s65, s50, 0x12e580
    s_add_u32 m0, s45, 45056
    s_nop 0
    buffer_load_dwordx4 v5, s[92:95], s65 offen lds
    ds_read_b64_tr_b16 a[88:89], v7 offset:49152
    ds_read_b64_tr_b16 a[90:91], v7 offset:53248
    ds_read_b64_tr_b16 a[92:93], v8 offset:49152
    ds_read_b64_tr_b16 a[94:95], v8 offset:53248
    s_waitcnt vmcnt(12)
    s_waitcnt lgkmcnt(0)
    s_barrier
    s_add_u32 s65, s50, 0x142800
    s_add_u32 m0, s45, 49152
    s_nop 0
    buffer_load_dwordx4 v5, s[88:91], s65 offen lds
    s_add_u32 s65, s50, 0x143d80
    s_add_u32 m0, s45, 53248
    s_nop 0
    buffer_load_dwordx4 v5, s[88:91], s65 offen lds
    ds_read_b64_tr_b16 a[216:217], v7 offset:57344
    ds_read_b64_tr_b16 a[218:219], v7 offset:61440
    ds_read_b64_tr_b16 a[220:221], v8 offset:57344
    ds_read_b64_tr_b16 a[222:223], v8 offset:61440
    s_waitcnt vmcnt(12)
    s_waitcnt lgkmcnt(0)
    s_barrier
    s_add_u32 s65, s50, 0x142800
    s_add_u32 m0, s45, 57344
    s_nop 0
    buffer_load_dwordx4 v5, s[92:95], s65 offen lds
    s_add_u32 s65, s50, 0x143d80
    s_add_u32 m0, s45, 61440
    s_nop 0
    buffer_load_dwordx4 v5, s[92:95], s65 offen lds
    ds_read_b64_tr_b16 a[96:97], v7 offset:0
    ds_read_b64_tr_b16 a[98:99], v7 offset:4096
    ds_read_b64_tr_b16 a[100:101], v8 offset:0
    ds_read_b64_tr_b16 a[102:103], v8 offset:4096
    s_waitcnt vmcnt(12)
    s_waitcnt lgkmcnt(0)
    s_barrier
    ds_read_b64_tr_b16 a[224:225], v7 offset:8192
    ds_read_b64_tr_b16 a[226:227], v7 offset:12288
    ds_read_b64_tr_b16 a[228:229], v8 offset:8192
    ds_read_b64_tr_b16 a[230:231], v8 offset:12288
    s_waitcnt vmcnt(10)
    s_waitcnt lgkmcnt(0)
    s_barrier
    ds_read_b64_tr_b16 a[104:105], v7 offset:16384
    ds_read_b64_tr_b16 a[106:107], v7 offset:20480
    ds_read_b64_tr_b16 a[108:109], v8 offset:16384
    ds_read_b64_tr_b16 a[110:111], v8 offset:20480
    s_waitcnt vmcnt(8)
    s_waitcnt lgkmcnt(0)
    s_barrier
    ds_read_b64_tr_b16 a[232:233], v7 offset:24576
    ds_read_b64_tr_b16 a[234:235], v7 offset:28672
    ds_read_b64_tr_b16 a[236:237], v8 offset:24576
    ds_read_b64_tr_b16 a[238:239], v8 offset:28672
    s_waitcnt vmcnt(6)
    s_waitcnt lgkmcnt(0)
    s_barrier
    ds_read_b64_tr_b16 a[112:113], v7 offset:32768
    ds_read_b64_tr_b16 a[114:115], v7 offset:36864
    ds_read_b64_tr_b16 a[116:117], v8 offset:32768
    ds_read_b64_tr_b16 a[118:119], v8 offset:36864
    s_waitcnt vmcnt(4)
    s_waitcnt lgkmcnt(0)
    s_barrier
    ds_read_b64_tr_b16 a[240:241], v7 offset:40960
    ds_read_b64_tr_b16 a[242:243], v7 offset:45056
    ds_read_b64_tr_b16 a[244:245], v8 offset:40960
    ds_read_b64_tr_b16 a[246:247], v8 offset:45056
    s_waitcnt vmcnt(2)
    s_waitcnt lgkmcnt(0)
    s_barrier
    ds_read_b64_tr_b16 a[120:121], v7 offset:49152
    ds_read_b64_tr_b16 a[122:123], v7 offset:53248
    ds_read_b64_tr_b16 a[124:125], v8 offset:49152
    ds_read_b64_tr_b16 a[126:127], v8 offset:53248
    s_waitcnt vmcnt(0)
    s_waitcnt lgkmcnt(0)
    s_barrier
    ds_read_b64_tr_b16 a[248:249], v7 offset:57344
    ds_read_b64_tr_b16 a[250:251], v7 offset:61440
    ds_read_b64_tr_b16 a[252:253], v8 offset:57344
    ds_read_b64_tr_b16 a[254:255], v8 offset:61440
    s_waitcnt vmcnt(0) lgkmcnt(0)
    s_mov_b32 s12, s40
    s_mov_b32 s13, s41
    s_mov_b32 s14, 0x100
    s_mov_b32 s15, 0x20000
    v_and_b32 v15, 15, v2
    v_lshlrev_b32 v15, 2, v15
    s_mov_b32 s65, 0x80808080
    s_cmp_lg_u32 s3, 0
    s_cbranch_scc1 O_init_ok
O_init:
    buffer_load_dword v14, v15, s[12:15], 0 offen sc1
    s_sub_u32 s69, s69, 1
    s_cbranch_scc1 L_exit
    s_waitcnt vmcnt(0)
    v_and_b32 v16, s65, v14
    v_cmp_ne_u32 vcc, s65, v16
    s_cbranch_vccz O_init_ok
    s_sleep 8
    s_branch O_init
O_init_ok:
    s_barrier
    s_add_u32 m0, s47, 0
    s_add_u32 s65, s46, 0
    buffer_load_dwordx4 v0, s[4:7], s65 offen offset:0 sc1 lds
    buffer_load_dwordx4 v0, s[4:7], s65 offen offset:1024 sc1 lds
    buffer_load_dwordx4 v0, s[4:7], s65 offen offset:2048 sc1 lds
    buffer_load_dwordx4 v0, s[4:7], s65 offen offset:3072 sc1 lds
    s_add_u32 m0, s47, 4096
    s_add_u32 s65, s46, 4096
    buffer_load_dwordx4 v0, s[4:7], s65 offen offset:0 sc1 lds
    buffer_load_dwordx4 v0, s[4:7], s65 offen offset:1024 sc1 lds
    buffer_load_dwordx4 v0, s[4:7], s65 offen offset:2048 sc1 lds
    buffer_load_dwordx4 v0, s[4:7], s65 offen offset:3072 sc1 lds
    s_xor_b32 s47, s47, 32768
    s_add_u32 s46, s46, s70
    s_waitcnt vmcnt(0)
    s_mov_b32 s54, 0xbfb8aa3b
    s_mov_b32 s55, 0x40000000
O_ffn:
    s_waitcnt vmcnt(2)
    s_barrier
    ds_read_b128 v[56:59], v1 offset:0
    ds_read_b128 v[60:63], v1 offset:16384
    s_waitcnt lgkmcnt(1)
    v_mfma_f32_16x16x32_bf16 v[24:27], a[0:3], v[56:59], 0
    ds_read_b128 v[64:67], v1 offset:1024
    v_mfma_f32_16x16x32_bf16 v[32:35], a[4:7], v[56:59], 0
    s_add_u32 m0, s47, 0
    s_add_u32 s65, s46, 0
    buffer_load_dwordx4 v0, s[4:7], s65 offen offset:0 sc1 lds
    v_mfma_f32_16x16x32_bf16 v[40:43], a[128:131], v[56:59], 0
    ds_read_b128 v[68:71], v1 offset:17408
    v_mfma_f32_16x16x32_bf16 v[48:51], a[132:135], v[56:59], 0
    s_waitcnt lgkmcnt(2)
    v_mfma_f32_16x16x32_bf16 v[28:31], a[0:3], v[60:63], 0
    buffer_load_dwordx4 v0, s[4:7], s65 offen offset:1024 sc1 lds
    v_mfma_f32_16x16x32_bf16 v[36:39], a[4:7], v[60:63], 0
    v_mfma_f32_16x16x32_bf16 v[44:47], a[128:131], v[60:63], 0
    buffer_load_dwordx4 v0, s[4:7], s65 offen offset:2048 sc1 lds
    v_mfma_f32_16x16x32_bf16 v[52:55], a[132:135], v[60:63], 0
    s_waitcnt lgkmcnt(1)
    v_mfma_f32_16x16x32_bf16 v[24:27], a[8:11], v[64:67], v[24:27]
    ds_read_b128 v[56:59], v1 offset:2048
    v_mul_f32 v72, s54, v96
    v_mfma_f32_16x16x32_bf16 v[32:35], a[12:15], v[64:67], v[32:35]
    buffer_load_dwordx4 v0, s[4:7], s65 offen offset:3072 sc1 lds
    v_mfma_f32_16x16x32_bf16 v[40:43], a[136:139], v[64:67], v[40:43]
    ds_read_b128 v[60:63], v1 offset:18432
    v_mul_f32 v73, s54, v97
    v_mfma_f32_16x16x32_bf16 v[48:51], a[140:143], v[64:67], v[48:51]
    s_waitcnt lgkmcnt(2)
    v_mul_f32 v74, s54, v98
    v_mfma_f32_16x16x32_bf16 v[28:31], a[8:11], v[68:71], v[28:31]
    s_add_u32 m0, s47, 4096
    s_add_u32 s65, s46, 4096
    buffer_load_dwordx4 v0, s[4:7], s65 offen offset:0 sc1 lds
    v_mfma_f32_16x16x32_bf16 v[36:39], a[12:15], v[68:71], v[36:39]
    v_mul_f32 v75, s54, v99
    v_mfma_f32_16x16x32_bf16 v[44:47], a[136:139], v[68:71], v[44:47]
    buffer_load_dwordx4 v0, s[4:7], s65 offen offset:1024 sc1 lds
    v_mfma_f32_16x16x32_bf16 v[52:55], a[140:143], v[68:71], v[52:55]
    s_waitcnt lgkmcnt(1)
    v_mul_f32 v76, s54, v104
    v_mfma_f32_16x16x32_bf16 v[24:27], a[16:19], v[56:59], v[24:27]
    ds_read_b128 v[64:67], v1 offset:3072
    v_mul_f32 v77, s54, v105
    v_mfma_f32_16x16x32_bf16 v[32:35], a[20:23], v[56:59], v[32:35]
    buffer_load_dwordx4 v0, s[4:7], s65 offen offset:2048 sc1 lds
    v_mfma_f32_16x16x32_bf16 v[40:43], a[144:147], v[56:59], v[40:43]
    ds_read_b128 v[68:71], v1 offset:19456
    v_mul_f32 v78, s54, v106
    v_mfma_f32_16x16x32_bf16 v[48:51], a[148:151], v[56:59], v[48:51]
    s_waitcnt lgkmcnt(2)
    v_mul_f32 v79, s54, v107
    v_mfma_f32_16x16x32_bf16 v[28:31], a[16:19], v[60:63], v[28:31]
    buffer_load_dwordx4 v0, s[4:7], s65 offen offset:3072 sc1 lds
    v_mfma_f32_16x16x32_bf16 v[36:39], a[20:23], v[60:63], v[36:39]
    v_exp_f32 v72, v72
    v_mfma_f32_16x16x32_bf16 v[44:47], a[144:147], v[60:63], v[44:47]
    s_xor_b32 s47, s47, 32768
    s_add_u32 s46, s46, s70
    v_mfma_f32_16x16x32_bf16 v[52:55], a[148:151], v[60:63], v[52:55]
    s_waitcnt lgkmcnt(1)
    v_exp_f32 v73, v73
    v_mfma_f32_16x16x32_bf16 v[24:27], a[24:27], v[64:67], v[24:27]
    ds_read_b128 v[56:59], v1 offset:4096
    v_exp_f32 v74, v74
    v_mfma_f32_16x16x32_bf16 v[32:35], a[28:31], v[64:67], v[32:35]
    v_exp_f32 v75, v75
    v_mfma_f32_16x16x32_bf16 v[40:43], a[152:155], v[64:67], v[40:43]
    ds_read_b128 v[60:63], v1 offset:20480
    v_exp_f32 v76, v76
    v_mfma_f32_16x16x32_bf16 v[48:51], a[156:159], v[64:67], v[48:51]
    s_waitcnt lgkmcnt(2)
    v_exp_f32 v77, v77
    v_mfma_f32_16x16x32_bf16 v[28:31], a[24:27], v[68:71], v[28:31]
    v_exp_f32 v78, v78
    v_mfma_f32_16x16x32_bf16 v[36:39], a[28:31], v[68:71], v[36:39]
    v_exp_f32 v79, v79
    v_mfma_f32_16x16x32_bf16 v[44:47], a[152:155], v[68:71], v[44:47]
    v_add_f32 v72, 1.0, v72
    v_mfma_f32_16x16x32_bf16 v[52:55], a[156:159], v[68:71], v[52:55]
    s_waitcnt lgkmcnt(1)
    v_add_f32 v73, 1.0, v73
    v_mfma_f32_16x16x32_bf16 v[24:27], a[32:35], v[56:59], v[24:27]
    ds_read_b128 v[64:67], v1 offset:5120
    v_add_f32 v74, 1.0, v74
    v_mfma_f32_16x16x32_bf16 v[32:35], a[36:39], v[56:59], v[32:35]
    v_add_f32 v75, 1.0, v75
    v_mfma_f32_16x16x32_bf16 v[40:43], a[160:163], v[56:59], v[40:43]
    ds_read_b128 v[68:71], v1 offset:21504
    v_add_f32 v76, 1.0, v76
    v_mfma_f32_16x16x32_bf16 v[48:51], a[164:167], v[56:59], v[48:51]
    s_waitcnt lgkmcnt(2)
    v_add_f32 v77, 1.0, v77
    v_mfma_f32_16x16x32_bf16 v[28:31], a[32:35], v[60:63], v[28:31]
    v_add_f32 v78, 1.0, v78
    v_mfma_f32_16x16x32_bf16 v[36:39], a[36:39], v[60:63], v[36:39]
    v_add_f32 v79, 1.0, v79
    v_mfma_f32_16x16x32_bf16 v[44:47], a[160:163], v[60:63], v[44:47]
    v_rcp_f32 v72, v72
    v_mfma_f32_16x16x32_bf16 v[52:55], a[164:167], v[60:63], v[52:55]
    s_waitcnt lgkmcnt(1)
    v_rcp_f32 v73, v73
    v_mfma_f32_16x16x32_bf16 v[24:27], a[40:43], v[64:67], v[24:27]
    ds_read_b128 v[56:59], v1 offset:6144
    v_rcp_f32 v74, v74
    v_mfma_f32_16x16x32_bf16 v[32:35], a[44:47], v[64:67], v[32:35]
    v_rcp_f32 v75, v75
    v_mfma_f32_16x16x32_bf16 v[40:43], a[168:171], v[64:67], v[40:43]
    ds_read_b128 v[60:63], v1 offset:22528
    v_rcp_f32 v76, v76
    v_mfma_f32_16x16x32_bf16 v[48:51], a[172:175], v[64:67], v[48:51]
    s_waitcnt lgkmcnt(2)
    v_rcp_f32 v77, v77
    v_mfma_f32_16x16x32_bf16 v[28:31], a[40:43], v[68:71], v[28:31]
    v_rcp_f32 v78, v78
    v_mfma_f32_16x16x32_bf16 v[36:39], a[44:47], v[68:71], v[36:39]
    v_rcp_f32 v79, v79
    v_mfma_f32_16x16x32_bf16 v[44:47], a[168:171], v[68:71], v[44:47]
    v_mul_f32 v96, v96, v72
    v_mfma_f32_16x16x32_bf16 v[52:55], a[172:175], v[68:71], v[52:55]
    s_waitcnt lgkmcnt(1)
    v_mul_f32 v97, v97, v73
    v_mfma_f32_16x16x32_bf16 v[24:27], a[48:51], v[56:59], v[24:27]
    ds_read_b128 v[64:67], v1 offset:7168
    v_mul_f32 v98, v98, v74
    v_mfma_f32_16x16x32_bf16 v[32:35], a[52:55], v[56:59], v[32:35]
    v_mul_f32 v99, v99, v75
    v_mfma_f32_16x16x32_bf16 v[40:43], a[176:179], v[56:59], v[40:43]
    ds_read_b128 v[68:71], v1 offset:23552
    v_mul_f32 v104, v104, v76
    v_mfma_f32_16x16x32_bf16 v[48:51], a[180:183], v[56:59], v[48:51]
    s_waitcnt lgkmcnt(2)
    v_mul_f32 v105, v105, v77
    v_mfma_f32_16x16x32_bf16 v[28:31], a[48:51], v[60:63], v[28:31]
    v_mul_f32 v106, v106, v78
    v_mfma_f32_16x16x32_bf16 v[36:39], a[52:55], v[60:63], v[36:39]
    v_mul_f32 v107, v107, v79
    v_mfma_f32_16x16x32_bf16 v[44:47], a[176:179], v[60:63], v[44:47]
    v_mul_f32 v96, v96, v112
    v_mfma_f32_16x16x32_bf16 v[52:55], a[180:183], v[60:63], v[52:55]
    s_waitcnt lgkmcnt(1)
    v_mul_f32 v97, v97, v113
    v_mfma_f32_16x16x32_bf16 v[24:27], a[56:59], v[64:67], v[24:27]
    ds_read_b128 v[56:59], v1 offset:8192
    v_mul_f32 v98, v98, v114
    v_mfma_f32_16x16x32_bf16 v[32:35], a[60:63], v[64:67], v[32:35]
    v_mul_f32 v99, v99, v115
    v_mfma_f32_16x16x32_bf16 v[40:43], a[184:187], v[64:67], v[40:43]
    ds_read_b128 v[60:63], v1 offset:24576
    v_mul_f32 v104, v104, v120
    v_mfma_f32_16x16x32_bf16 v[48:51], a[188:191], v[64:67], v[48:51]
    s_waitcnt lgkmcnt(2)
    v_mul_f32 v105, v105, v121
    v_mfma_f32_16x16x32_bf16 v[28:31], a[56:59], v[68:71], v[28:31]
    v_mul_f32 v106, v106, v122
    v_mfma_f32_16x16x32_bf16 v[36:39], a[60:63], v[68:71], v[36:39]
    v_mul_f32 v107, v107, v123
    v_mfma_f32_16x16x32_bf16 v[44:47], a[184:187], v[68:71], v[44:47]
    v_cvt_pk_bf16_f32 v88, v96, v97
    v_mfma_f32_16x16x32_bf16 v[52:55], a[188:191], v[68:71], v[52:55]
    s_waitcnt lgkmcnt(1)
    v_cvt_pk_bf16_f32 v89, v98, v99
    v_mfma_f32_16x16x32_bf16 v[24:27], a[64:67], v[56:59], v[24:27]
    ds_read_b128 v[64:67], v1 offset:9216
    v_cvt_pk_bf16_f32 v90, v104, v105
    v_mfma_f32_16x16x32_bf16 v[32:35], a[68:71], v[56:59], v[32:35]
    v_cvt_pk_bf16_f32 v91, v106, v107
    v_mfma_f32_16x16x32_bf16 v[40:43], a[192:195], v[56:59], v[40:43]
    ds_read_b128 v[68:71], v1 offset:25600
    buffer_store_dwordx4 v[88:91], v0, s[4:7], s55 offen sc1
    s_add_u32 s55, s55, 45056
    v_mfma_f32_16x16x32_bf16 v[48:51], a[196:199], v[56:59], v[48:51]
    s_waitcnt lgkmcnt(2)
    v_mul_f32 v80, s54, v100
    v_mfma_f32_16x16x32_bf16 v[28:31], a[64:67], v[60:63], v[28:31]
    v_mul_f32 v81, s54, v101
    v_mfma_f32_16x16x32_bf16 v[36:39], a[68:71], v[60:63], v[36:39]
    v_mul_f32 v82, s54, v102
    v_mfma_f32_16x16x32_bf16 v[44:47], a[192:195], v[60:63], v[44:47]
    v_mul_f32 v83, s54, v103
    v_mfma_f32_16x16x32_bf16 v[52:55], a[196:199], v[60:63], v[52:55]
    s_waitcnt lgkmcnt(1)
    v_mul_f32 v84, s54, v108
    v_mfma_f32_16x16x32_bf16 v[24:27], a[72:75], v[64:67], v[24:27]
    ds_read_b128 v[56:59], v1 offset:10240
    v_mul_f32 v85, s54, v109
    v_mfma_f32_16x16x32_bf16 v[32:35], a[76:79], v[64:67], v[32:35]
    v_mul_f32 v86, s54, v110
    v_mfma_f32_16x16x32_bf16 v[40:43], a[200:203], v[64:67], v[40:43]
    ds_read_b128 v[60:63], v1 offset:26624
    v_mul_f32 v87, s54, v111
    v_mfma_f32_16x16x32_bf16 v[48:51], a[204:207], v[64:67], v[48:51]
    s_waitcnt lgkmcnt(2)
    v_exp_f32 v80, v80
    v_mfma_f32_16x16x32_bf16 v[28:31], a[72:75], v[68:71], v[28:31]
    v_exp_f32 v81, v81
    v_mfma_f32_16x16x32_bf16 v[36:39], a[76:79], v[68:71], v[36:39]
    v_exp_f32 v82, v82
    v_mfma_f32_16x16x32_bf16 v[44:47], a[200:203], v[68:71], v[44:47]
    v_exp_f32 v83, v83
    v_mfma_f32_16x16x32_bf16 v[52:55], a[204:207], v[68:71], v[52:55]
    s_waitcnt lgkmcnt(1)
    v_exp_f32 v84, v84
    v_mfma_f32_16x16x32_bf16 v[24:27], a[80:83], v[56:59], v[24:27]
    ds_read_b128 v[64:67], v1 offset:11264
    v_exp_f32 v85, v85
    v_mfma_f32_16x16x32_bf16 v[32:35], a[84:87], v[56:59], v[32:35]
    v_exp_f32 v86, v86
    v_mfma_f32_16x16x32_bf16 v[40:43], a[208:211], v[56:59], v[40:43]
    ds_read_b128 v[68:71], v1 offset:27648
    v_exp_f32 v87, v87
    v_mfma_f32_16x16x32_bf16 v[48:51], a[212:215], v[56:59], v[48:51]
    s_waitcnt lgkmcnt(2)
    v_add_f32 v80, 1.0, v80
    v_mfma_f32_16x16x32_bf16 v[28:31], a[80:83], v[60:63], v[28:31]
    v_add_f32 v81, 1.0, v81
    v_mfma_f32_16x16x32_bf16 v[36:39], a[84:87], v[60:63], v[36:39]
    v_add_f32 v82, 1.0, v82
    v_mfma_f32_16x16x32_bf16 v[44:47], a[208:211], v[60:63], v[44:47]
    v_add_f32 v83, 1.0, v83
    v_mfma_f32_16x16x32_bf16 v[52:55], a[212:215], v[60:63], v[52:55]
    s_waitcnt lgkmcnt(1)
    v_add_f32 v84, 1.0, v84
    v_mfma_f32_16x16x32_bf16 v[24:27], a[88:91], v[64:67], v[24:27]
    ds_read_b128 v[56:59], v1 offset:12288
    v_add_f32 v85, 1.0, v85
    v_mfma_f32_16x16x32_bf16 v[32:35], a[92:95], v[64:67], v[32:35]
    v_add_f32 v86, 1.0, v86
    v_mfma_f32_16x16x32_bf16 v[40:43], a[216:219], v[64:67], v[40:43]
    ds_read_b128 v[60:63], v1 offset:28672
    v_add_f32 v87, 1.0, v87
    v_mfma_f32_16x16x32_bf16 v[48:51], a[220:223], v[64:67], v[48:51]
    s_waitcnt lgkmcnt(2)
    v_rcp_f32 v80, v80
    v_mfma_f32_16x16x32_bf16 v[28:31], a[88:91], v[68:71], v[28:31]
    v_rcp_f32 v81, v81
    v_mfma_f32_16x16x32_bf16 v[36:39], a[92:95], v[68:71], v[36:39]
    v_rcp_f32 v82, v82
    v_mfma_f32_16x16x32_bf16 v[44:47], a[216:219], v[68:71], v[44:47]
    v_rcp_f32 v83, v83
    v_mfma_f32_16x16x32_bf16 v[52:55], a[220:223], v[68:71], v[52:55]
    s_waitcnt lgkmcnt(1)
    v_rcp_f32 v84, v84
    v_mfma_f32_16x16x32_bf16 v[24:27], a[96:99], v[56:59], v[24:27]
    ds_read_b128 v[64:67], v1 offset:13312
    v_rcp_f32 v85, v85
    v_mfma_f32_16x16x32_bf16 v[32:35], a[100:103], v[56:59], v[32:35]
    v_rcp_f32 v86, v86
    v_mfma_f32_16x16x32_bf16 v[40:43], a[224:227], v[56:59], v[40:43]
    ds_read_b128 v[68:71], v1 offset:29696
    v_rcp_f32 v87, v87
    v_mfma_f32_16x16x32_bf16 v[48:51], a[228:231], v[56:59], v[48:51]
    s_waitcnt lgkmcnt(2)
    v_mul_f32 v100, v100, v80
    v_mfma_f32_16x16x32_bf16 v[28:31], a[96:99], v[60:63], v[28:31]
    v_mul_f32 v101, v101, v81
    v_mfma_f32_16x16x32_bf16 v[36:39], a[100:103], v[60:63], v[36:39]
    v_mul_f32 v102, v102, v82
    v_mfma_f32_16x16x32_bf16 v[44:47], a[224:227], v[60:63], v[44:47]
    v_mul_f32 v103, v103, v83
    v_mfma_f32_16x16x32_bf16 v[52:55], a[228:231], v[60:63], v[52:55]
    s_waitcnt lgkmcnt(1)
    v_mul_f32 v108, v108, v84
    v_mfma_f32_16x16x32_bf16 v[24:27], a[104:107], v[64:67], v[24:27]
    ds_read_b128 v[56:59], v1 offset:14336
    v_mul_f32 v109, v109, v85
    v_mfma_f32_16x16x32_bf16 v[32:35], a[108:111], v[64:67], v[32:35]
    v_mul_f32 v110, v110, v86
    v_mfma_f32_16x16x32_bf16 v[40:43], a[232:235], v[64:67], v[40:43]
    ds_read_b128 v[60:63], v1 offset:30720
    v_mul_f32 v111, v111, v87
    v_mfma_f32_16x16x32_bf16 v[48:51], a[236:239], v[64:67], v[48:51]
    s_waitcnt lgkmcnt(2)
    v_mul_f32 v100, v100, v116
    v_mfma_f32_16x16x32_bf16 v[28:31], a[104:107], v[68:71], v[28:31]
    v_mul_f32 v101, v101, v117
    v_mfma_f32_16x16x32_bf16 v[36:39], a[108:111], v[68:71], v[36:39]
    v_mul_f32 v102, v102, v118
    v_mfma_f32_16x16x32_bf16 v[44:47], a[232:235], v[68:71], v[44:47]
    v_mul_f32 v103, v103, v119
    v_mfma_f32_16x16x32_bf16 v[52:55], a[236:239], v[68:71], v[52:55]
    s_waitcnt lgkmcnt(1)
    v_mul_f32 v108, v108, v124
    v_mfma_f32_16x16x32_bf16 v[24:27], a[112:115], v[56:59], v[24:27]
    ds_read_b128 v[64:67], v1 offset:15360
    v_mul_f32 v109, v109, v125
    v_mfma_f32_16x16x32_bf16 v[32:35], a[116:119], v[56:59], v[32:35]
    v_mul_f32 v110, v110, v126
    v_mfma_f32_16x16x32_bf16 v[40:43], a[240:243], v[56:59], v[40:43]
    ds_read_b128 v[68:71], v1 offset:31744
    v_mul_f32 v111, v111, v127
    v_mfma_f32_16x16x32_bf16 v[48:51], a[244:247], v[56:59], v[48:51]
    s_waitcnt lgkmcnt(2)
    v_cvt_pk_bf16_f32 v92, v100, v101
    v_mfma_f32_16x16x32_bf16 v[28:31], a[112:115], v[60:63], v[28:31]
    v_cvt_pk_bf16_f32 v93, v102, v103
    v_mfma_f32_16x16x32_bf16 v[36:39], a[116:119], v[60:63], v[36:39]
    v_cvt_pk_bf16_f32 v94, v108, v109
    v_mfma_f32_16x16x32_bf16 v[44:47], a[240:243], v[60:63], v[44:47]
    v_cvt_pk_bf16_f32 v95, v110, v111
    v_mfma_f32_16x16x32_bf16 v[52:55], a[244:247], v[60:63], v[52:55]
    buffer_store_dwordx4 v[92:95], v0, s[4:7], s55 offen sc1
    s_add_u32 s55, s55, 45056
    s_waitcnt lgkmcnt(1)
    v_mfma_f32_16x16x32_bf16 v[24:27], a[120:123], v[64:67], v[24:27]
    v_mfma_f32_16x16x32_bf16 v[32:35], a[124:127], v[64:67], v[32:35]
    v_mfma_f32_16x16x32_bf16 v[40:43], a[248:251], v[64:67], v[40:43]
    v_mfma_f32_16x16x32_bf16 v[48:51], a[252:255], v[64:67], v[48:51]
    s_waitcnt lgkmcnt(0)
    v_mfma_f32_16x16x32_bf16 v[28:31], a[120:123], v[68:71], v[28:31]
    v_mfma_f32_16x16x32_bf16 v[36:39], a[124:127], v[68:71], v[36:39]
    v_mfma_f32_16x16x32_bf16 v[44:47], a[248:251], v[68:71], v[44:47]
    v_mfma_f32_16x16x32_bf16 v[52:55], a[252:255], v[68:71], v[52:55]
    v_xor_b32 v1, 0x8000, v1
    s_mov_b32 s55, s48
    s_add_u32 s48, s48, s71
    s_add_u32 s49, s49, s72
    v_mov_b64 v[96:97], v[24:25]
    v_mov_b64 v[98:99], v[26:27]
    v_mov_b64 v[104:105], v[32:33]
    v_mov_b64 v[106:107], v[34:35]
    v_mov_b64 v[112:113], v[40:41]
    v_mov_b64 v[114:115], v[42:43]
    v_mov_b64 v[120:121], v[48:49]
    v_mov_b64 v[122:123], v[50:51]
    v_mov_b64 v[100:101], v[28:29]
    v_mov_b64 v[102:103], v[30:31]
    v_mov_b64 v[108:109], v[36:37]
    v_mov_b64 v[110:111], v[38:39]
    v_mov_b64 v[116:117], v[44:45]
    v_mov_b64 v[118:119], v[46:47]
    v_mov_b64 v[124:125], v[52:53]
    v_mov_b64 v[126:127], v[54:55]
    s_cmp_lt_u32 s49, s73
    s_cbranch_scc1 O_ffn
    v_mul_f32 v72, s54, v96
    v_mul_f32 v73, s54, v97
    v_mul_f32 v74, s54, v98
    v_mul_f32 v75, s54, v99
    v_mul_f32 v76, s54, v104
    v_mul_f32 v77, s54, v105
    v_mul_f32 v78, s54, v106
    v_mul_f32 v79, s54, v107
    v_exp_f32 v72, v72
    v_exp_f32 v73, v73
    v_exp_f32 v74, v74
    v_exp_f32 v75, v75
    v_exp_f32 v76, v76
    v_exp_f32 v77, v77
    v_exp_f32 v78, v78
    v_exp_f32 v79, v79
    v_add_f32 v72, 1.0, v72
    v_add_f32 v73, 1.0, v73
    v_add_f32 v74, 1.0, v74
    v_add_f32 v75, 1.0, v75
    v_add_f32 v76, 1.0, v76
    v_add_f32 v77, 1.0, v77
    v_add_f32 v78, 1.0, v78
    v_add_f32 v79, 1.0, v79
    v_rcp_f32 v72, v72
    v_rcp_f32 v73, v73
    v_rcp_f32 v74, v74
    v_rcp_f32 v75, v75
    v_rcp_f32 v76, v76
    v_rcp_f32 v77, v77
    v_rcp_f32 v78, v78
    v_rcp_f32 v79, v79
    v_mul_f32 v96, v96, v72
    v_mul_f32 v97, v97, v73
    v_mul_f32 v98, v98, v74
    v_mul_f32 v99, v99, v75
    v_mul_f32 v104, v104, v76
    v_mul_f32 v105, v105, v77
    v_mul_f32 v106, v106, v78
    v_mul_f32 v107, v107, v79
    v_mul_f32 v96, v96, v112
    v_mul_f32 v97, v97, v113
    v_mul_f32 v98, v98, v114
    v_mul_f32 v99, v99, v115
    v_mul_f32 v104, v104, v120
    v_mul_f32 v105, v105, v121
    v_mul_f32 v106, v106, v122
    v_mul_f32 v107, v107, v123
    v_cvt_pk_bf16_f32 v88, v96, v97
    v_cvt_pk_bf16_f32 v89, v98, v99
    v_cvt_pk_bf16_f32 v90, v104, v105
    v_cvt_pk_bf16_f32 v91, v106, v107
    buffer_store_dwordx4 v[88:91], v0, s[4:7], s55 offen sc1
    s_add_u32 s55, s55, 45056
    v_mul_f32 v80, s54, v100
    v_mul_f32 v81, s54, v101
    v_mul_f32 v82, s54, v102
    v_mul_f32 v83, s54, v103
    v_mul_f32 v84, s54, v108
    v_mul_f32 v85, s54, v109
    v_mul_f32 v86, s54, v110
    v_mul_f32 v87, s54, v111
    v_exp_f32 v80, v80
    v_exp_f32 v81, v81
    v_exp_f32 v82, v82
    v_exp_f32 v83, v83
    v_exp_f32 v84, v84
    v_exp_f32 v85, v85
    v_exp_f32 v86, v86
    v_exp_f32 v87, v87
    v_add_f32 v80, 1.0, v80
    v_add_f32 v81, 1.0, v81
    v_add_f32 v82, 1.0, v82
    v_add_f32 v83, 1.0, v83
    v_add_f32 v84, 1.0, v84
    v_add_f32 v85, 1.0, v85
    v_add_f32 v86, 1.0, v86
    v_add_f32 v87, 1.0, v87
    v_rcp_f32 v80, v80
    v_rcp_f32 v81, v81
    v_rcp_f32 v82, v82
    v_rcp_f32 v83, v83
    v_rcp_f32 v84, v84
    v_rcp_f32 v85, v85
    v_rcp_f32 v86, v86
    v_rcp_f32 v87, v87
    v_mul_f32 v100, v100, v80
    v_mul_f32 v101, v101, v81
    v_mul_f32 v102, v102, v82
    v_mul_f32 v103, v103, v83
    v_mul_f32 v108, v108, v84
    v_mul_f32 v109, v109, v85
    v_mul_f32 v110, v110, v86
    v_mul_f32 v111, v111, v87
    v_mul_f32 v100, v100, v116
    v_mul_f32 v101, v101, v117
    v_mul_f32 v102, v102, v118
    v_mul_f32 v103, v103, v119
    v_mul_f32 v108, v108, v124
    v_mul_f32 v109, v109, v125
    v_mul_f32 v110, v110, v126
    v_mul_f32 v111, v111, v127
    v_cvt_pk_bf16_f32 v92, v100, v101
    v_cvt_pk_bf16_f32 v93, v102, v103
    v_cvt_pk_bf16_f32 v94, v108, v109
    v_cvt_pk_bf16_f32 v95, v110, v111
    buffer_store_dwordx4 v[92:95], v0, s[4:7], s55 offen sc1
    s_add_u32 s55, s55, 45056
    v_mov_b32 v15, 1
    s_lshl_b32 s65, s74, 7
    s_add_u32 s65, s65, 0xf5000
    s_cmp_eq_u32 s3, 0
    s_cselect_b32 s65, s65, 0x40000000
    s_waitcnt vmcnt(0)
    s_barrier
    buffer_store_dword v15, off, s[4:7], s65 sc1
    s_cmp_lt_u32 s44, 64
    s_cbranch_scc1 O_wo
    s_endpgm
O_noffn:
    s_mov_b32 s12, s40
    s_mov_b32 s13, s41
    s_mov_b32 s14, 0x100
    s_mov_b32 s15, 0x20000
    v_and_b32 v15, 15, v2
    v_lshlrev_b32 v15, 2, v15
    s_mov_b32 s65, 0x80808080
    s_cmp_lg_u32 s3, 0
    s_cbranch_scc1 O_init2_ok
O_init2:
    buffer_load_dword v14, v15, s[12:15], 0 offen sc1
    s_sub_u32 s69, s69, 1
    s_cbranch_scc1 L_exit
    s_waitcnt vmcnt(0)
    v_and_b32 v16, s65, v14
    v_cmp_ne_u32 vcc, s65, v16
    s_cbranch_vccz O_init2_ok
    s_sleep 8
    s_branch O_init2
O_init2_ok:
    s_barrier
O_wo:
    s_mov_b32 s88, s26
    s_mov_b32 s89, s27
    s_mov_b32 s90, 0x400000
    s_mov_b32 s91, 0x20000
    s_mov_b32 s92, s38
    s_mov_b32 s93, s39
    s_mov_b32 s94, 0x200000
    s_mov_b32 s95, 0x20000
    s_mul_i32 s45, s3, 40960
    v_bfe_u32 v15, v2, 1, 1
    v_xor_b32 v15, v15, v3
    v_and_b32 v15, 1, v15
    v_lshlrev_b32 v15, 5, v15
    v_and_b32 v16, 1, v2
    v_lshl_add_u32 v15, v16, 4, v15
    v_lshrrev_b32 v14, 2, v2
    v_mul_u32_u24 v14, 1024, v14
    v_add_u32 v6, v14, v15
    v_lshrrev_b32 v14, 2, v2
    v_lshlrev_b32 v14, 6, v14
    v_and_b32 v15, 3, v2
    v_lshl_add_u32 v14, v15, 3, v14
    v_and_b32 v16, 1, v3
    v_lshl_add_u32 v14, v16, 5, v14
    v_add_u32 v7, s45, v14
    v_xor_b32 v14, 32, v14
    v_add_u32 v8, s45, v14
    s_add_u32 s65, s52, 0x0
    s_add_u32 m0, s45, 0
    s_nop 0
    buffer_load_dwordx4 v6, s[88:91], s65 offen lds
    s_add_u32 s65, s52, 0x4000
    s_add_u32 m0, s45, 1024
    s_nop 0
    buffer_load_dwordx4 v6, s[88:91], s65 offen lds
    s_add_u32 s65, s52, 0x8000
    s_add_u32 m0, s45, 2048
    s_nop 0
    buffer_load_dwordx4 v6, s[88:91], s65 offen lds
    s_add_u32 s65, s52, 0xc000
    s_add_u32 m0, s45, 3072
    s_nop 0
    buffer_load_dwordx4 v6, s[88:91], s65 offen lds
    s_add_u32 s65, s52, 0x10000
    s_add_u32 m0, s45, 4096
    s_nop 0
    buffer_load_dwordx4 v6, s[88:91], s65 offen lds
    s_add_u32 s65, s52, 0x14000
    s_add_u32 m0, s45, 5120
    s_nop 0
    buffer_load_dwordx4 v6, s[88:91], s65 offen lds
    s_add_u32 s65, s52, 0x18000
    s_add_u32 m0, s45, 6144
    s_nop 0
    buffer_load_dwordx4 v6, s[88:91], s65 offen lds
    s_add_u32 s65, s52, 0x1c000
    s_add_u32 m0, s45, 7168
    s_nop 0
    buffer_load_dwordx4 v6, s[88:91], s65 offen lds
    s_add_u32 s65, s52, 0x20000
    s_add_u32 m0, s45, 8192
    s_nop 0
    buffer_load_dwordx4 v6, s[88:91], s65 offen lds
    s_add_u32 s65, s52, 0x24000
    s_add_u32 m0, s45, 9216
    s_nop 0
    buffer_load_dwordx4 v6, s[88:91], s65 offen lds
    s_add_u32 s65, s52, 0x28000
    s_add_u32 m0, s45, 10240
    s_nop 0
    buffer_load_dwordx4 v6, s[88:91], s65 offen lds
    s_add_u32 s65, s52, 0x2c000
    s_add_u32 m0, s45, 11264
    s_nop 0
    buffer_load_dwordx4 v6, s[88:91], s65 offen lds
    s_add_u32 s65, s52, 0x30000
    s_add_u32 m0, s45, 12288
    s_nop 0
    buffer_load_dwordx4 v6, s[88:91], s65 offen lds
    s_add_u32 s65, s52, 0x34000
    s_add_u32 m0, s45, 13312
    s_nop 0
    buffer_load_dwordx4 v6, s[88:91], s65 offen lds
    s_add_u32 s65, s52, 0x38000
    s_add_u32 m0, s45, 14336
    s_nop 0
    buffer_load_dwordx4 v6, s[88:91], s65 offen lds
    s_add_u32 s65, s52, 0x3c000
    s_add_u32 m0, s45, 15360
    s_nop 0
    buffer_load_dwordx4 v6, s[88:91], s65 offen lds
    s_add_u32 s65, s52, 0x40000
    s_add_u32 m0, s45, 16384
    s_nop 0
    buffer_load_dwordx4 v6, s[88:91], s65 offen lds
    s_add_u32 s65, s52, 0x44000
    s_add_u32 m0, s45, 17408
    s_nop 0
    buffer_load_dwordx4 v6, s[88:91], s65 offen lds
    s_add_u32 s65, s52, 0x48000
    s_add_u32 m0, s45, 18432
    s_nop 0
    buffer_load_dwordx4 v6, s[88:91], s65 offen lds
    s_add_u32 s65, s52, 0x4c000
    s_add_u32 m0, s45, 19456
    s_nop 0
    buffer_load_dwordx4 v6, s[88:91], s65 offen lds
    s_add_u32 s65, s52, 0x50000
    s_add_u32 m0, s45, 20480
    s_nop 0
    buffer_load_dwordx4 v6, s[88:91], s65 offen lds
    s_add_u32 s65, s52, 0x54000
    s_add_u32 m0, s45, 21504
    s_nop 0
    buffer_load_dwordx4 v6, s[88:91], s65 offen lds
    s_add_u32 s65, s52, 0x58000
    s_add_u32 m0, s45, 22528
    s_nop 0
    buffer_load_dwordx4 v6, s[88:91], s65 offen lds
    s_add_u32 s65, s52, 0x5c000
    s_add_u32 m0, s45, 23552
    s_nop 0
    buffer_load_dwordx4 v6, s[88:91], s65 offen lds
    s_add_u32 s65, s52, 0x60000
    s_add_u32 m0, s45, 24576
    s_nop 0
    buffer_load_dwordx4 v6, s[88:91], s65 offen lds
    s_add_u32 s65, s52, 0x64000
    s_add_u32 m0, s45, 25600
    s_nop 0
    buffer_load_dwordx4 v6, s[88:91], s65 offen lds
    s_add_u32 s65, s52, 0x68000
    s_add_u32 m0, s45, 26624
    s_nop 0
    buffer_load_dwordx4 v6, s[88:91], s65 offen lds
    s_add_u32 s65, s52, 0x6c000
    s_add_u32 m0, s45, 27648
    s_nop 0
    buffer_load_dwordx4 v6, s[88:91], s65 offen lds
    s_add_u32 s65, s52, 0x70000
    s_add_u32 m0, s45, 28672
    s_nop 0
    buffer_load_dwordx4 v6, s[88:91], s65 offen lds
    s_add_u32 s65, s52, 0x74000
    s_add_u32 m0, s45, 29696
    s_nop 0
    buffer_load_dwordx4 v6, s[88:91], s65 offen lds
    s_add_u32 s65, s52, 0x78000
    s_add_u32 m0, s45, 30720
    s_nop 0
    buffer_load_dwordx4 v6, s[88:91], s65 offen lds
    s_add_u32 s65, s52, 0x7c000
    s_add_u32 m0, s45, 31744
    s_nop 0
    buffer_load_dwordx4 v6, s[88:91], s65 offen lds
    s_mul_i32 s66, s3, 2304
    v_mul_u32_u24 v14, 144, v4
    v_lshl_add_u32 v14, v3, 4, v14
    v_add_u32 v9, s66, v14
    s_lshl_b32 s66, s3, 2
    v_add_u32 v15, s66, v3
    v_mul_u32_u24 v14, 144, v15
    v_lshl_add_u32 v10, v4, 3, v14
    v_lshlrev_b32 v14, 10, v15
    v_lshl_add_u32 v11, v4, 2, v14
    v_min_u32 v14, 54, v2
    v_lshlrev_b32 v12, 7, v14
    v_and_b32 v14, 7, v2
    v_lshlrev_b32 v13, 9, v14
    s_lshr_b32 s53, s44, 4
    s_waitcnt vmcnt(30)
    ds_read_b64_tr_b16 a[0:1], v7 offset:0
    ds_read_b64_tr_b16 a[2:3], v7 offset:1024
    ds_read_b64_tr_b16 a[4:5], v8 offset:0
    ds_read_b64_tr_b16 a[6:7], v8 offset:1024
    s_add_u32 s65, s52, 0x80000
    s_add_u32 m0, s45, 32768
    s_nop 0
    buffer_load_dwordx4 v6, s[88:91], s65 offen lds
    s_add_u32 s65, s52, 0x84000
    s_add_u32 m0, s45, 33792
    s_nop 0
    buffer_load_dwordx4 v6, s[88:91], s65 offen lds
    s_waitcnt vmcnt(30)
    ds_read_b64_tr_b16 a[8:9], v7 offset:2048
    ds_read_b64_tr_b16 a[10:11], v7 offset:3072
    ds_read_b64_tr_b16 a[12:13], v8 offset:2048
    ds_read_b64_tr_b16 a[14:15], v8 offset:3072
    s_add_u32 s65, s52, 0x88000
    s_add_u32 m0, s45, 34816
    s_nop 0
    buffer_load_dwordx4 v6, s[88:91], s65 offen lds
    s_add_u32 s65, s52, 0x8c000
    s_add_u32 m0, s45, 35840
    s_nop 0
    buffer_load_dwordx4 v6, s[88:91], s65 offen lds
    s_waitcnt vmcnt(30)
    ds_read_b64_tr_b16 a[16:17], v7 offset:4096
    ds_read_b64_tr_b16 a[18:19], v7 offset:5120
    ds_read_b64_tr_b16 a[20:21], v8 offset:4096
    ds_read_b64_tr_b16 a[22:23], v8 offset:5120
    s_add_u32 s65, s52, 0x90000
    s_add_u32 m0, s45, 36864
    s_nop 0
    buffer_load_dwordx4 v6, s[88:91], s65 offen lds
    s_add_u32 s65, s52, 0x94000
    s_add_u32 m0, s45, 37888
    s_nop 0
    buffer_load_dwordx4 v6, s[88:91], s65 offen lds
    s_waitcnt vmcnt(30)
    ds_read_b64_tr_b16 a[24:25], v7 offset:6144
    ds_read_b64_tr_b16 a[26:27], v7 offset:7168
    ds_read_b64_tr_b16 a[28:29], v8 offset:6144
    ds_read_b64_tr_b16 a[30:31], v8 offset:7168
    s_add_u32 s65, s52, 0x98000
    s_add_u32 m0, s45, 38912
    s_nop 0
    buffer_load_dwordx4 v6, s[88:91], s65 offen lds
    s_add_u32 s65, s52, 0x9c000
    s_add_u32 m0, s45, 39936
    s_nop 0
    buffer_load_dwordx4 v6, s[88:91], s65 offen lds
    s_waitcnt vmcnt(30)
    ds_read_b64_tr_b16 a[32:33], v7 offset:8192
    ds_read_b64_tr_b16 a[34:35], v7 offset:9216
    ds_read_b64_tr_b16 a[36:37], v8 offset:8192
    ds_read_b64_tr_b16 a[38:39], v8 offset:9216
    s_waitcnt lgkmcnt(15)
    s_add_u32 s65, s52, 0xa0000
    s_add_u32 m0, s45, 0
    s_nop 0
    buffer_load_dwordx4 v6, s[88:91], s65 offen lds
    s_add_u32 s65, s52, 0xa4000
    s_add_u32 m0, s45, 1024
    s_nop 0
    buffer_load_dwordx4 v6, s[88:91], s65 offen lds
    s_waitcnt vmcnt(30)
    ds_read_b64_tr_b16 a[40:41], v7 offset:10240
    ds_read_b64_tr_b16 a[42:43], v7 offset:11264
    ds_read_b64_tr_b16 a[44:45], v8 offset:10240
    ds_read_b64_tr_b16 a[46:47], v8 offset:11264
    s_waitcnt lgkmcnt(15)
    s_add_u32 s65, s52, 0xa8000
    s_add_u32 m0, s45, 2048
    s_nop 0
    buffer_load_dwordx4 v6, s[88:91], s65 offen lds
    s_add_u32 s65, s52, 0xac000
    s_add_u32 m0, s45, 3072
    s_nop 0
    buffer_load_dwordx4 v6, s[88:91], s65 offen lds
    s_waitcnt vmcnt(30)
    ds_read_b64_tr_b16 a[48:49], v7 offset:12288
    ds_read_b64_tr_b16 a[50:51], v7 offset:13312
    ds_read_b64_tr_b16 a[52:53], v8 offset:12288
    ds_read_b64_tr_b16 a[54:55], v8 offset:13312
    s_waitcnt lgkmcnt(15)
    s_add_u32 s65, s52, 0xb0000
    s_add_u32 m0, s45, 4096
    s_nop 0
    buffer_load_dwordx4 v6, s[88:91], s65 offen lds
    s_add_u32 s65, s52, 0xb4000
    s_add_u32 m0, s45, 5120
    s_nop 0
    buffer_load_dwordx4 v6, s[88:91], s65 offen lds
    s_waitcnt vmcnt(30)
    ds_read_b64_tr_b16 a[56:57], v7 offset:14336
    ds_read_b64_tr_b16 a[58:59], v7 offset:15360
    ds_read_b64_tr_b16 a[60:61], v8 offset:14336
    ds_read_b64_tr_b16 a[62:63], v8 offset:15360
    s_waitcnt lgkmcnt(15)
    s_add_u32 s65, s52, 0xb8000
    s_add_u32 m0, s45, 6144
    s_nop 0
    buffer_load_dwordx4 v6, s[88:91], s65 offen lds
    s_add_u32 s65, s52, 0xbc000
    s_add_u32 m0, s45, 7168
    s_nop 0
    buffer_load_dwordx4 v6, s[88:91], s65 offen lds
    s_waitcnt vmcnt(30)
    ds_read_b64_tr_b16 a[64:65], v7 offset:16384
    ds_read_b64_tr_b16 a[66:67], v7 offset:17408
    ds_read_b64_tr_b16 a[68:69], v8 offset:16384
    ds_read_b64_tr_b16 a[70:71], v8 offset:17408
    s_waitcnt lgkmcnt(15)
    s_add_u32 s65, s52, 0xc0000
    s_add_u32 m0, s45, 8192
    s_nop 0
    buffer_load_dwordx4 v6, s[88:91], s65 offen lds
    s_add_u32 s65, s52, 0xc4000
    s_add_u32 m0, s45, 9216
    s_nop 0
    buffer_load_dwordx4 v6, s[88:91], s65 offen lds
    s_waitcnt vmcnt(30)
    ds_read_b64_tr_b16 a[72:73], v7 offset:18432
    ds_read_b64_tr_b16 a[74:75], v7 offset:19456
    ds_read_b64_tr_b16 a[76:77], v8 offset:18432
    ds_read_b64_tr_b16 a[78:79], v8 offset:19456
    s_waitcnt lgkmcnt(15)
    s_add_u32 s65, s52, 0xc8000
    s_add_u32 m0, s45, 10240
    s_nop 0
    buffer_load_dwordx4 v6, s[88:91], s65 offen lds
    s_add_u32 s65, s52, 0xcc000
    s_add_u32 m0, s45, 11264
    s_nop 0
    buffer_load_dwordx4 v6, s[88:91], s65 offen lds
    s_waitcnt vmcnt(30)
    ds_read_b64_tr_b16 a[80:81], v7 offset:20480
    ds_read_b64_tr_b16 a[82:83], v7 offset:21504
    ds_read_b64_tr_b16 a[84:85], v8 offset:20480
    ds_read_b64_tr_b16 a[86:87], v8 offset:21504
    s_waitcnt lgkmcnt(15)
    s_add_u32 s65, s52, 0xd0000
    s_add_u32 m0, s45, 12288
    s_nop 0
    buffer_load_dwordx4 v6, s[88:91], s65 offen lds
    s_add_u32 s65, s52, 0xd4000
    s_add_u32 m0, s45, 13312
    s_nop 0
    buffer_load_dwordx4 v6, s[88:91], s65 offen lds
    s_waitcnt vmcnt(30)
    ds_read_b64_tr_b16 a[88:89], v7 offset:22528
    ds_read_b64_tr_b16 a[90:91], v7 offset:23552
    ds_read_b64_tr_b16 a[92:93], v8 offset:22528
    ds_read_b64_tr_b16 a[94:95], v8 offset:23552
    s_waitcnt lgkmcnt(15)
    s_add_u32 s65, s52, 0xd8000
    s_add_u32 m0, s45, 14336
    s_nop 0
    buffer_load_dwordx4 v6, s[88:91], s65 offen lds
    s_add_u32 s65, s52, 0xdc000
    s_add_u32 m0, s45, 15360
    s_nop 0
    buffer_load_dwordx4 v6, s[88:91], s65 offen lds
    s_waitcnt vmcnt(30)
    ds_read_b64_tr_b16 a[96:97], v7 offset:24576
    ds_read_b64_tr_b16 a[98:99], v7 offset:25600
    ds_read_b64_tr_b16 a[100:101], v8 offset:24576
    ds_read_b64_tr_b16 a[102:103], v8 offset:25600
    s_waitcnt lgkmcnt(15)
    s_add_u32 s65, s52, 0xe0000
    s_add_u32 m0, s45, 16384
    s_nop 0
    buffer_load_dwordx4 v6, s[88:91], s65 offen lds
    s_add_u32 s65, s52, 0xe4000
    s_add_u32 m0, s45, 17408
    s_nop 0
    buffer_load_dwordx4 v6, s[88:91], s65 offen lds
    s_waitcnt vmcnt(30)
    ds_read_b64_tr_b16 a[104:105], v7 offset:26624
    ds_read_b64_tr_b16 a[106:107], v7 offset:27648
    ds_read_b64_tr_b16 a[108:109], v8 offset:26624
    ds_read_b64_tr_b16 a[110:111], v8 offset:27648
    s_waitcnt lgkmcnt(15)
    s_add_u32 s65, s52, 0xe8000
    s_add_u32 m0, s45, 18432
    s_nop 0
    buffer_load_dwordx4 v6, s[88:91], s65 offen lds
    s_add_u32 s65, s52, 0xec000
    s_add_u32 m0, s45, 19456
    s_nop 0
    buffer_load_dwordx4 v6, s[88:91], s65 offen lds
    s_waitcnt vmcnt(30)
    ds_read_b64_tr_b16 a[112:113], v7 offset:28672
    ds_read_b64_tr_b16 a[114:115], v7 offset:29696
    ds_read_b64_tr_b16 a[116:117], v8 offset:28672
    ds_read_b64_tr_b16 a[118:119], v8 offset:29696
    s_waitcnt lgkmcnt(15)
    s_add_u32 s65, s52, 0xf0000
    s_add_u32 m0, s45, 20480
    s_nop 0
    buffer_load_dwordx4 v6, s[88:91], s65 offen lds
    s_add_u32 s65, s52, 0xf4000
    s_add_u32 m0, s45, 21504
    s_nop 0
    buffer_load_dwordx4 v6, s[88:91], s65 offen lds
    s_waitcnt vmcnt(30)
    ds_read_b64_tr_b16 a[120:121], v7 offset:30720
    ds_read_b64_tr_b16 a[122:123], v7 offset:31744
    ds_read_b64_tr_b16 a[124:125], v8 offset:30720
    ds_read_b64_tr_b16 a[126:127], v8 offset:31744
    s_waitcnt lgkmcnt(15)
    s_add_u32 s65, s52, 0xf8000
    s_add_u32 m0, s45, 22528
    s_nop 0
    buffer_load_dwordx4 v6, s[88:91], s65 offen lds
    s_add_u32 s65, s52, 0xfc000
    s_add_u32 m0, s45, 23552
    s_nop 0
    buffer_load_dwordx4 v6, s[88:91], s65 offen lds
    s_waitcnt vmcnt(30)
    ds_read_b64_tr_b16 a[128:129], v7 offset:32768
    ds_read_b64_tr_b16 a[130:131], v7 offset:33792
    ds_read_b64_tr_b16 a[132:133], v8 offset:32768
    ds_read_b64_tr_b16 a[134:135], v8 offset:33792
    s_waitcnt lgkmcnt(15)
    s_add_u32 s65, s51, 0x0
    s_add_u32 m0, s45, 24576
    s_nop 0
    buffer_load_dwordx4 v6, s[96:99], s65 offen lds
    s_add_u32 s65, s51, 0x4000
    s_add_u32 m0, s45, 25600
    s_nop 0
    buffer_load_dwordx4 v6, s[96:99], s65 offen lds
    s_waitcnt vmcnt(30)
    ds_read_b64_tr_b16 a[136:137], v7 offset:34816
    ds_read_b64_tr_b16 a[138:139], v7 offset:35840
    ds_read_b64_tr_b16 a[140:141], v8 offset:34816
    ds_read_b64_tr_b16 a[142:143], v8 offset:35840
    s_waitcnt lgkmcnt(15)
    s_add_u32 s65, s51, 0x8000
    s_add_u32 m0, s45, 26624
    s_nop 0
    buffer_load_dwordx4 v6, s[96:99], s65 offen lds
    s_add_u32 s65, s51, 0xc000
    s_add_u32 m0, s45, 27648
    s_nop 0
    buffer_load_dwordx4 v6, s[96:99], s65 offen lds
    s_waitcnt vmcnt(30)
    ds_read_b64_tr_b16 a[144:145], v7 offset:36864
    ds_read_b64_tr_b16 a[146:147], v7 offset:37888
    ds_read_b64_tr_b16 a[148:149], v8 offset:36864
    ds_read_b64_tr_b16 a[150:151], v8 offset:37888
    s_waitcnt lgkmcnt(15)
    s_add_u32 s65, s51, 0x10000
    s_add_u32 m0, s45, 28672
    s_nop 0
    buffer_load_dwordx4 v6, s[96:99], s65 offen lds
    s_add_u32 s65, s51, 0x14000
    s_add_u32 m0, s45, 29696
    s_nop 0
    buffer_load_dwordx4 v6, s[96:99], s65 offen lds
    s_waitcnt vmcnt(30)
    ds_read_b64_tr_b16 a[152:153], v7 offset:38912
    ds_read_b64_tr_b16 a[154:155], v7 offset:39936
    ds_read_b64_tr_b16 a[156:157], v8 offset:38912
    ds_read_b64_tr_b16 a[158:159], v8 offset:39936
    s_waitcnt lgkmcnt(15)
    s_add_u32 s65, s51, 0x18000
    s_add_u32 m0, s45, 30720
    s_nop 0
    buffer_load_dwordx4 v6, s[96:99], s65 offen lds
    s_add_u32 s65, s51, 0x1c000
    s_add_u32 m0, s45, 31744
    s_nop 0
    buffer_load_dwordx4 v6, s[96:99], s65 offen lds
    s_waitcnt vmcnt(30)
    ds_read_b64_tr_b16 a[160:161], v7 offset:0
    ds_read_b64_tr_b16 a[162:163], v7 offset:1024
    ds_read_b64_tr_b16 a[164:165], v8 offset:0
    ds_read_b64_tr_b16 a[166:167], v8 offset:1024
    s_waitcnt lgkmcnt(15)
    s_add_u32 s65, s51, 0x20000
    s_add_u32 m0, s45, 32768
    s_nop 0
    buffer_load_dwordx4 v6, s[96:99], s65 offen lds
    s_add_u32 s65, s51, 0x24000
    s_add_u32 m0, s45, 33792
    s_nop 0
    buffer_load_dwordx4 v6, s[96:99], s65 offen lds
    s_waitcnt vmcnt(30)
    ds_read_b64_tr_b16 a[168:169], v7 offset:2048
    ds_read_b64_tr_b16 a[170:171], v7 offset:3072
    ds_read_b64_tr_b16 a[172:173], v8 offset:2048
    ds_read_b64_tr_b16 a[174:175], v8 offset:3072
    s_waitcnt lgkmcnt(15)
    s_add_u32 s65, s51, 0x28000
    s_add_u32 m0, s45, 34816
    s_nop 0
    buffer_load_dwordx4 v6, s[96:99], s65 offen lds
    s_add_u32 s65, s51, 0x2c000
    s_add_u32 m0, s45, 35840
    s_nop 0
    buffer_load_dwordx4 v6, s[96:99], s65 offen lds
    s_waitcnt vmcnt(30)
    ds_read_b64_tr_b16 a[176:177], v7 offset:4096
    ds_read_b64_tr_b16 a[178:179], v7 offset:5120
    ds_read_b64_tr_b16 a[180:181], v8 offset:4096
    ds_read_b64_tr_b16 a[182:183], v8 offset:5120
    s_waitcnt lgkmcnt(15)
    s_add_u32 s65, s51, 0x30000
    s_add_u32 m0, s45, 36864
    s_nop 0
    buffer_load_dwordx4 v6, s[96:99], s65 offen lds
    s_add_u32 s65, s51, 0x34000
    s_add_u32 m0, s45, 37888
    s_nop 0
    buffer_load_dwordx4 v6, s[96:99], s65 offen lds
    s_waitcnt vmcnt(30)
    ds_read_b64_tr_b16 a[184:185], v7 offset:6144
    ds_read_b64_tr_b16 a[186:187], v7 offset:7168
    ds_read_b64_tr_b16 a[188:189], v8 offset:6144
    ds_read_b64_tr_b16 a[190:191], v8 offset:7168
    s_waitcnt lgkmcnt(15)
    s_add_u32 s65, s51, 0x38000
    s_add_u32 m0, s45, 38912
    s_nop 0
    buffer_load_dwordx4 v6, s[96:99], s65 offen lds
    s_add_u32 s65, s51, 0x3c000
    s_add_u32 m0, s45, 39936
    s_nop 0
    buffer_load_dwordx4 v6, s[96:99], s65 offen lds
    s_waitcnt vmcnt(30)
    ds_read_b64_tr_b16 a[192:193], v7 offset:8192
    ds_read_b64_tr_b16 a[194:195], v7 offset:9216
    ds_read_b64_tr_b16 a[196:197], v8 offset:8192
    ds_read_b64_tr_b16 a[198:199], v8 offset:9216
    s_waitcnt lgkmcnt(15)
    s_add_u32 s65, s51, 0x40000
    s_add_u32 m0, s45, 0
    s_nop 0
    buffer_load_dwordx4 v6, s[96:99], s65 offen lds
    s_add_u32 s65, s51, 0x44000
    s_add_u32 m0, s45, 1024
    s_nop 0
    buffer_load_dwordx4 v6, s[96:99], s65 offen lds
    s_waitcnt vmcnt(30)
    ds_read_b64_tr_b16 a[200:201], v7 offset:10240
    ds_read_b64_tr_b16 a[202:203], v7 offset:11264
    ds_read_b64_tr_b16 a[204:205], v8 offset:10240
    ds_read_b64_tr_b16 a[206:207], v8 offset:11264
    s_waitcnt lgkmcnt(15)
    s_add_u32 s65, s51, 0x48000
    s_add_u32 m0, s45, 2048
    s_nop 0
    buffer_load_dwordx4 v6, s[96:99], s65 offen lds
    s_add_u32 s65, s51, 0x4c000
    s_add_u32 m0, s45, 3072
    s_nop 0
    buffer_load_dwordx4 v6, s[96:99], s65 offen lds
    s_waitcnt vmcnt(30)
    ds_read_b64_tr_b16 a[208:209], v7 offset:12288
    ds_read_b64_tr_b16 a[210:211], v7 offset:13312
    ds_read_b64_tr_b16 a[212:213], v8 offset:12288
    ds_read_b64_tr_b16 a[214:215], v8 offset:13312
    s_waitcnt lgkmcnt(15)
    s_add_u32 s65, s51, 0x50000
    s_add_u32 m0, s45, 4096
    s_nop 0
    buffer_load_dwordx4 v6, s[96:99], s65 offen lds
    s_add_u32 s65, s51, 0x54000
    s_add_u32 m0, s45, 5120
    s_nop 0
    buffer_load_dwordx4 v6, s[96:99], s65 offen lds
    s_waitcnt vmcnt(30)
    ds_read_b64_tr_b16 a[216:217], v7 offset:14336
    ds_read_b64_tr_b16 a[218:219], v7 offset:15360
    ds_read_b64_tr_b16 a[220:221], v8 offset:14336
    ds_read_b64_tr_b16 a[222:223], v8 offset:15360
    s_waitcnt vmcnt(28)
    ds_read_b64_tr_b16 a[224:225], v7 offset:16384
    ds_read_b64_tr_b16 a[226:227], v7 offset:17408
    ds_read_b64_tr_b16 a[228:229], v8 offset:16384
    ds_read_b64_tr_b16 a[230:231], v8 offset:17408
    s_waitcnt vmcnt(26)
    ds_read_b64_tr_b16 a[232:233], v7 offset:18432
    ds_read_b64_tr_b16 a[234:235], v7 offset:19456
    ds_read_b64_tr_b16 a[236:237], v8 offset:18432
    ds_read_b64_tr_b16 a[238:239], v8 offset:19456
    s_waitcnt vmcnt(24)
    ds_read_b64_tr_b16 a[240:241], v7 offset:20480
    ds_read_b64_tr_b16 a[242:243], v7 offset:21504
    ds_read_b64_tr_b16 a[244:245], v8 offset:20480
    ds_read_b64_tr_b16 a[246:247], v8 offset:21504
    s_waitcnt vmcnt(22)
    ds_read_b64_tr_b16 a[248:249], v7 offset:22528
    ds_read_b64_tr_b16 a[250:251], v7 offset:23552
    ds_read_b64_tr_b16 a[252:253], v8 offset:22528
    ds_read_b64_tr_b16 a[254:255], v8 offset:23552
    s_waitcnt vmcnt(20)
    ds_read_b64_tr_b16 v[168:169], v7 offset:24576
    ds_read_b64_tr_b16 v[170:171], v7 offset:25600
    ds_read_b64_tr_b16 v[172:173], v8 offset:24576
    ds_read_b64_tr_b16 v[174:175], v8 offset:25600
    s_waitcnt vmcnt(18)
    ds_read_b64_tr_b16 v[176:177], v7 offset:26624
    ds_read_b64_tr_b16 v[178:179], v7 offset:27648
    ds_read_b64_tr_b16 v[180:181], v8 offset:26624
    ds_read_b64_tr_b16 v[182:183], v8 offset:27648
    s_waitcnt vmcnt(16)
    ds_read_b64_tr_b16 v[184:185], v7 offset:28672
    ds_read_b64_tr_b16 v[186:187], v7 offset:29696
    ds_read_b64_tr_b16 v[188:189], v8 offset:28672
    ds_read_b64_tr_b16 v[190:191], v8 offset:29696
    s_waitcnt vmcnt(14)
    ds_read_b64_tr_b16 v[192:193], v7 offset:30720
    ds_read_b64_tr_b16 v[194:195], v7 offset:31744
    ds_read_b64_tr_b16 v[196:197], v8 offset:30720
    ds_read_b64_tr_b16 v[198:199], v8 offset:31744
    s_waitcnt vmcnt(12)
    ds_read_b64_tr_b16 v[200:201], v7 offset:32768
    ds_read_b64_tr_b16 v[202:203], v7 offset:33792
    ds_read_b64_tr_b16 v[204:205], v8 offset:32768
    ds_read_b64_tr_b16 v[206:207], v8 offset:33792
    s_waitcnt vmcnt(10)
    ds_read_b64_tr_b16 v[208:209], v7 offset:34816
    ds_read_b64_tr_b16 v[210:211], v7 offset:35840
    ds_read_b64_tr_b16 v[212:213], v8 offset:34816
    ds_read_b64_tr_b16 v[214:215], v8 offset:35840
    s_waitcnt vmcnt(8)
    ds_read_b64_tr_b16 v[216:217], v7 offset:36864
    ds_read_b64_tr_b16 v[218:219], v7 offset:37888
    ds_read_b64_tr_b16 v[220:221], v8 offset:36864
    ds_read_b64_tr_b16 v[222:223], v8 offset:37888
    s_waitcnt vmcnt(6)
    ds_read_b64_tr_b16 v[224:225], v7 offset:38912
    ds_read_b64_tr_b16 v[226:227], v7 offset:39936
    ds_read_b64_tr_b16 v[228:229], v8 offset:38912
    ds_read_b64_tr_b16 v[230:231], v8 offset:39936
    s_waitcnt vmcnt(4)
    ds_read_b64_tr_b16 v[232:233], v7 offset:0
    ds_read_b64_tr_b16 v[234:235], v7 offset:1024
    ds_read_b64_tr_b16 v[236:237], v8 offset:0
    ds_read_b64_tr_b16 v[238:239], v8 offset:1024
    s_waitcnt vmcnt(2)
    ds_read_b64_tr_b16 v[240:241], v7 offset:2048
    ds_read_b64_tr_b16 v[242:243], v7 offset:3072
    ds_read_b64_tr_b16 v[244:245], v8 offset:2048
    ds_read_b64_tr_b16 v[246:247], v8 offset:3072
    s_waitcnt vmcnt(0)
    ds_read_b64_tr_b16 v[248:249], v7 offset:4096
    ds_read_b64_tr_b16 v[250:251], v7 offset:5120
    ds_read_b64_tr_b16 v[252:253], v8 offset:4096
    ds_read_b64_tr_b16 v[254:255], v8 offset:5120
    s_waitcnt vmcnt(0) lgkmcnt(0)
    s_barrier
    s_mov_b32 s66, 0xf5000
O_ph:
    buffer_load_dword v14, v12, s[4:7], s66 offen sc1
    buffer_load_dword v15, v12, s[4:7], s66 offen offset:2816 sc1
    s_sub_u32 s69, s69, 1
    s_cbranch_scc1 L_exit
    s_waitcnt vmcnt(0)
    v_min_u32 v14, v14, v15
    v_cmp_eq_u32 vcc, 0, v14
    s_cbranch_vccz O_ph_ok
    s_sleep 8
    s_branch O_ph
O_ph_ok:
    v_mov_b32 v162, -1
    v_mov_b32 v163, -1
    s_add_u32 s53, s53, 124
    s_mul_i32 s54, s53, 45056
    s_mul_i32 s65, s3, 11264
    s_add_u32 s54, s54, s65
    s_add_u32 s54, s54, 0x400000
    s_lshl_b32 s63, s53, 14
    s_add_u32 s63, s63, s58
    s_add_u32 s55, s54, 10240
    s_cmp_eq_u32 s3, 3
    s_cselect_b32 s55, 0x40000000, s55
    s_bfe_u32 s65, s53, 0x20001
    s_lshl_b32 s65, s65, 7
    s_lshl_b32 s66, s3, 12
    s_add_u32 s60, s65, s66
    s_add_u32 s60, s60, 0xf1000
    s_mov_b64 exec, 0xff
    buffer_load_dword v163, v13, s[4:7], s60 offen sc1
    s_mov_b64 exec, -1
    buffer_load_dword v160, v11, s[8:11], s63 offen
    buffer_load_dwordx4 v[24:27], v0, s[4:7], s54 offen offset:0 sc1
    buffer_load_dwordx4 v[28:31], v0, s[4:7], s54 offen offset:1024 sc1
    buffer_load_dwordx4 v[32:35], v0, s[4:7], s54 offen offset:2048 sc1
    buffer_load_dwordx4 v[36:39], v0, s[4:7], s54 offen offset:3072 sc1
    s_add_u32 s54, s54, 4096
    buffer_load_dwordx4 v[40:43], v0, s[4:7], s54 offen offset:0 sc1
    buffer_load_dwordx4 v[44:47], v0, s[4:7], s54 offen offset:1024 sc1
    buffer_load_dwordx4 v[48:51], v0, s[4:7], s54 offen offset:2048 sc1
    buffer_load_dwordx4 v[52:55], v0, s[4:7], s54 offen offset:3072 sc1
    s_add_u32 s54, s54, 4096
    buffer_load_dwordx4 v[56:59], v0, s[4:7], s54 offen offset:0 sc1
    buffer_load_dwordx4 v[60:63], v0, s[4:7], s54 offen offset:1024 sc1
    buffer_load_dwordx4 v[64:67], v0, s[4:7], s55 offen offset:0 sc1
    s_lshl_b32 s65, s3, 12
    s_add_u32 s65, s65, 0x8000
    v_add_u32 v5, s65, v0
    s_sub_u32 s53, s53, 124
    s_waitcnt vmcnt(10)
    v_mfma_f32_16x16x32_bf16 v[152:155], v[168:171], v[24:27], 0
    v_mfma_f32_16x16x32_bf16 v[156:159], v[172:175], v[24:27], 0
    s_waitcnt vmcnt(9)
    v_mfma_f32_16x16x32_bf16 v[152:155], v[176:179], v[28:31], v[152:155]
    v_mfma_f32_16x16x32_bf16 v[156:159], v[180:183], v[28:31], v[156:159]
    s_waitcnt vmcnt(8)
    v_mfma_f32_16x16x32_bf16 v[152:155], v[184:187], v[32:35], v[152:155]
    v_mfma_f32_16x16x32_bf16 v[156:159], v[188:191], v[32:35], v[156:159]
    s_waitcnt vmcnt(7)
    v_mfma_f32_16x16x32_bf16 v[152:155], v[192:195], v[36:39], v[152:155]
    v_mfma_f32_16x16x32_bf16 v[156:159], v[196:199], v[36:39], v[156:159]
    s_waitcnt vmcnt(6)
    v_mfma_f32_16x16x32_bf16 v[152:155], v[200:203], v[40:43], v[152:155]
    v_mfma_f32_16x16x32_bf16 v[156:159], v[204:207], v[40:43], v[156:159]
    s_waitcnt vmcnt(5)
    v_mfma_f32_16x16x32_bf16 v[152:155], v[208:211], v[44:47], v[152:155]
    v_mfma_f32_16x16x32_bf16 v[156:159], v[212:215], v[44:47], v[156:159]
    s_waitcnt vmcnt(4)
    v_mfma_f32_16x16x32_bf16 v[152:155], v[216:219], v[48:51], v[152:155]
    v_mfma_f32_16x16x32_bf16 v[156:159], v[220:223], v[48:51], v[156:159]
    s_waitcnt vmcnt(3)
    v_mfma_f32_16x16x32_bf16 v[152:155], v[224:227], v[52:55], v[152:155]
    v_mfma_f32_16x16x32_bf16 v[156:159], v[228:231], v[52:55], v[156:159]
    s_waitcnt vmcnt(2)
    v_mfma_f32_16x16x32_bf16 v[152:155], v[232:235], v[56:59], v[152:155]
    v_mfma_f32_16x16x32_bf16 v[156:159], v[236:239], v[56:59], v[156:159]
    s_waitcnt vmcnt(1)
    v_mfma_f32_16x16x32_bf16 v[152:155], v[240:243], v[60:63], v[152:155]
    v_mfma_f32_16x16x32_bf16 v[156:159], v[244:247], v[60:63], v[156:159]
    s_waitcnt vmcnt(0)
    v_mfma_f32_16x16x32_bf16 v[152:155], v[248:251], v[64:67], v[152:155]
    v_mfma_f32_16x16x32_bf16 v[156:159], v[252:255], v[64:67], v[156:159]
    ds_write_b32 v5, v160 offset:2048
    s_nop 6
    ds_write_b128 v5, v[152:155] offset:0
    ds_write_b128 v5, v[156:159] offset:1024
    s_waitcnt lgkmcnt(0)
    s_mul_i32 s54, s53, 45056
    s_mul_i32 s65, s3, 11264
    s_add_u32 s54, s54, s65
    s_add_u32 s54, s54, 0x400000
    s_lshl_b32 s63, s53, 14
    s_add_u32 s63, s63, s58
    s_add_u32 s55, s54, 10240
    s_cmp_eq_u32 s3, 3
    s_cselect_b32 s55, 0x40000000, s55
    s_bfe_u32 s65, s53, 0x20001
    s_lshl_b32 s65, s65, 7
    s_lshl_b32 s66, s3, 12
    s_add_u32 s60, s65, s66
    s_add_u32 s60, s60, 0xf1000
    s_mov_b64 exec, 0xff
    buffer_load_dword v163, v13, s[4:7], s60 offen sc1
    s_mov_b64 exec, -1
    buffer_load_dword v160, v11, s[8:11], s63 offen
    buffer_load_dwordx4 v[24:27], v0, s[4:7], s54 offen offset:0 sc1
    buffer_load_dwordx4 v[28:31], v0, s[4:7], s54 offen offset:1024 sc1
    buffer_load_dwordx4 v[32:35], v0, s[4:7], s54 offen offset:2048 sc1
    buffer_load_dwordx4 v[36:39], v0, s[4:7], s54 offen offset:3072 sc1
    s_add_u32 s54, s54, 4096
    buffer_load_dwordx4 v[40:43], v0, s[4:7], s54 offen offset:0 sc1
    buffer_load_dwordx4 v[44:47], v0, s[4:7], s54 offen offset:1024 sc1
    buffer_load_dwordx4 v[48:51], v0, s[4:7], s54 offen offset:2048 sc1
    buffer_load_dwordx4 v[52:55], v0, s[4:7], s54 offen offset:3072 sc1
    s_add_u32 s54, s54, 4096
    buffer_load_dwordx4 v[56:59], v0, s[4:7], s54 offen offset:0 sc1
    buffer_load_dwordx4 v[60:63], v0, s[4:7], s54 offen offset:1024 sc1
    buffer_load_dwordx4 v[64:67], v0, s[4:7], s55 offen offset:0 sc1
    s_mov_b64 exec, 0xff
    buffer_load_dword v162, v13, s[4:7], s60 offen sc1
    s_mov_b64 exec, -1
    s_waitcnt vmcnt(0)
O_task:
    s_lshl_b32 s56, s53, 17
    s_lshl_b32 s65, s3, 15
    s_add_u32 s56, s56, s65
    s_add_u32 s56, s56, 0x1000000
    s_lshr_b32 s57, s53, 3
    s_mov_b32 s62, s63
    s_waitcnt vmcnt(14)
    v_cmp_ge_u32 vcc, s57, v163
    s_waitcnt vmcnt(13)
    v_lshlrev_b32 v15, 16, v160
    v_and_b32 v16, 0xffff0000, v160
    s_cbranch_vccnz O_alt
O_main:
    buffer_load_dwordx4 v[68:71], v0, s[4:7], s56 offen offset:0 sc1
    s_waitcnt vmcnt(13)
    v_mfma_f32_16x16x32_bf16 v[152:155], v[168:171], v[24:27], 0
    v_mfma_f32_16x16x32_bf16 v[156:159], v[172:175], v[24:27], 0
    buffer_load_dwordx4 v[72:75], v0, s[4:7], s56 offen offset:1024 sc1
    s_waitcnt vmcnt(13)
    v_mfma_f32_16x16x32_bf16 v[152:155], v[176:179], v[28:31], v[152:155]
    v_mfma_f32_16x16x32_bf16 v[156:159], v[180:183], v[28:31], v[156:159]
    buffer_load_dwordx4 v[76:79], v0, s[4:7], s56 offen offset:2048 sc1
    s_waitcnt vmcnt(13)
    v_mfma_f32_16x16x32_bf16 v[152:155], v[184:187], v[32:35], v[152:155]
    v_mfma_f32_16x16x32_bf16 v[156:159], v[188:191], v[32:35], v[156:159]
    buffer_load_dwordx4 v[80:83], v0, s[4:7], s56 offen offset:3072 sc1
    s_waitcnt vmcnt(13)
    v_mfma_f32_16x16x32_bf16 v[152:155], v[192:195], v[36:39], v[152:155]
    v_mfma_f32_16x16x32_bf16 v[156:159], v[196:199], v[36:39], v[156:159]
    s_add_u32 s56, s56, 4096
    buffer_load_dwordx4 v[84:87], v0, s[4:7], s56 offen offset:0 sc1
    s_waitcnt vmcnt(13)
    v_mfma_f32_16x16x32_bf16 v[152:155], v[200:203], v[40:43], v[152:155]
    v_mfma_f32_16x16x32_bf16 v[156:159], v[204:207], v[40:43], v[156:159]
    buffer_load_dwordx4 v[88:91], v0, s[4:7], s56 offen offset:1024 sc1
    s_waitcnt vmcnt(13)
    v_mfma_f32_16x16x32_bf16 v[152:155], v[208:211], v[44:47], v[152:155]
    v_mfma_f32_16x16x32_bf16 v[156:159], v[212:215], v[44:47], v[156:159]
    buffer_load_dwordx4 v[92:95], v0, s[4:7], s56 offen offset:2048 sc1
    s_waitcnt vmcnt(13)
    v_mfma_f32_16x16x32_bf16 v[152:155], v[216:219], v[48:51], v[152:155]
    v_mfma_f32_16x16x32_bf16 v[156:159], v[220:223], v[48:51], v[156:159]
    buffer_load_dwordx4 v[96:99], v0, s[4:7], s56 offen offset:3072 sc1
    s_waitcnt vmcnt(13)
    v_mfma_f32_16x16x32_bf16 v[152:155], v[224:227], v[52:55], v[152:155]
    v_mfma_f32_16x16x32_bf16 v[156:159], v[228:231], v[52:55], v[156:159]
    s_add_u32 s56, s56, 4096
    buffer_load_dwordx4 v[100:103], v0, s[4:7], s56 offen offset:0 sc1
    s_waitcnt vmcnt(13)
    v_mfma_f32_16x16x32_bf16 v[152:155], v[232:235], v[56:59], v[152:155]
    v_mfma_f32_16x16x32_bf16 v[156:159], v[236:239], v[56:59], v[156:159]
    buffer_load_dwordx4 v[104:107], v0, s[4:7], s56 offen offset:1024 sc1
    s_waitcnt vmcnt(13)
    v_mfma_f32_16x16x32_bf16 v[152:155], v[240:243], v[60:63], v[152:155]
    v_mfma_f32_16x16x32_bf16 v[156:159], v[244:247], v[60:63], v[156:159]
    buffer_load_dwordx4 v[108:111], v0, s[4:7], s56 offen offset:2048 sc1
    s_waitcnt vmcnt(13)
    v_mfma_f32_16x16x32_bf16 v[152:155], v[248:251], v[64:67], v[152:155]
    v_mfma_f32_16x16x32_bf16 v[156:159], v[252:255], v[64:67], v[156:159]
    buffer_load_dwordx4 v[112:115], v0, s[4:7], s56 offen offset:3072 sc1
O_join:
    s_add_u32 s53, s53, 4
    s_cmp_ge_u32 s53, 124
    s_cbranch_scc1 O_last
    s_mul_i32 s54, s53, 45056
    s_mul_i32 s65, s3, 11264
    s_add_u32 s54, s54, s65
    s_add_u32 s54, s54, 0x400000
    s_lshl_b32 s63, s53, 14
    s_add_u32 s63, s63, s58
    s_add_u32 s55, s54, 10240
    s_cmp_eq_u32 s3, 3
    s_cselect_b32 s55, 0x40000000, s55
    s_bfe_u32 s65, s53, 0x20001
    s_lshl_b32 s65, s65, 7
    s_lshl_b32 s66, s3, 12
    s_add_u32 s60, s65, s66
    s_add_u32 s60, s60, 0xf1000
    s_waitcnt vmcnt(11)
    v_mfma_f32_16x16x32_bf16 v[152:155], a[0:3], v[68:71], v[152:155]
    v_mfma_f32_16x16x32_bf16 v[156:159], a[4:7], v[68:71], v[156:159]
    s_add_u32 s56, s56, 4096
    buffer_load_dwordx4 v[116:119], v0, s[4:7], s56 offen offset:0 sc1
    s_waitcnt vmcnt(11)
    v_mfma_f32_16x16x32_bf16 v[152:155], a[8:11], v[72:75], v[152:155]
    v_mfma_f32_16x16x32_bf16 v[156:159], a[12:15], v[72:75], v[156:159]
    buffer_load_dwordx4 v[120:123], v0, s[4:7], s56 offen offset:1024 sc1
    s_waitcnt vmcnt(11)
    v_mfma_f32_16x16x32_bf16 v[152:155], a[16:19], v[76:79], v[152:155]
    v_mfma_f32_16x16x32_bf16 v[156:159], a[20:23], v[76:79], v[156:159]
    buffer_load_dwordx4 v[124:127], v0, s[4:7], s56 offen offset:2048 sc1
    s_waitcnt vmcnt(11)
    v_mfma_f32_16x16x32_bf16 v[152:155], a[24:27], v[80:83], v[152:155]
    v_mfma_f32_16x16x32_bf16 v[156:159], a[28:31], v[80:83], v[156:159]
    buffer_load_dwordx4 v[128:131], v0, s[4:7], s56 offen offset:3072 sc1
    s_waitcnt vmcnt(11)
    v_mfma_f32_16x16x32_bf16 v[152:155], a[32:35], v[84:87], v[152:155]
    v_mfma_f32_16x16x32_bf16 v[156:159], a[36:39], v[84:87], v[156:159]
    s_add_u32 s56, s56, 4096
    buffer_load_dwordx4 v[132:135], v0, s[4:7], s56 offen offset:0 sc1
    s_waitcnt vmcnt(11)
    v_mfma_f32_16x16x32_bf16 v[152:155], a[40:43], v[88:91], v[152:155]
    v_mfma_f32_16x16x32_bf16 v[156:159], a[44:47], v[88:91], v[156:159]
    buffer_load_dwordx4 v[136:139], v0, s[4:7], s56 offen offset:1024 sc1
    s_waitcnt vmcnt(11)
    v_mfma_f32_16x16x32_bf16 v[152:155], a[48:51], v[92:95], v[152:155]
    v_mfma_f32_16x16x32_bf16 v[156:159], a[52:55], v[92:95], v[156:159]
    buffer_load_dwordx4 v[140:143], v0, s[4:7], s56 offen offset:2048 sc1
    s_waitcnt vmcnt(11)
    v_mfma_f32_16x16x32_bf16 v[152:155], a[56:59], v[96:99], v[152:155]
    v_mfma_f32_16x16x32_bf16 v[156:159], a[60:63], v[96:99], v[156:159]
    buffer_load_dwordx4 v[144:147], v0, s[4:7], s56 offen offset:3072 sc1
    s_waitcnt vmcnt(11)
    v_mfma_f32_16x16x32_bf16 v[152:155], a[64:67], v[100:103], v[152:155]
    v_mfma_f32_16x16x32_bf16 v[156:159], a[68:71], v[100:103], v[156:159]
    s_add_u32 s56, s56, 4096
    buffer_load_dwordx4 v[148:151], v0, s[4:7], s56 offen offset:0 sc1
    s_waitcnt vmcnt(11)
    v_mfma_f32_16x16x32_bf16 v[152:155], a[72:75], v[104:107], v[152:155]
    v_mfma_f32_16x16x32_bf16 v[156:159], a[76:79], v[104:107], v[156:159]
    buffer_load_dwordx4 v[68:71], v0, s[4:7], s56 offen offset:1024 sc1
    s_waitcnt vmcnt(11)
    v_mfma_f32_16x16x32_bf16 v[152:155], a[80:83], v[108:111], v[152:155]
    v_mfma_f32_16x16x32_bf16 v[156:159], a[84:87], v[108:111], v[156:159]
    buffer_load_dwordx4 v[72:75], v0, s[4:7], s56 offen offset:2048 sc1
    s_waitcnt vmcnt(11)
    v_mfma_f32_16x16x32_bf16 v[152:155], a[88:91], v[112:115], v[152:155]
    v_mfma_f32_16x16x32_bf16 v[156:159], a[92:95], v[112:115], v[156:159]
    buffer_load_dwordx4 v[76:79], v0, s[4:7], s56 offen offset:3072 sc1
    s_waitcnt vmcnt(11)
    v_mfma_f32_16x16x32_bf16 v[152:155], a[96:99], v[116:119], v[152:155]
    v_mfma_f32_16x16x32_bf16 v[156:159], a[100:103], v[116:119], v[156:159]
    s_add_u32 s56, s56, 4096
    buffer_load_dwordx4 v[80:83], v0, s[4:7], s56 offen offset:0 sc1
    s_waitcnt vmcnt(11)
    v_mfma_f32_16x16x32_bf16 v[152:155], a[104:107], v[120:123], v[152:155]
    v_mfma_f32_16x16x32_bf16 v[156:159], a[108:111], v[120:123], v[156:159]
    buffer_load_dwordx4 v[84:87], v0, s[4:7], s56 offen offset:1024 sc1
    s_waitcnt vmcnt(11)
    v_mfma_f32_16x16x32_bf16 v[152:155], a[112:115], v[124:127], v[152:155]
    v_mfma_f32_16x16x32_bf16 v[156:159], a[116:119], v[124:127], v[156:159]
    buffer_load_dwordx4 v[88:91], v0, s[4:7], s56 offen offset:2048 sc1
    s_waitcnt vmcnt(11)
    v_mfma_f32_16x16x32_bf16 v[152:155], a[120:123], v[128:131], v[152:155]
    v_mfma_f32_16x16x32_bf16 v[156:159], a[124:127], v[128:131], v[156:159]
    buffer_load_dwordx4 v[92:95], v0, s[4:7], s56 offen offset:3072 sc1
    s_waitcnt vmcnt(11)
    v_mfma_f32_16x16x32_bf16 v[152:155], a[128:131], v[132:135], v[152:155]
    v_mfma_f32_16x16x32_bf16 v[156:159], a[132:135], v[132:135], v[156:159]
    s_add_u32 s56, s56, 4096
    buffer_load_dwordx4 v[96:99], v0, s[4:7], s56 offen offset:0 sc1
    s_waitcnt vmcnt(11)
    v_mfma_f32_16x16x32_bf16 v[152:155], a[136:139], v[136:139], v[152:155]
    v_mfma_f32_16x16x32_bf16 v[156:159], a[140:143], v[136:139], v[156:159]
    buffer_load_dwordx4 v[100:103], v0, s[4:7], s56 offen offset:1024 sc1
    s_waitcnt vmcnt(11)
    v_mfma_f32_16x16x32_bf16 v[152:155], a[144:147], v[140:143], v[152:155]
    v_mfma_f32_16x16x32_bf16 v[156:159], a[148:151], v[140:143], v[156:159]
    buffer_load_dwordx4 v[104:107], v0, s[4:7], s56 offen offset:2048 sc1
    s_waitcnt vmcnt(11)
    v_mfma_f32_16x16x32_bf16 v[152:155], a[152:155], v[144:147], v[152:155]
    v_mfma_f32_16x16x32_bf16 v[156:159], a[156:159], v[144:147], v[156:159]
    buffer_load_dwordx4 v[108:111], v0, s[4:7], s56 offen offset:3072 sc1
    s_waitcnt vmcnt(11)
    v_mfma_f32_16x16x32_bf16 v[152:155], a[160:163], v[148:151], v[152:155]
    v_mfma_f32_16x16x32_bf16 v[156:159], a[164:167], v[148:151], v[156:159]
    s_mov_b64 exec, 0xff
    buffer_load_dword v163, v13, s[4:7], s60 offen sc1
    s_mov_b64 exec, -1
    buffer_load_dword v160, v11, s[8:11], s63 offen
    s_waitcnt vmcnt(12)
    v_mfma_f32_16x16x32_bf16 v[152:155], a[168:171], v[68:71], v[152:155]
    v_mfma_f32_16x16x32_bf16 v[156:159], a[172:175], v[68:71], v[156:159]
    buffer_load_dwordx4 v[24:27], v0, s[4:7], s54 offen offset:0 sc1
    s_waitcnt vmcnt(12)
    v_mfma_f32_16x16x32_bf16 v[152:155], a[176:179], v[72:75], v[152:155]
    v_mfma_f32_16x16x32_bf16 v[156:159], a[180:183], v[72:75], v[156:159]
    buffer_load_dwordx4 v[28:31], v0, s[4:7], s54 offen offset:1024 sc1
    s_waitcnt vmcnt(12)
    v_mfma_f32_16x16x32_bf16 v[152:155], a[184:187], v[76:79], v[152:155]
    v_mfma_f32_16x16x32_bf16 v[156:159], a[188:191], v[76:79], v[156:159]
    buffer_load_dwordx4 v[32:35], v0, s[4:7], s54 offen offset:2048 sc1
    s_waitcnt vmcnt(12)
    v_mfma_f32_16x16x32_bf16 v[152:155], a[192:195], v[80:83], v[152:155]
    v_mfma_f32_16x16x32_bf16 v[156:159], a[196:199], v[80:83], v[156:159]
    buffer_load_dwordx4 v[36:39], v0, s[4:7], s54 offen offset:3072 sc1
    s_waitcnt vmcnt(12)
    v_mfma_f32_16x16x32_bf16 v[152:155], a[200:203], v[84:87], v[152:155]
    v_mfma_f32_16x16x32_bf16 v[156:159], a[204:207], v[84:87], v[156:159]
    s_add_u32 s54, s54, 4096
    buffer_load_dwordx4 v[40:43], v0, s[4:7], s54 offen offset:0 sc1
    s_waitcnt vmcnt(12)
    v_mfma_f32_16x16x32_bf16 v[152:155], a[208:211], v[88:91], v[152:155]
    v_mfma_f32_16x16x32_bf16 v[156:159], a[212:215], v[88:91], v[156:159]
    buffer_load_dwordx4 v[44:47], v0, s[4:7], s54 offen offset:1024 sc1
    s_waitcnt vmcnt(12)
    v_mfma_f32_16x16x32_bf16 v[152:155], a[216:219], v[92:95], v[152:155]
    v_mfma_f32_16x16x32_bf16 v[156:159], a[220:223], v[92:95], v[156:159]
    buffer_load_dwordx4 v[48:51], v0, s[4:7], s54 offen offset:2048 sc1
    s_waitcnt vmcnt(12)
    v_mfma_f32_16x16x32_bf16 v[152:155], a[224:227], v[96:99], v[152:155]
    v_mfma_f32_16x16x32_bf16 v[156:159], a[228:231], v[96:99], v[156:159]
    buffer_load_dwordx4 v[52:55], v0, s[4:7], s54 offen offset:3072 sc1
    s_waitcnt vmcnt(12)
    v_mfma_f32_16x16x32_bf16 v[152:155], a[232:235], v[100:103], v[152:155]
    v_mfma_f32_16x16x32_bf16 v[156:159], a[236:239], v[100:103], v[156:159]
    s_add_u32 s54, s54, 4096
    buffer_load_dwordx4 v[56:59], v0, s[4:7], s54 offen offset:0 sc1
    s_waitcnt vmcnt(12)
    v_mfma_f32_16x16x32_bf16 v[152:155], a[240:243], v[104:107], v[152:155]
    v_mfma_f32_16x16x32_bf16 v[156:159], a[244:247], v[104:107], v[156:159]
    buffer_load_dwordx4 v[60:63], v0, s[4:7], s54 offen offset:1024 sc1
    s_waitcnt vmcnt(12)
    v_mfma_f32_16x16x32_bf16 v[152:155], a[248:251], v[108:111], v[152:155]
    v_mfma_f32_16x16x32_bf16 v[156:159], a[252:255], v[108:111], v[156:159]
    buffer_load_dwordx4 v[64:67], v0, s[4:7], s55 offen offset:0 sc1
    s_mov_b64 exec, 0xff
    buffer_load_dword v162, v13, s[4:7], s60 offen sc1
    s_mov_b64 exec, -1
    s_nop 4
    ds_write_b128 v9, v[152:155] offset:0
    ds_write_b128 v9, v[156:159] offset:64
    s_waitcnt lgkmcnt(0)
    s_barrier
    ds_read_b64 v[120:121], v10 offset:0
    ds_read_b64 v[122:123], v10 offset:2304
    ds_read_b64 v[124:125], v10 offset:4608
    ds_read_b64 v[126:127], v10 offset:6912
    v_xor_b32 v9, 0x4000, v9
    v_xor_b32 v10, 0x4000, v10
    s_waitcnt lgkmcnt(3)
    v_add_f32 v15, v15, v120
    v_add_f32 v16, v16, v121
    s_waitcnt lgkmcnt(2)
    v_add_f32 v15, v15, v122
    v_add_f32 v16, v16, v123
    s_waitcnt lgkmcnt(1)
    v_add_f32 v15, v15, v124
    v_add_f32 v16, v16, v125
    s_waitcnt lgkmcnt(0)
    v_add_f32 v15, v15, v126
    v_add_f32 v16, v16, v127
    v_cvt_pk_bf16_f32 v14, v15, v16
    buffer_store_dword v14, v11, s[92:95], s62 offen nt
    s_branch O_task
O_last:
    s_add_u32 s56, s56, 4096
    buffer_load_dwordx4 v[116:119], v0, s[4:7], s56 offen offset:0 sc1
    buffer_load_dwordx4 v[120:123], v0, s[4:7], s56 offen offset:1024 sc1
    buffer_load_dwordx4 v[124:127], v0, s[4:7], s56 offen offset:2048 sc1
    buffer_load_dwordx4 v[128:131], v0, s[4:7], s56 offen offset:3072 sc1
    s_add_u32 s56, s56, 4096
    buffer_load_dwordx4 v[132:135], v0, s[4:7], s56 offen offset:0 sc1
    buffer_load_dwordx4 v[136:139], v0, s[4:7], s56 offen offset:1024 sc1
    buffer_load_dwordx4 v[140:143], v0, s[4:7], s56 offen offset:2048 sc1
    buffer_load_dwordx4 v[144:147], v0, s[4:7], s56 offen offset:3072 sc1
    s_add_u32 s56, s56, 4096
    buffer_load_dwordx4 v[148:151], v0, s[4:7], s56 offen offset:0 sc1
    s_mul_i32 s54, s53, 45056
    s_mul_i32 s65, s3, 11264
    s_add_u32 s54, s54, s65
    s_add_u32 s54, s54, 0x400000
    s_lshl_b32 s63, s53, 14
    s_add_u32 s63, s63, s58
    s_add_u32 s55, s54, 10240
    s_cmp_eq_u32 s3, 3
    s_cselect_b32 s55, 0x40000000, s55
    s_bfe_u32 s65, s53, 0x20001
    s_lshl_b32 s65, s65, 7
    s_lshl_b32 s66, s3, 12
    s_add_u32 s60, s65, s66
    s_add_u32 s60, s60, 0xf1000
    s_mov_b32 s49, 0
    ds_write_b128 v5, v[152:155] offset:16384
    ds_write_b128 v5, v[156:159] offset:17408
    s_waitcnt vmcnt(20)
    v_mfma_f32_16x16x32_bf16 v[152:155], a[0:3], v[68:71], v[152:155]
    v_mfma_f32_16x16x32_bf16 v[156:159], a[4:7], v[68:71], v[156:159]
    buffer_load_dwordx4 v[68:71], v0, s[4:7], s56 offen offset:1024 sc1
    s_waitcnt vmcnt(20)
    v_mfma_f32_16x16x32_bf16 v[152:155], a[8:11], v[72:75], v[152:155]
    v_mfma_f32_16x16x32_bf16 v[156:159], a[12:15], v[72:75], v[156:159]
    buffer_load_dwordx4 v[72:75], v0, s[4:7], s56 offen offset:2048 sc1
    s_waitcnt vmcnt(20)
    v_mfma_f32_16x16x32_bf16 v[152:155], a[16:19], v[76:79], v[152:155]
    v_mfma_f32_16x16x32_bf16 v[156:159], a[20:23], v[76:79], v[156:159]
    buffer_load_dwordx4 v[76:79], v0, s[4:7], s56 offen offset:3072 sc1
    s_waitcnt vmcnt(20)
    v_mfma_f32_16x16x32_bf16 v[152:155], a[24:27], v[80:83], v[152:155]
    v_mfma_f32_16x16x32_bf16 v[156:159], a[28:31], v[80:83], v[156:159]
    s_add_u32 s56, s56, 4096
    buffer_load_dwordx4 v[80:83], v0, s[4:7], s56 offen offset:0 sc1
    s_waitcnt vmcnt(20)
    v_mfma_f32_16x16x32_bf16 v[152:155], a[32:35], v[84:87], v[152:155]
    v_mfma_f32_16x16x32_bf16 v[156:159], a[36:39], v[84:87], v[156:159]
    buffer_load_dwordx4 v[84:87], v0, s[4:7], s56 offen offset:1024 sc1
    s_waitcnt vmcnt(20)
    v_mfma_f32_16x16x32_bf16 v[152:155], a[40:43], v[88:91], v[152:155]
    v_mfma_f32_16x16x32_bf16 v[156:159], a[44:47], v[88:91], v[156:159]
    buffer_load_dwordx4 v[88:91], v0, s[4:7], s56 offen offset:2048 sc1
    s_waitcnt vmcnt(20)
    v_mfma_f32_16x16x32_bf16 v[152:155], a[48:51], v[92:95], v[152:155]
    v_mfma_f32_16x16x32_bf16 v[156:159], a[52:55], v[92:95], v[156:159]
    buffer_load_dwordx4 v[92:95], v0, s[4:7], s56 offen offset:3072 sc1
    s_waitcnt vmcnt(20)
    v_mfma_f32_16x16x32_bf16 v[152:155], a[56:59], v[96:99], v[152:155]
    v_mfma_f32_16x16x32_bf16 v[156:159], a[60:63], v[96:99], v[156:159]
    s_add_u32 s56, s56, 4096
    buffer_load_dwordx4 v[96:99], v0, s[4:7], s56 offen offset:0 sc1
    s_waitcnt vmcnt(20)
    v_mfma_f32_16x16x32_bf16 v[152:155], a[64:67], v[100:103], v[152:155]
    v_mfma_f32_16x16x32_bf16 v[156:159], a[68:71], v[100:103], v[156:159]
    buffer_load_dwordx4 v[100:103], v0, s[4:7], s56 offen offset:1024 sc1
    s_waitcnt vmcnt(20)
    v_mfma_f32_16x16x32_bf16 v[152:155], a[72:75], v[104:107], v[152:155]
    v_mfma_f32_16x16x32_bf16 v[156:159], a[76:79], v[104:107], v[156:159]
    buffer_load_dwordx4 v[104:107], v0, s[4:7], s56 offen offset:2048 sc1
    s_waitcnt vmcnt(20)
    v_mfma_f32_16x16x32_bf16 v[152:155], a[80:83], v[108:111], v[152:155]
    v_mfma_f32_16x16x32_bf16 v[156:159], a[84:87], v[108:111], v[156:159]
    buffer_load_dwordx4 v[108:111], v0, s[4:7], s56 offen offset:3072 sc1
    s_waitcnt vmcnt(20)
    v_mfma_f32_16x16x32_bf16 v[152:155], a[88:91], v[112:115], v[152:155]
    v_mfma_f32_16x16x32_bf16 v[156:159], a[92:95], v[112:115], v[156:159]
    s_waitcnt vmcnt(19)
    v_mfma_f32_16x16x32_bf16 v[152:155], a[96:99], v[116:119], v[152:155]
    v_mfma_f32_16x16x32_bf16 v[156:159], a[100:103], v[116:119], v[156:159]
    s_waitcnt vmcnt(18)
    v_mfma_f32_16x16x32_bf16 v[152:155], a[104:107], v[120:123], v[152:155]
    v_mfma_f32_16x16x32_bf16 v[156:159], a[108:111], v[120:123], v[156:159]
    s_waitcnt vmcnt(17)
    v_mfma_f32_16x16x32_bf16 v[152:155], a[112:115], v[124:127], v[152:155]
    v_mfma_f32_16x16x32_bf16 v[156:159], a[116:119], v[124:127], v[156:159]
    s_waitcnt vmcnt(16)
    v_mfma_f32_16x16x32_bf16 v[152:155], a[120:123], v[128:131], v[152:155]
    v_mfma_f32_16x16x32_bf16 v[156:159], a[124:127], v[128:131], v[156:159]
    s_waitcnt vmcnt(15)
    v_mfma_f32_16x16x32_bf16 v[152:155], a[128:131], v[132:135], v[152:155]
    v_mfma_f32_16x16x32_bf16 v[156:159], a[132:135], v[132:135], v[156:159]
    s_waitcnt vmcnt(14)
    v_mfma_f32_16x16x32_bf16 v[152:155], a[136:139], v[136:139], v[152:155]
    v_mfma_f32_16x16x32_bf16 v[156:159], a[140:143], v[136:139], v[156:159]
    s_waitcnt vmcnt(13)
    v_mfma_f32_16x16x32_bf16 v[152:155], a[144:147], v[140:143], v[152:155]
    v_mfma_f32_16x16x32_bf16 v[156:159], a[148:151], v[140:143], v[156:159]
    s_waitcnt vmcnt(12)
    v_mfma_f32_16x16x32_bf16 v[152:155], a[152:155], v[144:147], v[152:155]
    v_mfma_f32_16x16x32_bf16 v[156:159], a[156:159], v[144:147], v[156:159]
    s_waitcnt vmcnt(11)
    v_mfma_f32_16x16x32_bf16 v[152:155], a[160:163], v[148:151], v[152:155]
    v_mfma_f32_16x16x32_bf16 v[156:159], a[164:167], v[148:151], v[156:159]
    s_waitcnt vmcnt(10)
    v_mfma_f32_16x16x32_bf16 v[152:155], a[168:171], v[68:71], v[152:155]
    v_mfma_f32_16x16x32_bf16 v[156:159], a[172:175], v[68:71], v[156:159]
    s_waitcnt vmcnt(9)
    v_mfma_f32_16x16x32_bf16 v[152:155], a[176:179], v[72:75], v[152:155]
    v_mfma_f32_16x16x32_bf16 v[156:159], a[180:183], v[72:75], v[156:159]
    s_waitcnt vmcnt(8)
    v_mfma_f32_16x16x32_bf16 v[152:155], a[184:187], v[76:79], v[152:155]
    v_mfma_f32_16x16x32_bf16 v[156:159], a[188:191], v[76:79], v[156:159]
    s_waitcnt vmcnt(7)
    v_mfma_f32_16x16x32_bf16 v[152:155], a[192:195], v[80:83], v[152:155]
    v_mfma_f32_16x16x32_bf16 v[156:159], a[196:199], v[80:83], v[156:159]
    s_waitcnt vmcnt(6)
    v_mfma_f32_16x16x32_bf16 v[152:155], a[200:203], v[84:87], v[152:155]
    v_mfma_f32_16x16x32_bf16 v[156:159], a[204:207], v[84:87], v[156:159]
    s_waitcnt vmcnt(5)
    v_mfma_f32_16x16x32_bf16 v[152:155], a[208:211], v[88:91], v[152:155]
    v_mfma_f32_16x16x32_bf16 v[156:159], a[212:215], v[88:91], v[156:159]
    s_waitcnt vmcnt(4)
    v_mfma_f32_16x16x32_bf16 v[152:155], a[216:219], v[92:95], v[152:155]
    v_mfma_f32_16x16x32_bf16 v[156:159], a[220:223], v[92:95], v[156:159]
    s_waitcnt vmcnt(3)
    v_mfma_f32_16x16x32_bf16 v[152:155], a[224:227], v[96:99], v[152:155]
    v_mfma_f32_16x16x32_bf16 v[156:159], a[228:231], v[96:99], v[156:159]
    s_waitcnt vmcnt(2)
    v_mfma_f32_16x16x32_bf16 v[152:155], a[232:235], v[100:103], v[152:155]
    v_mfma_f32_16x16x32_bf16 v[156:159], a[236:239], v[100:103], v[156:159]
    s_waitcnt vmcnt(1)
    v_mfma_f32_16x16x32_bf16 v[152:155], a[240:243], v[104:107], v[152:155]
    v_mfma_f32_16x16x32_bf16 v[156:159], a[244:247], v[104:107], v[156:159]
    s_waitcnt vmcnt(0)
    v_mfma_f32_16x16x32_bf16 v[152:155], a[248:251], v[108:111], v[152:155]
    v_mfma_f32_16x16x32_bf16 v[156:159], a[252:255], v[108:111], v[156:159]
    s_mov_b64 exec, 0xff
    buffer_load_dword v162, v13, s[4:7], s60 offen sc1
    s_mov_b64 exec, -1
    s_nop 4
O_red:
    ds_write_b128 v9, v[152:155] offset:0
    ds_write_b128 v9, v[156:159] offset:64
    v_cmp_u_f32 vcc, v152, v152
    s_cbranch_vccnz O_nan
O_nan_ok:
    s_waitcnt lgkmcnt(0)
    s_barrier
    ds_read_b64 v[120:121], v10 offset:0
    ds_read_b64 v[122:123], v10 offset:2304
    ds_read_b64 v[124:125], v10 offset:4608
    ds_read_b64 v[126:127], v10 offset:6912
    v_xor_b32 v9, 0x4000, v9
    v_xor_b32 v10, 0x4000, v10
    s_waitcnt lgkmcnt(3)
    v_add_f32 v15, v15, v120
    v_add_f32 v16, v16, v121
    s_waitcnt lgkmcnt(2)
    v_add_f32 v15, v15, v122
    v_add_f32 v16, v16, v123
    s_waitcnt lgkmcnt(1)
    v_add_f32 v15, v15, v124
    v_add_f32 v16, v16, v125
    s_waitcnt lgkmcnt(0)
    v_add_f32 v15, v15, v126
    v_add_f32 v16, v16, v127
    v_cvt_pk_bf16_f32 v14, v15, v16
    buffer_store_dword v14, v11, s[92:95], s62 offen nt
    s_cmp_ge_u32 s53, 128
    s_cbranch_scc1 L_exit
    ds_read_b128 v[152:155], v5 offset:0
    ds_read_b128 v[156:159], v5 offset:1024
    ds_read_b32 v160, v5 offset:2048
    s_lshl_b32 s56, s53, 17
    s_lshl_b32 s65, s3, 15
    s_add_u32 s56, s56, s65
    s_add_u32 s56, s56, 0x1000000
    s_lshr_b32 s57, s53, 3
    s_mov_b32 s62, s63
    s_waitcnt vmcnt(1)
    v_cmp_ge_u32 vcc, s57, v162
    s_waitcnt lgkmcnt(0)
    v_lshlrev_b32 v15, 16, v160
    v_and_b32 v16, 0xffff0000, v160
    s_cbranch_vccz O_po_ok
    s_branch O_po
O_alt:
    s_waitcnt vmcnt(1)
    v_cmp_ge_u32 vcc, s57, v162
    s_cbranch_vccz O_main
    s_mov_b64 exec, 0xff
    buffer_load_dword v162, v13, s[4:7], s60 offen sc1
    s_mov_b64 exec, -1
    v_mfma_f32_16x16x32_bf16 v[152:155], v[168:171], v[24:27], 0
    v_mfma_f32_16x16x32_bf16 v[156:159], v[172:175], v[24:27], 0
    v_mfma_f32_16x16x32_bf16 v[152:155], v[176:179], v[28:31], v[152:155]
    v_mfma_f32_16x16x32_bf16 v[156:159], v[180:183], v[28:31], v[156:159]
    v_mfma_f32_16x16x32_bf16 v[152:155], v[184:187], v[32:35], v[152:155]
    v_mfma_f32_16x16x32_bf16 v[156:159], v[188:191], v[32:35], v[156:159]
    v_mfma_f32_16x16x32_bf16 v[152:155], v[192:195], v[36:39], v[152:155]
    v_mfma_f32_16x16x32_bf16 v[156:159], v[196:199], v[36:39], v[156:159]
    v_mfma_f32_16x16x32_bf16 v[152:155], v[200:203], v[40:43], v[152:155]
    v_mfma_f32_16x16x32_bf16 v[156:159], v[204:207], v[40:43], v[156:159]
    v_mfma_f32_16x16x32_bf16 v[152:155], v[208:211], v[44:47], v[152:155]
    v_mfma_f32_16x16x32_bf16 v[156:159], v[212:215], v[44:47], v[156:159]
    v_mfma_f32_16x16x32_bf16 v[152:155], v[216:219], v[48:51], v[152:155]
    v_mfma_f32_16x16x32_bf16 v[156:159], v[220:223], v[48:51], v[156:159]
    v_mfma_f32_16x16x32_bf16 v[152:155], v[224:227], v[52:55], v[152:155]
    v_mfma_f32_16x16x32_bf16 v[156:159], v[228:231], v[52:55], v[156:159]
    v_mfma_f32_16x16x32_bf16 v[152:155], v[232:235], v[56:59], v[152:155]
    v_mfma_f32_16x16x32_bf16 v[156:159], v[236:239], v[56:59], v[156:159]
    v_mfma_f32_16x16x32_bf16 v[152:155], v[240:243], v[60:63], v[152:155]
    v_mfma_f32_16x16x32_bf16 v[156:159], v[244:247], v[60:63], v[156:159]
    v_mfma_f32_16x16x32_bf16 v[152:155], v[248:251], v[64:67], v[152:155]
    v_mfma_f32_16x16x32_bf16 v[156:159], v[252:255], v[64:67], v[156:159]
    s_branch O_pw
O_po:
    s_mov_b64 exec, 0xff
    buffer_load_dword v162, v13, s[4:7], s60 offen sc1
    s_mov_b64 exec, -1
    s_sub_u32 s69, s69, 1
    s_cbranch_scc1 L_exit
O_pw:
    s_waitcnt vmcnt(0)
    v_cmp_ge_u32 vcc, s57, v162
    s_cbranch_vccz O_po_ok
    s_sleep 1
    s_cmp_ge_u32 s53, 116
    s_cbranch_scc1 O_po
    s_sleep 2
    s_branch O_po
O_po_ok:
    buffer_load_dwordx4 v[68:71], v0, s[4:7], s56 offen offset:0 sc1
    buffer_load_dwordx4 v[72:75], v0, s[4:7], s56 offen offset:1024 sc1
    buffer_load_dwordx4 v[76:79], v0, s[4:7], s56 offen offset:2048 sc1
    buffer_load_dwordx4 v[80:83], v0, s[4:7], s56 offen offset:3072 sc1
    s_add_u32 s56, s56, 4096
    buffer_load_dwordx4 v[84:87], v0, s[4:7], s56 offen offset:0 sc1
    buffer_load_dwordx4 v[88:91], v0, s[4:7], s56 offen offset:1024 sc1
    buffer_load_dwordx4 v[92:95], v0, s[4:7], s56 offen offset:2048 sc1
    buffer_load_dwordx4 v[96:99], v0, s[4:7], s56 offen offset:3072 sc1
    s_add_u32 s56, s56, 4096
    buffer_load_dwordx4 v[100:103], v0, s[4:7], s56 offen offset:0 sc1
    buffer_load_dwordx4 v[104:107], v0, s[4:7], s56 offen offset:1024 sc1
    buffer_load_dwordx4 v[108:111], v0, s[4:7], s56 offen offset:2048 sc1
    buffer_load_dwordx4 v[112:115], v0, s[4:7], s56 offen offset:3072 sc1
    s_branch O_join
O_nan:
    s_cmp_lg_u32 s49, 0
    s_cbranch_scc1 O_nan_ok
    s_mov_b32 s49, 1
O_nan1:
    s_sub_u32 s56, s56, 28672
    buffer_load_dwordx4 v[24:27], v0, s[4:7], s56 offen offset:0 sc1
    buffer_load_dwordx4 v[28:31], v0, s[4:7], s56 offen offset:1024 sc1
    buffer_load_dwordx4 v[32:35], v0, s[4:7], s56 offen offset:2048 sc1
    buffer_load_dwordx4 v[36:39], v0, s[4:7], s56 offen offset:3072 sc1
    s_add_u32 s56, s56, 4096
    buffer_load_dwordx4 v[40:43], v0, s[4:7], s56 offen offset:0 sc1
    buffer_load_dwordx4 v[44:47], v0, s[4:7], s56 offen offset:1024 sc1
    buffer_load_dwordx4 v[48:51], v0, s[4:7], s56 offen offset:2048 sc1
    buffer_load_dwordx4 v[52:55], v0, s[4:7], s56 offen offset:3072 sc1
    s_add_u32 s56, s56, 4096
    buffer_load_dwordx4 v[56:59], v0, s[4:7], s56 offen offset:0 sc1
    buffer_load_dwordx4 v[60:63], v0, s[4:7], s56 offen offset:1024 sc1
    buffer_load_dwordx4 v[64:67], v0, s[4:7], s56 offen offset:2048 sc1
    buffer_load_dwordx4 v[68:71], v0, s[4:7], s56 offen offset:3072 sc1
    s_add_u32 s56, s56, 4096
    buffer_load_dwordx4 v[72:75], v0, s[4:7], s56 offen offset:0 sc1
    buffer_load_dwordx4 v[76:79], v0, s[4:7], s56 offen offset:1024 sc1
    buffer_load_dwordx4 v[80:83], v0, s[4:7], s56 offen offset:2048 sc1
    buffer_load_dwordx4 v[84:87], v0, s[4:7], s56 offen offset:3072 sc1
    s_add_u32 s56, s56, 4096
    buffer_load_dwordx4 v[88:91], v0, s[4:7], s56 offen offset:0 sc1
    buffer_load_dwordx4 v[92:95], v0, s[4:7], s56 offen offset:1024 sc1
    buffer_load_dwordx4 v[96:99], v0, s[4:7], s56 offen offset:2048 sc1
    buffer_load_dwordx4 v[100:103], v0, s[4:7], s56 offen offset:3072 sc1
    s_add_u32 s56, s56, 4096
    buffer_load_dwordx4 v[104:107], v0, s[4:7], s56 offen offset:0 sc1
    buffer_load_dwordx4 v[108:111], v0, s[4:7], s56 offen offset:1024 sc1
    buffer_load_dwordx4 v[112:115], v0, s[4:7], s56 offen offset:2048 sc1
    buffer_load_dwordx4 v[116:119], v0, s[4:7], s56 offen offset:3072 sc1
    s_add_u32 s56, s56, 4096
    buffer_load_dwordx4 v[120:123], v0, s[4:7], s56 offen offset:0 sc1
    buffer_load_dwordx4 v[124:127], v0, s[4:7], s56 offen offset:1024 sc1
    buffer_load_dwordx4 v[128:131], v0, s[4:7], s56 offen offset:2048 sc1
    buffer_load_dwordx4 v[132:135], v0, s[4:7], s56 offen offset:3072 sc1
    s_add_u32 s56, s56, 4096
    buffer_load_dwordx4 v[136:139], v0, s[4:7], s56 offen offset:0 sc1
    buffer_load_dwordx4 v[140:143], v0, s[4:7], s56 offen offset:1024 sc1
    buffer_load_dwordx4 v[144:147], v0, s[4:7], s56 offen offset:2048 sc1
    buffer_load_dwordx4 v[148:151], v0, s[4:7], s56 offen offset:3072 sc1
    ds_read_b128 v[152:155], v5 offset:16384
    ds_read_b128 v[156:159], v5 offset:17408
    s_sub_u32 s69, s69, 1
    s_cbranch_scc1 L_exit
    s_waitcnt vmcnt(0) lgkmcnt(0)
    v_max_u32 v14, v24, v25
    v_max3_u32 v14, v14, v26, v27
    v_max3_u32 v14, v14, v28, v29
    v_max3_u32 v14, v14, v30, v31
    v_max3_u32 v14, v14, v32, v33
    v_max3_u32 v14, v14, v34, v35
    v_max3_u32 v14, v14, v36, v37
    v_max3_u32 v14, v14, v38, v39
    v_max3_u32 v14, v14, v40, v41
    v_max3_u32 v14, v14, v42, v43
    v_max3_u32 v14, v14, v44, v45
    v_max3_u32 v14, v14, v46, v47
    v_max3_u32 v14, v14, v48, v49
    v_max3_u32 v14, v14, v50, v51
    v_max3_u32 v14, v14, v52, v53
    v_max3_u32 v14, v14, v54, v55
    v_max3_u32 v14, v14, v56, v57
    v_max3_u32 v14, v14, v58, v59
    v_max3_u32 v14, v14, v60, v61
    v_max3_u32 v14, v14, v62, v63
    v_max3_u32 v14, v14, v64, v65
    v_max3_u32 v14, v14, v66, v67
    v_max3_u32 v14, v14, v68, v69
    v_max3_u32 v14, v14, v70, v71
    v_max3_u32 v14, v14, v72, v73
    v_max3_u32 v14, v14, v74, v75
    v_max3_u32 v14, v14, v76, v77
    v_max3_u32 v14, v14, v78, v79
    v_max3_u32 v14, v14, v80, v81
    v_max3_u32 v14, v14, v82, v83
    v_max3_u32 v14, v14, v84, v85
    v_max3_u32 v14, v14, v86, v87
    v_max3_u32 v14, v14, v88, v89
    v_max3_u32 v14, v14, v90, v91
    v_max3_u32 v14, v14, v92, v93
    v_max3_u32 v14, v14, v94, v95
    v_max3_u32 v14, v14, v96, v97
    v_max3_u32 v14, v14, v98, v99
    v_max3_u32 v14, v14, v100, v101
    v_max3_u32 v14, v14, v102, v103
    v_max3_u32 v14, v14, v104, v105
    v_max3_u32 v14, v14, v106, v107
    v_max3_u32 v14, v14, v108, v109
    v_max3_u32 v14, v14, v110, v111
    v_max3_u32 v14, v14, v112, v113
    v_max3_u32 v14, v14, v114, v115
    v_max3_u32 v14, v14, v116, v117
    v_max3_u32 v14, v14, v118, v119
    v_max3_u32 v14, v14, v120, v121
    v_max3_u32 v14, v14, v122, v123
    v_max3_u32 v14, v14, v124, v125
    v_max3_u32 v14, v14, v126, v127
    v_max3_u32 v14, v14, v128, v129
    v_max3_u32 v14, v14, v130, v131
    v_max3_u32 v14, v14, v132, v133
    v_max3_u32 v14, v14, v134, v135
    v_max3_u32 v14, v14, v136, v137
    v_max3_u32 v14, v14, v138, v139
    v_max3_u32 v14, v14, v140, v141
    v_max3_u32 v14, v14, v142, v143
    v_max3_u32 v14, v14, v144, v145
    v_max3_u32 v14, v14, v146, v147
    v_max3_u32 v14, v14, v148, v149
    v_max3_u32 v14, v14, v150, v151
    v_cmp_eq_u32 vcc, -1, v14
    s_cbranch_vccnz O_nan1
    v_mfma_f32_16x16x32_bf16 v[152:155], a[0:3], v[24:27], v[152:155]
    v_mfma_f32_16x16x32_bf16 v[156:159], a[4:7], v[24:27], v[156:159]
    v_mfma_f32_16x16x32_bf16 v[152:155], a[8:11], v[28:31], v[152:155]
    v_mfma_f32_16x16x32_bf16 v[156:159], a[12:15], v[28:31], v[156:159]
    v_mfma_f32_16x16x32_bf16 v[152:155], a[16:19], v[32:35], v[152:155]
    v_mfma_f32_16x16x32_bf16 v[156:159], a[20:23], v[32:35], v[156:159]
    v_mfma_f32_16x16x32_bf16 v[152:155], a[24:27], v[36:39], v[152:155]
    v_mfma_f32_16x16x32_bf16 v[156:159], a[28:31], v[36:39], v[156:159]
    v_mfma_f32_16x16x32_bf16 v[152:155], a[32:35], v[40:43], v[152:155]
    v_mfma_f32_16x16x32_bf16 v[156:159], a[36:39], v[40:43], v[156:159]
    v_mfma_f32_16x16x32_bf16 v[152:155], a[40:43], v[44:47], v[152:155]
    v_mfma_f32_16x16x32_bf16 v[156:159], a[44:47], v[44:47], v[156:159]
    v_mfma_f32_16x16x32_bf16 v[152:155], a[48:51], v[48:51], v[152:155]
    v_mfma_f32_16x16x32_bf16 v[156:159], a[52:55], v[48:51], v[156:159]
    v_mfma_f32_16x16x32_bf16 v[152:155], a[56:59], v[52:55], v[152:155]
    v_mfma_f32_16x16x32_bf16 v[156:159], a[60:63], v[52:55], v[156:159]
    v_mfma_f32_16x16x32_bf16 v[152:155], a[64:67], v[56:59], v[152:155]
    v_mfma_f32_16x16x32_bf16 v[156:159], a[68:71], v[56:59], v[156:159]
    v_mfma_f32_16x16x32_bf16 v[152:155], a[72:75], v[60:63], v[152:155]
    v_mfma_f32_16x16x32_bf16 v[156:159], a[76:79], v[60:63], v[156:159]
    v_mfma_f32_16x16x32_bf16 v[152:155], a[80:83], v[64:67], v[152:155]
    v_mfma_f32_16x16x32_bf16 v[156:159], a[84:87], v[64:67], v[156:159]
    v_mfma_f32_16x16x32_bf16 v[152:155], a[88:91], v[68:71], v[152:155]
    v_mfma_f32_16x16x32_bf16 v[156:159], a[92:95], v[68:71], v[156:159]
    v_mfma_f32_16x16x32_bf16 v[152:155], a[96:99], v[72:75], v[152:155]
    v_mfma_f32_16x16x32_bf16 v[156:159], a[100:103], v[72:75], v[156:159]
    v_mfma_f32_16x16x32_bf16 v[152:155], a[104:107], v[76:79], v[152:155]
    v_mfma_f32_16x16x32_bf16 v[156:159], a[108:111], v[76:79], v[156:159]
    v_mfma_f32_16x16x32_bf16 v[152:155], a[112:115], v[80:83], v[152:155]
    v_mfma_f32_16x16x32_bf16 v[156:159], a[116:119], v[80:83], v[156:159]
    v_mfma_f32_16x16x32_bf16 v[152:155], a[120:123], v[84:87], v[152:155]
    v_mfma_f32_16x16x32_bf16 v[156:159], a[124:127], v[84:87], v[156:159]
    v_mfma_f32_16x16x32_bf16 v[152:155], a[128:131], v[88:91], v[152:155]
    v_mfma_f32_16x16x32_bf16 v[156:159], a[132:135], v[88:91], v[156:159]
    v_mfma_f32_16x16x32_bf16 v[152:155], a[136:139], v[92:95], v[152:155]
    v_mfma_f32_16x16x32_bf16 v[156:159], a[140:143], v[92:95], v[156:159]
    v_mfma_f32_16x16x32_bf16 v[152:155], a[144:147], v[96:99], v[152:155]
    v_mfma_f32_16x16x32_bf16 v[156:159], a[148:151], v[96:99], v[156:159]
    v_mfma_f32_16x16x32_bf16 v[152:155], a[152:155], v[100:103], v[152:155]
    v_mfma_f32_16x16x32_bf16 v[156:159], a[156:159], v[100:103], v[156:159]
    v_mfma_f32_16x16x32_bf16 v[152:155], a[160:163], v[104:107], v[152:155]
    v_mfma_f32_16x16x32_bf16 v[156:159], a[164:167], v[104:107], v[156:159]
    v_mfma_f32_16x16x32_bf16 v[152:155], a[168:171], v[108:111], v[152:155]
    v_mfma_f32_16x16x32_bf16 v[156:159], a[172:175], v[108:111], v[156:159]
    v_mfma_f32_16x16x32_bf16 v[152:155], a[176:179], v[112:115], v[152:155]
    v_mfma_f32_16x16x32_bf16 v[156:159], a[180:183], v[112:115], v[156:159]
    v_mfma_f32_16x16x32_bf16 v[152:155], a[184:187], v[116:119], v[152:155]
    v_mfma_f32_16x16x32_bf16 v[156:159], a[188:191], v[116:119], v[156:159]
    v_mfma_f32_16x16x32_bf16 v[152:155], a[192:195], v[120:123], v[152:155]
    v_mfma_f32_16x16x32_bf16 v[156:159], a[196:199], v[120:123], v[156:159]
    v_mfma_f32_16x16x32_bf16 v[152:155], a[200:203], v[124:127], v[152:155]
    v_mfma_f32_16x16x32_bf16 v[156:159], a[204:207], v[124:127], v[156:159]
    v_mfma_f32_16x16x32_bf16 v[152:155], a[208:211], v[128:131], v[152:155]
    v_mfma_f32_16x16x32_bf16 v[156:159], a[212:215], v[128:131], v[156:159]
    v_mfma_f32_16x16x32_bf16 v[152:155], a[216:219], v[132:135], v[152:155]
    v_mfma_f32_16x16x32_bf16 v[156:159], a[220:223], v[132:135], v[156:159]
    v_mfma_f32_16x16x32_bf16 v[152:155], a[224:227], v[136:139], v[152:155]
    v_mfma_f32_16x16x32_bf16 v[156:159], a[228:231], v[136:139], v[156:159]
    v_mfma_f32_16x16x32_bf16 v[152:155], a[232:235], v[140:143], v[152:155]
    v_mfma_f32_16x16x32_bf16 v[156:159], a[236:239], v[140:143], v[156:159]
    v_mfma_f32_16x16x32_bf16 v[152:155], a[240:243], v[144:147], v[152:155]
    v_mfma_f32_16x16x32_bf16 v[156:159], a[244:247], v[144:147], v[156:159]
    v_mfma_f32_16x16x32_bf16 v[152:155], a[248:251], v[148:151], v[152:155]
    v_mfma_f32_16x16x32_bf16 v[156:159], a[252:255], v[148:151], v[156:159]
    s_nop 7
    s_branch O_red
L_chain:
    s_lshr_b32 s44, s2, 3
    v_and_b32 v8, 63, v0
    v_lshrrev_b32 v9, 4, v8
    v_and_b32 v10, 15, v8
    v_lshlrev_b32 v17, 2, v9
    v_xor_b32 v17, v17, v10
    v_lshlrev_b32 v17, 4, v17
    v_lshrrev_b32 v16, 1, v9
    v_lshlrev_b32 v16, 4, v16
    v_and_b32 v18, 1, v9
    v_add_u32 v16, v16, v18
    v_lshl_add_u32 v12, v16, 10, v17
    s_lshl_b32 s59, s44, 17
    s_lshl_b32 s66, s3, 8
    s_add_u32 s59, s59, s66
    s_lshl_b32 s52, s3, 10
    s_lshl_b32 s72, s44, 8
    s_mov_b32 s8, s26
    s_mov_b32 s9, s27
    s_mov_b32 s10, 0x400000
    s_mov_b32 s11, 0x20000
    s_mov_b32 s88, s20
    s_mov_b32 s89, s21
    s_mov_b32 s90, 0x400000
    s_mov_b32 s91, 0x20000
    s_mov_b32 s92, s22
    s_mov_b32 s93, s23
    s_mov_b32 s94, 0x400000
    s_mov_b32 s95, 0x20000
    s_mov_b32 s96, s24
    s_mov_b32 s97, s25
    s_mov_b32 s98, 0x400000
    s_mov_b32 s99, 0x20000
    s_and_b32 s65, s3, 1
    s_lshl_b32 s65, s65, 2
    v_add_u32 v17, s65, v9
    v_lshlrev_b32 v17, 1, v17
    v_xor_b32 v17, v17, v10
    v_lshlrev_b32 v17, 4, v17
    v_and_b32 v16, 1, v9
    v_lshlrev_b32 v16, 4, v16
    v_lshrrev_b32 v18, 1, v9
    s_lshl_b32 s65, s3, 2
    v_add3_u32 v16, v16, v18, s65
    v_mul_u32_u24 v16, 8192, v16
    v_add_u32 v11, v16, v17
    v_bfe_u32 v17, v8, 2, 3
    s_lshl_b32 s65, s3, 1
    v_xor_b32 v17, s65, v17
    v_lshrrev_b32 v16, 2, v8
    v_lshlrev_b32 v16, 8, v16
    v_lshl_add_u32 v16, v17, 5, v16
    v_and_b32 v17, 3, v8
    v_lshl_add_u32 v16, v17, 3, v16
    v_add_u32 v13, 0, v16
    v_xor_b32 v16, 32, v16
    v_add_u32 v14, 0, v16
    s_add_u32 s65, s72, 0x0
    s_add_u32 m0, s52, 0
    s_nop 0
    buffer_load_dwordx4 v11, s[92:95], s65 offen  lds
    s_add_u32 s65, s72, 0x4000
    s_add_u32 m0, s52, 4096
    s_nop 0
    buffer_load_dwordx4 v11, s[92:95], s65 offen  lds
    s_mov_b32 s12, s18
    s_mov_b32 s13, s19
    s_mov_b32 s14, 0x2000
    s_mov_b32 s15, 0x20000
    v_lshlrev_b32 v93, 4, v8
    s_lshl_b32 s65, s3, 11
    s_add_u32 m0, s65, 71680
    v_mov_b64 v[72:73], -1
    v_mov_b64 v[74:75], -1
    buffer_load_dwordx4 v93, s[12:15], s65 offen lds
    buffer_load_dwordx4 v93, s[12:15], s65 offen offset:1024 lds
    s_add_u32 s65, s72, 0x100000
    s_add_u32 m0, s52, 8192
    s_nop 0
    buffer_load_dwordx4 v11, s[92:95], s65 offen  lds
    s_add_u32 s65, s72, 0x104000
    s_add_u32 m0, s52, 12288
    s_nop 0
    buffer_load_dwordx4 v11, s[92:95], s65 offen  lds
    s_add_u32 s65, s72, 0x200000
    s_add_u32 m0, s52, 16384
    s_nop 0
    buffer_load_dwordx4 v11, s[92:95], s65 offen  lds
    s_add_u32 s65, s72, 0x204000
    s_add_u32 m0, s52, 20480
    s_nop 0
    buffer_load_dwordx4 v11, s[92:95], s65 offen  lds
    s_add_u32 s65, s72, 0x300000
    s_add_u32 m0, s52, 24576
    s_nop 0
    buffer_load_dwordx4 v11, s[92:95], s65 offen  lds
    s_add_u32 s65, s72, 0x304000
    s_add_u32 m0, s52, 28672
    s_nop 0
    buffer_load_dwordx4 v11, s[92:95], s65 offen  lds
    s_add_u32 s65, s72, 0x40000
    s_add_u32 m0, s52, 32768
    s_nop 0
    buffer_load_dwordx4 v11, s[92:95], s65 offen  lds
    s_add_u32 s65, s72, 0x44000
    s_add_u32 m0, s52, 36864
    s_nop 0
    buffer_load_dwordx4 v11, s[92:95], s65 offen  lds
    s_add_u32 s65, s72, 0x140000
    s_add_u32 m0, s52, 40960
    s_nop 0
    buffer_load_dwordx4 v11, s[92:95], s65 offen  lds
    s_add_u32 s65, s72, 0x144000
    s_add_u32 m0, s52, 45056
    s_nop 0
    buffer_load_dwordx4 v11, s[92:95], s65 offen  lds
    s_add_u32 s65, s72, 0x240000
    s_add_u32 m0, s52, 49152
    s_nop 0
    buffer_load_dwordx4 v11, s[92:95], s65 offen  lds
    s_add_u32 s65, s72, 0x244000
    s_add_u32 m0, s52, 53248
    s_nop 0
    buffer_load_dwordx4 v11, s[92:95], s65 offen  lds
    v_bfe_u32 v17, v8, 2, 1
    v_and_b32 v18, 1, v9
    v_lshl_add_u32 v17, v18, 1, v17
    v_mul_u32_u24 v16, 320, v17
    v_lshrrev_b32 v18, 1, v9
    v_lshl_add_u32 v16, v18, 12, v16
    v_bfe_u32 v18, v8, 3, 1
    v_lshl_add_u32 v16, v18, 5, v16
    v_and_b32 v18, 3, v8
    v_lshl_add_u32 v16, v18, 3, v16
    v_add_u32 v20, s52, v16
    v_xor_b32 v21, 64, v20
    v_xor_b32 v22, 0x80, v20
    v_xor_b32 v23, 0xc0, v20
    s_getreg_b32 s71, hwreg(HW_REG_XCC_ID, 0, 4)
    s_mov_b32 s69, 262144
    s_mul_i32 s87, s3, 30720
    s_add_u32 s87, s87, 40960
    v_add_u32 v94, s87, v93
    v_lshrrev_b32 v95, 1, v93
    s_mul_i32 s65, s3, 65536
    s_mul_i32 s66, s44, 2048
    s_add_u32 s49, s65, s66
    s_xor_b32 s50, s49, 0x80000
    s_mul_i32 s65, s3, 16384
    s_lshl_b32 s66, s44, 6
    s_add_u32 s45, s65, s66
    s_add_u32 s46, s45, 65536
    s_add_u32 s47, s45, 131072
    s_add_u32 s48, s45, 196608
    s_lshr_b32 s65, s44, 3
    s_lshl_b32 s66, s3, 2
    s_add_u32 s65, s65, s66
    s_lshl_b32 s65, s65, 9
    s_and_b32 s66, s44, 7
    s_lshl_b32 s66, s66, 5
    s_add_u32 s65, s65, s66
    v_and_b32 v16, 1, v10
    v_lshlrev_b32 v16, 4, v16
    v_lshrrev_b32 v17, 3, v10
    v_lshl_add_u32 v16, v17, 8, v16
    v_and_b32 v17, 6, v10
    v_lshlrev_b32 v17, 1, v17
    v_add3_u32 v16, v16, v17, s65
    s_lshl_b32 s65, s3, 5
    s_add_u32 s65, s65, s44
    s_lshl_b32 s65, s65, 2
    s_add_u32 s65, s65, 8192
    s_sub_u32 s65, s65, 8192
    v_lshl_add_u32 v18, v8, 9, s65
    v_mov_b32 v17, 0x40000000
    v_cmp_gt_u32 vcc, 20, v8
    s_mul_i32 s66, s44, 256
    s_lshr_b32 s66, s66, 10
    v_cndmask_b32 v17, v17, v18, vcc
    s_mul_i32 s66, s66, 4
    s_sub_u32 s66, s44, s66
    s_lshl_b32 s66, s66, 9
    s_lshl_b32 s65, s3, 7
    s_add_u32 s66, s66, s65
    s_add_u32 s73, s66, 8192
    v_cmp_gt_u32 vcc, 16, v8
    s_nop 1
    v_cndmask_b32 v103, v17, v16, vcc
    v_lshrrev_b32 v16, 1, v10
    v_lshlrev_b32 v16, 10, v16
    v_lshrrev_b32 v17, 1, v9
    v_lshl_add_u32 v16, v17, 8, v16
    v_and_b32 v17, 1, v9
    v_lshl_add_u32 v16, v17, 4, v16
    v_and_b32 v17, 1, v10
    v_lshl_add_u32 v16, v17, 1, v16
    s_lshl_b32 s65, s3, 6
    s_add_u32 s65, s65, 71680
    v_add_u32 v15, s65, v16
    v_mul_u32_u24 v16, 576, v9
    v_and_b32 v17, 8, v10
    v_and_b32 v18, 3, v10
    v_lshl_add_u32 v17, v18, 1, v17
    v_bfe_u32 v18, v10, 2, 1
    v_add_u32 v17, v17, v18
    v_lshl_add_u32 v16, v17, 2, v16
    s_lshl_b32 s65, s3, 6
    s_add_u32 s66, s65, 8192
    v_add_u32 v96, s66, v16
    v_mul_u32_u24 v16, 640, v9
    v_lshl_add_u32 v16, v10, 2, v16
    s_add_u32 s66, s65, 10496
    v_add_u32 v97, s66, v16
    v_lshrrev_b32 v17, 1, v10
    v_mul_u32_u24 v16, 288, v17
    v_lshl_add_u32 v16, v9, 4, v16
    v_add_u32 v98, 8192, v16
    v_mul_u32_u24 v16, 320, v17
    v_lshl_add_u32 v16, v9, 5, v16
    v_and_b32 v18, 1, v10
    v_lshl_add_u32 v16, v18, 4, v16
    v_add_u32 v99, 10496, v16
    v_lshlrev_b32 v16, 4, v10
    v_lshl_add_u32 v16, v9, 2, v16
    s_lshl_b32 s65, s3, 8
    s_add_u32 s65, s65, 13056
    v_add_u32 v100, s65, v16
    v_mul_u32_u24 v16, 4096, v9
    v_lshl_add_u32 v101, v10, 2, v16
    v_cmp_eq_u32 vcc, 1, v18
    v_mov_b32 v16, 0x88884444
    v_mov_b32 v17, 0xddddeeee
    v_cndmask_b32 v92, v16, v17, vcc
    v_mov_b32 v88, 0x3f803f80
    v_mov_b32 v89, 0x3f803f80
    v_mov_b32 v90, 0x3f803f80
    v_mov_b32 v91, 0x3f803f80
    s_mov_b32 s61, 0xffc0ffc0
    s_mov_b32 s62, 0x3e0293ee
    s_mov_b32 s64, 0x4b800000
    s_lshl_b32 s65, s44, 14
    s_lshl_b32 s66, s3, 12
    s_add_u32 s56, s65, s66
    s_add_u32 s56, s56, 0x2000000
    s_lshl_b32 s58, s44, 7
    s_add_u32 s58, s58, 0xf0000
    v_min_u32 v25, 23, v8
    v_and_b32 v16, 16, v25
    v_add_lshl_u32 v25, v25, v16, 2
    s_mov_b32 s12, s40
    s_mov_b32 s13, s41
    s_mov_b32 s14, 0x100
    s_mov_b32 s15, 0x20000
    s_waitcnt vmcnt(14)
    s_barrier
    ds_read_b64_tr_b16 v[216:217], v13 offset:0
    ds_read_b64_tr_b16 v[218:219], v13 offset:4096
    ds_read_b64_tr_b16 v[224:225], v14 offset:0
    ds_read_b64_tr_b16 v[226:227], v14 offset:4096
    s_waitcnt vmcnt(10)
    s_waitcnt lgkmcnt(0)
    s_barrier
    s_add_u32 s65, s72, 0x340000
    s_add_u32 m0, s52, 0
    s_nop 0
    buffer_load_dwordx4 v11, s[92:95], s65 offen  lds
    s_add_u32 s65, s72, 0x344000
    s_add_u32 m0, s52, 4096
    s_nop 0
    buffer_load_dwordx4 v11, s[92:95], s65 offen  lds
    ds_read_b64_tr_b16 v[220:221], v13 offset:8192
    ds_read_b64_tr_b16 v[222:223], v13 offset:12288
    ds_read_b64_tr_b16 v[228:229], v14 offset:8192
    ds_read_b64_tr_b16 v[230:231], v14 offset:12288
    ds_read_u16 v0, v15 offset:0
    ds_read_u16 v32, v15 offset:32
    ds_read_u16 v1, v15 offset:4
    ds_read_u16 v33, v15 offset:36
    ds_read_u16 v2, v15 offset:8
    ds_read_u16 v34, v15 offset:40
    ds_read_u16 v3, v15 offset:12
    ds_read_u16 v35, v15 offset:44
    ds_read_u16 v4, v15 offset:512
    ds_read_u16 v36, v15 offset:544
    ds_read_u16 v5, v15 offset:516
    ds_read_u16 v37, v15 offset:548
    ds_read_u16 v6, v15 offset:520
    ds_read_u16 v38, v15 offset:552
    ds_read_u16 v7, v15 offset:524
    ds_read_u16 v39, v15 offset:556
    s_waitcnt vmcnt(10)
    s_waitcnt lgkmcnt(15)
    s_barrier
    s_add_u32 s65, s72, 0x80000
    s_add_u32 m0, s52, 8192
    s_nop 0
    buffer_load_dwordx4 v11, s[92:95], s65 offen  lds
    s_add_u32 s65, s72, 0x84000
    s_add_u32 m0, s52, 12288
    s_nop 0
    buffer_load_dwordx4 v11, s[92:95], s65 offen  lds
    ds_read_b64_tr_b16 v[232:233], v13 offset:16384
    ds_read_b64_tr_b16 v[234:235], v13 offset:20480
    ds_read_b64_tr_b16 v[240:241], v14 offset:16384
    ds_read_b64_tr_b16 v[242:243], v14 offset:20480
    buffer_store_dwordx4 v[72:75], v93, s[4:7], s49 offen sc1
    s_waitcnt vmcnt(11)
    s_waitcnt lgkmcnt(0)
    s_barrier
    s_add_u32 s65, s72, 0x180000
    s_add_u32 m0, s52, 16384
    s_nop 0
    buffer_load_dwordx4 v11, s[92:95], s65 offen  lds
    s_add_u32 s65, s72, 0x184000
    s_add_u32 m0, s52, 20480
    s_nop 0
    buffer_load_dwordx4 v11, s[92:95], s65 offen  lds
    ds_read_b64_tr_b16 v[236:237], v13 offset:24576
    ds_read_b64_tr_b16 v[238:239], v13 offset:28672
    ds_read_b64_tr_b16 v[244:245], v14 offset:24576
    ds_read_b64_tr_b16 v[246:247], v14 offset:28672
    v_lshl_or_b32 v0, v32, 16, v0
    v_lshl_or_b32 v1, v33, 16, v1
    v_lshl_or_b32 v2, v34, 16, v2
    v_lshl_or_b32 v3, v35, 16, v3
    v_lshl_or_b32 v4, v36, 16, v4
    v_lshl_or_b32 v5, v37, 16, v5
    v_lshl_or_b32 v6, v38, 16, v6
    v_lshl_or_b32 v7, v39, 16, v7
    v_min_u32 v0, 0xffc0ffbf, v0
    v_min_u32 v1, 0xffc0ffbf, v1
    v_min_u32 v2, 0xffc0ffbf, v2
    v_min_u32 v3, 0xffc0ffbf, v3
    v_min_u32 v4, 0xffc0ffbf, v4
    v_min_u32 v5, 0xffc0ffbf, v5
    v_min_u32 v6, 0xffc0ffbf, v6
    v_min_u32 v7, 0xffc0ffbf, v7
    s_waitcnt vmcnt(11)
    s_waitcnt lgkmcnt(0)
    s_barrier
    s_add_u32 s65, s72, 0x280000
    s_add_u32 m0, s52, 24576
    s_nop 0
    buffer_load_dwordx4 v11, s[92:95], s65 offen  lds
    s_add_u32 s65, s72, 0x284000
    s_add_u32 m0, s52, 28672
    s_nop 0
    buffer_load_dwordx4 v11, s[92:95], s65 offen  lds
    ds_read_b64_tr_b16 v[248:249], v13 offset:32768
    ds_read_b64_tr_b16 v[250:251], v13 offset:36864
    ds_read_b64_tr_b16 a[0:1], v14 offset:32768
    ds_read_b64_tr_b16 a[2:3], v14 offset:36864
    s_waitcnt vmcnt(11)
    s_waitcnt lgkmcnt(0)
    s_barrier
    s_add_u32 s65, s72, 0x380000
    s_add_u32 m0, s52, 32768
    s_nop 0
    buffer_load_dwordx4 v11, s[92:95], s65 offen  lds
    s_add_u32 s65, s72, 0x384000
    s_add_u32 m0, s52, 36864
    s_nop 0
    buffer_load_dwordx4 v11, s[92:95], s65 offen  lds
    ds_read_b64_tr_b16 v[252:253], v13 offset:40960
    ds_read_b64_tr_b16 v[254:255], v13 offset:45056
    ds_read_b64_tr_b16 a[4:5], v14 offset:40960
    ds_read_b64_tr_b16 a[6:7], v14 offset:45056
    buffer_store_dwordx4 v[72:75], v93, s[4:7], s49 offen offset:1024 sc1
    s_waitcnt vmcnt(12)
    s_waitcnt lgkmcnt(0)
    s_barrier
    s_add_u32 s65, s72, 0xc0000
    s_add_u32 m0, s52, 40960
    s_nop 0
    buffer_load_dwordx4 v11, s[92:95], s65 offen  lds
    s_add_u32 s65, s72, 0xc4000
    s_add_u32 m0, s52, 45056
    s_nop 0
    buffer_load_dwordx4 v11, s[92:95], s65 offen  lds
    ds_read_b64_tr_b16 a[8:9], v13 offset:49152
    ds_read_b64_tr_b16 a[10:11], v13 offset:53248
    ds_read_b64_tr_b16 a[16:17], v14 offset:49152
    ds_read_b64_tr_b16 a[18:19], v14 offset:53248
    s_waitcnt vmcnt(12)
    s_waitcnt lgkmcnt(0)
    s_barrier
    s_add_u32 s65, s72, 0x1c0000
    s_add_u32 m0, s52, 49152
    s_nop 0
    buffer_load_dwordx4 v11, s[92:95], s65 offen  lds
    s_add_u32 s65, s72, 0x1c4000
    s_add_u32 m0, s52, 53248
    s_nop 0
    buffer_load_dwordx4 v11, s[92:95], s65 offen  lds
    ds_read_b64_tr_b16 a[12:13], v13 offset:0
    ds_read_b64_tr_b16 a[14:15], v13 offset:4096
    ds_read_b64_tr_b16 a[20:21], v14 offset:0
    ds_read_b64_tr_b16 a[22:23], v14 offset:4096
    s_waitcnt vmcnt(12)
    s_waitcnt lgkmcnt(0)
    s_barrier
    s_add_u32 s65, s72, 0x2c0000
    s_add_u32 m0, s52, 0
    s_nop 0
    buffer_load_dwordx4 v11, s[92:95], s65 offen  lds
    s_add_u32 s65, s72, 0x2c4000
    s_add_u32 m0, s52, 4096
    s_nop 0
    buffer_load_dwordx4 v11, s[92:95], s65 offen  lds
    ds_read_b64_tr_b16 v[56:57], v13 offset:8192
    ds_read_b64_tr_b16 v[58:59], v13 offset:12288
    ds_read_b64_tr_b16 v[64:65], v14 offset:8192
    ds_read_b64_tr_b16 v[66:67], v14 offset:12288
    buffer_store_dwordx4 v[72:75], v93, s[4:7], s50 offen sc1
    s_waitcnt vmcnt(12)
    s_waitcnt lgkmcnt(0)
    s_barrier
    s_add_u32 s65, s72, 0x3c0000
    s_add_u32 m0, s52, 8192
    s_nop 0
    buffer_load_dwordx4 v11, s[92:95], s65 offen  lds
    s_add_u32 s65, s72, 0x3c4000
    s_add_u32 m0, s52, 12288
    s_nop 0
    buffer_load_dwordx4 v11, s[92:95], s65 offen  lds
    ds_read_b64_tr_b16 v[60:61], v13 offset:16384
    ds_read_b64_tr_b16 v[62:63], v13 offset:20480
    ds_read_b64_tr_b16 v[68:69], v14 offset:16384
    ds_read_b64_tr_b16 v[70:71], v14 offset:20480
    ds_write_b128 v94, v[56:59] offset:22528
    s_waitcnt lgkmcnt(3)
    ds_write_b128 v94, v[60:63] offset:23552
    ds_write_b128 v94, v[64:67] offset:24576
    s_waitcnt lgkmcnt(3)
    ds_write_b128 v94, v[68:71] offset:25600
    s_waitcnt vmcnt(12)
    s_barrier
    s_add_u32 s65, s72, 0x0
    s_add_u32 m0, s52, 16384
    s_nop 0
    buffer_load_dwordx4 v11, s[96:99], s65 offen  lds
    s_add_u32 s65, s72, 0x4000
    s_add_u32 m0, s52, 20480
    s_nop 0
    buffer_load_dwordx4 v11, s[96:99], s65 offen  lds
    ds_read_b64_tr_b16 v[56:57], v13 offset:24576
    ds_read_b64_tr_b16 v[58:59], v13 offset:28672
    ds_read_b64_tr_b16 v[64:65], v14 offset:24576
    ds_read_b64_tr_b16 v[66:67], v14 offset:28672
    s_waitcnt vmcnt(12)
    s_waitcnt lgkmcnt(0)
    s_barrier
    s_add_u32 s65, s72, 0x100000
    s_add_u32 m0, s52, 24576
    s_nop 0
    buffer_load_dwordx4 v11, s[96:99], s65 offen  lds
    s_add_u32 s65, s72, 0x104000
    s_add_u32 m0, s52, 28672
    s_nop 0
    buffer_load_dwordx4 v11, s[96:99], s65 offen  lds
    ds_read_b64_tr_b16 v[60:61], v13 offset:32768
    ds_read_b64_tr_b16 v[62:63], v13 offset:36864
    ds_read_b64_tr_b16 v[68:69], v14 offset:32768
    ds_read_b64_tr_b16 v[70:71], v14 offset:36864
    ds_write_b128 v94, v[56:59] offset:26624
    s_waitcnt lgkmcnt(3)
    ds_write_b128 v94, v[60:63] offset:27648
    ds_write_b128 v94, v[64:67] offset:28672
    s_waitcnt lgkmcnt(3)
    ds_write_b128 v94, v[68:71] offset:29696
    buffer_store_dwordx4 v[72:75], v93, s[4:7], s50 offen offset:1024 sc1
    s_waitcnt vmcnt(12)
    s_barrier
    s_add_u32 s65, s72, 0x200000
    s_add_u32 m0, s52, 32768
    s_nop 0
    buffer_load_dwordx4 v11, s[96:99], s65 offen  lds
    s_add_u32 s65, s72, 0x204000
    s_add_u32 m0, s52, 36864
    s_nop 0
    buffer_load_dwordx4 v11, s[96:99], s65 offen  lds
    ds_read_b64_tr_b16 a[24:25], v13 offset:40960
    ds_read_b64_tr_b16 a[26:27], v13 offset:45056
    ds_read_b64_tr_b16 a[32:33], v14 offset:40960
    ds_read_b64_tr_b16 a[34:35], v14 offset:45056
    s_waitcnt vmcnt(12)
    s_waitcnt lgkmcnt(0)
    s_barrier
    s_add_u32 s65, s72, 0x300000
    s_add_u32 m0, s52, 40960
    s_nop 0
    buffer_load_dwordx4 v11, s[96:99], s65 offen  lds
    s_add_u32 s65, s72, 0x304000
    s_add_u32 m0, s52, 45056
    s_nop 0
    buffer_load_dwordx4 v11, s[96:99], s65 offen  lds
    ds_read_b64_tr_b16 a[28:29], v13 offset:49152
    ds_read_b64_tr_b16 a[30:31], v13 offset:53248
    ds_read_b64_tr_b16 a[36:37], v14 offset:49152
    ds_read_b64_tr_b16 a[38:39], v14 offset:53248
    s_waitcnt vmcnt(12)
    s_waitcnt lgkmcnt(0)
    s_barrier
    s_add_u32 s65, s72, 0x40000
    s_add_u32 m0, s52, 49152
    s_nop 0
    buffer_load_dwordx4 v11, s[96:99], s65 offen  lds
    s_add_u32 s65, s72, 0x44000
    s_add_u32 m0, s52, 53248
    s_nop 0
    buffer_load_dwordx4 v11, s[96:99], s65 offen  lds
    ds_read_b64_tr_b16 a[40:41], v13 offset:0
    ds_read_b64_tr_b16 a[42:43], v13 offset:4096
    ds_read_b64_tr_b16 a[48:49], v14 offset:0
    ds_read_b64_tr_b16 a[50:51], v14 offset:4096
    s_lshl_b32 s65, s3, 14
    s_lshl_b32 s66, s44, 9
    s_add_u32 s65, s65, s66
    s_add_u32 s65, s65, 0xe0000
    s_mov_b32 exec_hi, 0
    buffer_store_dwordx4 v[72:75], v93, s[4:7], s65 offen sc1
    s_mov_b64 exec, -1
    s_waitcnt vmcnt(12)
    s_waitcnt lgkmcnt(0)
    s_barrier
    s_add_u32 s65, s72, 0x140000
    s_add_u32 m0, s52, 0
    s_nop 0
    buffer_load_dwordx4 v11, s[96:99], s65 offen  lds
    s_add_u32 s65, s72, 0x144000
    s_add_u32 m0, s52, 4096
    s_nop 0
    buffer_load_dwordx4 v11, s[96:99], s65 offen  lds
    ds_read_b64_tr_b16 a[44:45], v13 offset:8192
    ds_read_b64_tr_b16 a[46:47], v13 offset:12288
    ds_read_b64_tr_b16 a[52:53], v14 offset:8192
    ds_read_b64_tr_b16 a[54:55], v14 offset:12288
    s_waitcnt vmcnt(12)
    s_waitcnt lgkmcnt(0)
    s_barrier
    s_add_u32 s65, s72, 0x240000
    s_add_u32 m0, s52, 8192
    s_nop 0
    buffer_load_dwordx4 v11, s[96:99], s65 offen  lds
    s_add_u32 s65, s72, 0x244000
    s_add_u32 m0, s52, 12288
    s_nop 0
    buffer_load_dwordx4 v11, s[96:99], s65 offen  lds
    ds_read_b64_tr_b16 a[56:57], v13 offset:16384
    ds_read_b64_tr_b16 a[58:59], v13 offset:20480
    ds_read_b64_tr_b16 a[64:65], v14 offset:16384
    ds_read_b64_tr_b16 a[66:67], v14 offset:20480
    s_waitcnt vmcnt(12)
    s_waitcnt lgkmcnt(0)
    s_barrier
    s_add_u32 s65, s72, 0x340000
    s_add_u32 m0, s52, 16384
    s_nop 0
    buffer_load_dwordx4 v11, s[96:99], s65 offen  lds
    s_add_u32 s65, s72, 0x344000
    s_add_u32 m0, s52, 20480
    s_nop 0
    buffer_load_dwordx4 v11, s[96:99], s65 offen  lds
    ds_read_b64_tr_b16 a[60:61], v13 offset:24576
    ds_read_b64_tr_b16 a[62:63], v13 offset:28672
    ds_read_b64_tr_b16 a[68:69], v14 offset:24576
    ds_read_b64_tr_b16 a[70:71], v14 offset:28672
    s_waitcnt vmcnt(11)
    s_waitcnt lgkmcnt(0)
    s_barrier
    s_add_u32 s65, s72, 0x80000
    s_add_u32 m0, s52, 24576
    s_nop 0
    buffer_load_dwordx4 v11, s[96:99], s65 offen  lds
    s_add_u32 s65, s72, 0x84000
    s_add_u32 m0, s52, 28672
    s_nop 0
    buffer_load_dwordx4 v11, s[96:99], s65 offen  lds
    ds_read_b64_tr_b16 a[72:73], v13 offset:32768
    ds_read_b64_tr_b16 a[74:75], v13 offset:36864
    ds_read_b64_tr_b16 a[80:81], v14 offset:32768
    ds_read_b64_tr_b16 a[82:83], v14 offset:36864
    s_waitcnt vmcnt(11)
    s_waitcnt lgkmcnt(0)
    s_barrier
    s_add_u32 s65, s72, 0x180000
    s_add_u32 m0, s52, 32768
    s_nop 0
    buffer_load_dwordx4 v11, s[96:99], s65 offen  lds
    s_add_u32 s65, s72, 0x184000
    s_add_u32 m0, s52, 36864
    s_nop 0
    buffer_load_dwordx4 v11, s[96:99], s65 offen  lds
    ds_read_b64_tr_b16 a[76:77], v13 offset:40960
    ds_read_b64_tr_b16 a[78:79], v13 offset:45056
    ds_read_b64_tr_b16 a[84:85], v14 offset:40960
    ds_read_b64_tr_b16 a[86:87], v14 offset:45056
    s_waitcnt vmcnt(11)
    s_waitcnt lgkmcnt(0)
    s_barrier
    s_add_u32 s65, s72, 0x280000
    s_add_u32 m0, s52, 40960
    s_nop 0
    buffer_load_dwordx4 v11, s[96:99], s65 offen  lds
    s_add_u32 s65, s72, 0x284000
    s_add_u32 m0, s52, 45056
    s_nop 0
    buffer_load_dwordx4 v11, s[96:99], s65 offen  lds
    ds_read_b64_tr_b16 a[88:89], v13 offset:49152
    ds_read_b64_tr_b16 a[90:91], v13 offset:53248
    ds_read_b64_tr_b16 a[96:97], v14 offset:49152
    ds_read_b64_tr_b16 a[98:99], v14 offset:53248
    s_waitcnt vmcnt(10)
    s_waitcnt lgkmcnt(0)
    s_barrier
    s_add_u32 s65, s72, 0x380000
    s_add_u32 m0, s52, 49152
    s_nop 0
    buffer_load_dwordx4 v11, s[96:99], s65 offen  lds
    s_add_u32 s65, s72, 0x384000
    s_add_u32 m0, s52, 53248
    s_nop 0
    buffer_load_dwordx4 v11, s[96:99], s65 offen  lds
    ds_read_b64_tr_b16 a[92:93], v13 offset:0
    ds_read_b64_tr_b16 a[94:95], v13 offset:4096
    ds_read_b64_tr_b16 a[100:101], v14 offset:0
    ds_read_b64_tr_b16 a[102:103], v14 offset:4096
    s_or_b32 s65, s71, 0x80
    v_mov_b32 v16, s65
    s_add_u32 s65, s44, 128
    s_cmp_eq_u32 s3, 0
    s_cselect_b32 s65, s65, 0x40000000
    buffer_store_byte v16, off, s[12:15], s65 sc1
    s_waitcnt vmcnt(11)
    s_waitcnt lgkmcnt(0)
    s_barrier
    s_add_u32 s65, s72, 0xc0000
    s_add_u32 m0, s52, 0
    s_nop 0
    buffer_load_dwordx4 v11, s[96:99], s65 offen  lds
    s_add_u32 s65, s72, 0xc4000
    s_add_u32 m0, s52, 4096
    s_nop 0
    buffer_load_dwordx4 v11, s[96:99], s65 offen  lds
    ds_read_b64_tr_b16 a[104:105], v13 offset:8192
    ds_read_b64_tr_b16 a[106:107], v13 offset:12288
    ds_read_b64_tr_b16 a[112:113], v14 offset:8192
    ds_read_b64_tr_b16 a[114:115], v14 offset:12288
    s_waitcnt vmcnt(11)
    s_waitcnt lgkmcnt(0)
    s_barrier
    s_add_u32 s65, s72, 0x1c0000
    s_add_u32 m0, s52, 8192
    s_nop 0
    buffer_load_dwordx4 v11, s[96:99], s65 offen  lds
    s_add_u32 s65, s72, 0x1c4000
    s_add_u32 m0, s52, 12288
    s_nop 0
    buffer_load_dwordx4 v11, s[96:99], s65 offen  lds
    ds_read_b64_tr_b16 a[108:109], v13 offset:16384
    ds_read_b64_tr_b16 a[110:111], v13 offset:20480
    ds_read_b64_tr_b16 a[116:117], v14 offset:16384
    ds_read_b64_tr_b16 a[118:119], v14 offset:20480
    s_waitcnt vmcnt(11)
    s_waitcnt lgkmcnt(0)
    s_barrier
    s_add_u32 s65, s72, 0x2c0000
    s_add_u32 m0, s52, 16384
    s_nop 0
    buffer_load_dwordx4 v11, s[96:99], s65 offen  lds
    s_add_u32 s65, s72, 0x2c4000
    s_add_u32 m0, s52, 20480
    s_nop 0
    buffer_load_dwordx4 v11, s[96:99], s65 offen  lds
    ds_read_b64_tr_b16 a[120:121], v13 offset:24576
    ds_read_b64_tr_b16 a[122:123], v13 offset:28672
    ds_read_b64_tr_b16 a[128:129], v14 offset:24576
    ds_read_b64_tr_b16 a[130:131], v14 offset:28672
    s_waitcnt vmcnt(11)
    s_waitcnt lgkmcnt(0)
    s_barrier
    s_add_u32 s65, s72, 0x3c0000
    s_add_u32 m0, s52, 24576
    s_nop 0
    buffer_load_dwordx4 v11, s[96:99], s65 offen  lds
    s_add_u32 s65, s72, 0x3c4000
    s_add_u32 m0, s52, 28672
    s_nop 0
    buffer_load_dwordx4 v11, s[96:99], s65 offen  lds
    ds_read_b64_tr_b16 a[124:125], v13 offset:32768
    ds_read_b64_tr_b16 a[126:127], v13 offset:36864
    ds_read_b64_tr_b16 a[132:133], v14 offset:32768
    ds_read_b64_tr_b16 a[134:135], v14 offset:36864
    s_waitcnt vmcnt(11)
    s_waitcnt lgkmcnt(0)
    s_barrier
    s_add_u32 s65, s72, 0x0
    s_add_u32 m0, s52, 32768
    s_nop 0
    buffer_load_dwordx4 v11, s[88:91], s65 offen  lds
    s_add_u32 s65, s72, 0x4000
    s_add_u32 m0, s52, 36864
    s_nop 0
    buffer_load_dwordx4 v11, s[88:91], s65 offen  lds
    ds_read_b64_tr_b16 a[136:137], v13 offset:40960
    ds_read_b64_tr_b16 a[138:139], v13 offset:45056
    ds_read_b64_tr_b16 a[144:145], v14 offset:40960
    ds_read_b64_tr_b16 a[146:147], v14 offset:45056
    s_waitcnt vmcnt(11)
    s_waitcnt lgkmcnt(0)
    s_barrier
    s_add_u32 s65, s72, 0x100000
    s_add_u32 m0, s52, 40960
    s_nop 0
    buffer_load_dwordx4 v11, s[88:91], s65 offen  lds
    s_add_u32 s65, s72, 0x104000
    s_add_u32 m0, s52, 45056
    s_nop 0
    buffer_load_dwordx4 v11, s[88:91], s65 offen  lds
    ds_read_b64_tr_b16 a[140:141], v13 offset:49152
    ds_read_b64_tr_b16 a[142:143], v13 offset:53248
    ds_read_b64_tr_b16 a[148:149], v14 offset:49152
    ds_read_b64_tr_b16 a[150:151], v14 offset:53248
    s_waitcnt vmcnt(10)
    s_waitcnt lgkmcnt(0)
    s_barrier
    ds_read_b64_tr_b16 a[152:153], v13 offset:0
    ds_read_b64_tr_b16 a[154:155], v13 offset:4096
    ds_read_b64_tr_b16 a[160:161], v14 offset:0
    ds_read_b64_tr_b16 a[162:163], v14 offset:4096
    s_waitcnt vmcnt(8)
    s_waitcnt lgkmcnt(0)
    s_barrier
    s_add_u32 s65, s72, 0x200000
    s_add_u32 m0, s52, 0
    s_nop 0
    buffer_load_dwordx4 v11, s[88:91], s65 offen  lds
    s_add_u32 s65, s72, 0x204000
    s_add_u32 m0, s52, 4096
    s_nop 0
    buffer_load_dwordx4 v11, s[88:91], s65 offen  lds
    ds_read_b64_tr_b16 a[156:157], v13 offset:8192
    ds_read_b64_tr_b16 a[158:159], v13 offset:12288
    ds_read_b64_tr_b16 a[164:165], v14 offset:8192
    ds_read_b64_tr_b16 a[166:167], v14 offset:12288
    s_waitcnt vmcnt(8)
    s_waitcnt lgkmcnt(0)
    s_barrier
    s_add_u32 s65, s72, 0x300000
    s_add_u32 m0, s52, 8192
    s_nop 0
    buffer_load_dwordx4 v11, s[88:91], s65 offen  lds
    s_add_u32 s65, s72, 0x304000
    s_add_u32 m0, s52, 12288
    s_nop 0
    buffer_load_dwordx4 v11, s[88:91], s65 offen  lds
    ds_read_b64_tr_b16 v[56:57], v13 offset:16384
    ds_read_b64_tr_b16 v[58:59], v13 offset:20480
    ds_read_b64_tr_b16 v[64:65], v14 offset:16384
    ds_read_b64_tr_b16 v[66:67], v14 offset:20480
    s_waitcnt vmcnt(8)
    s_waitcnt lgkmcnt(0)
    s_barrier
    s_add_u32 s65, s72, 0x40000
    s_add_u32 m0, s52, 16384
    s_nop 0
    buffer_load_dwordx4 v11, s[88:91], s65 offen  lds
    s_add_u32 s65, s72, 0x44000
    s_add_u32 m0, s52, 20480
    s_nop 0
    buffer_load_dwordx4 v11, s[88:91], s65 offen  lds
    ds_read_b64_tr_b16 v[60:61], v13 offset:24576
    ds_read_b64_tr_b16 v[62:63], v13 offset:28672
    ds_read_b64_tr_b16 v[68:69], v14 offset:24576
    ds_read_b64_tr_b16 v[70:71], v14 offset:28672
    ds_write_b128 v94, v[56:59] offset:18432
    s_waitcnt lgkmcnt(3)
    ds_write_b128 v94, v[60:63] offset:19456
    ds_write_b128 v94, v[64:67] offset:20480
    s_waitcnt lgkmcnt(3)
    ds_write_b128 v94, v[68:71] offset:21504
    s_waitcnt vmcnt(8)
    s_barrier
    s_add_u32 s65, s72, 0x140000
    s_add_u32 m0, s52, 24576
    s_nop 0
    buffer_load_dwordx4 v11, s[88:91], s65 offen  lds
    s_add_u32 s65, s72, 0x144000
    s_add_u32 m0, s52, 28672
    s_nop 0
    buffer_load_dwordx4 v11, s[88:91], s65 offen  lds
    ds_read_b64_tr_b16 v[56:57], v13 offset:32768
    ds_read_b64_tr_b16 v[58:59], v13 offset:36864
    ds_read_b64_tr_b16 v[64:65], v14 offset:32768
    ds_read_b64_tr_b16 v[66:67], v14 offset:36864
    s_waitcnt vmcnt(8)
    s_waitcnt lgkmcnt(0)
    s_barrier
    s_add_u32 s65, s72, 0x240000
    s_add_u32 m0, s52, 32768
    s_nop 0
    buffer_load_dwordx4 v11, s[88:91], s65 offen  lds
    s_add_u32 s65, s72, 0x244000
    s_add_u32 m0, s52, 36864
    s_nop 0
    buffer_load_dwordx4 v11, s[88:91], s65 offen  lds
    ds_read_b64_tr_b16 v[60:61], v13 offset:40960
    ds_read_b64_tr_b16 v[62:63], v13 offset:45056
    ds_read_b64_tr_b16 v[68:69], v14 offset:40960
    ds_read_b64_tr_b16 v[70:71], v14 offset:45056
    ds_write_b128 v94, v[56:59] offset:10240
    s_waitcnt lgkmcnt(3)
    ds_write_b128 v94, v[60:63] offset:11264
    ds_write_b128 v94, v[64:67] offset:12288
    s_waitcnt lgkmcnt(3)
    ds_write_b128 v94, v[68:71] offset:13312
    s_waitcnt vmcnt(8)
    s_barrier
    s_add_u32 s65, s72, 0x340000
    s_add_u32 m0, s52, 40960
    s_nop 0
    buffer_load_dwordx4 v11, s[88:91], s65 offen  lds
    s_add_u32 s65, s72, 0x344000
    s_add_u32 m0, s52, 45056
    s_nop 0
    buffer_load_dwordx4 v11, s[88:91], s65 offen  lds
    ds_read_b64_tr_b16 v[120:121], v13 offset:0
    ds_read_b64_tr_b16 v[122:123], v13 offset:4096
    ds_read_b64_tr_b16 v[128:129], v14 offset:0
    ds_read_b64_tr_b16 v[130:131], v14 offset:4096
    s_waitcnt vmcnt(8)
    s_waitcnt lgkmcnt(0)
    s_barrier
    s_add_u32 s65, s72, 0x80000
    s_add_u32 m0, s52, 0
    s_nop 0
    buffer_load_dwordx4 v11, s[88:91], s65 offen  lds
    s_add_u32 s65, s72, 0x84000
    s_add_u32 m0, s52, 4096
    s_nop 0
    buffer_load_dwordx4 v11, s[88:91], s65 offen  lds
    ds_read_b64_tr_b16 v[124:125], v13 offset:8192
    ds_read_b64_tr_b16 v[126:127], v13 offset:12288
    ds_read_b64_tr_b16 v[132:133], v14 offset:8192
    ds_read_b64_tr_b16 v[134:135], v14 offset:12288
    s_waitcnt vmcnt(8)
    s_waitcnt lgkmcnt(0)
    s_barrier
    s_add_u32 s65, s72, 0x180000
    s_add_u32 m0, s52, 8192
    s_nop 0
    buffer_load_dwordx4 v11, s[88:91], s65 offen  lds
    s_add_u32 s65, s72, 0x184000
    s_add_u32 m0, s52, 12288
    s_nop 0
    buffer_load_dwordx4 v11, s[88:91], s65 offen  lds
    ds_read_b64_tr_b16 v[136:137], v13 offset:16384
    ds_read_b64_tr_b16 v[138:139], v13 offset:20480
    ds_read_b64_tr_b16 v[144:145], v14 offset:16384
    ds_read_b64_tr_b16 v[146:147], v14 offset:20480
    s_waitcnt vmcnt(8)
    s_waitcnt lgkmcnt(0)
    s_barrier
    s_add_u32 s65, s72, 0x280000
    s_add_u32 m0, s52, 16384
    s_nop 0
    buffer_load_dwordx4 v11, s[88:91], s65 offen  lds
    s_add_u32 s65, s72, 0x284000
    s_add_u32 m0, s52, 20480
    s_nop 0
    buffer_load_dwordx4 v11, s[88:91], s65 offen  lds
    ds_read_b64_tr_b16 v[140:141], v13 offset:24576
    ds_read_b64_tr_b16 v[142:143], v13 offset:28672
    ds_read_b64_tr_b16 v[148:149], v14 offset:24576
    ds_read_b64_tr_b16 v[150:151], v14 offset:28672
    s_waitcnt vmcnt(8)
    s_waitcnt lgkmcnt(0)
    s_barrier
    s_add_u32 s65, s72, 0x380000
    s_add_u32 m0, s52, 24576
    s_nop 0
    buffer_load_dwordx4 v11, s[88:91], s65 offen  lds
    s_add_u32 s65, s72, 0x384000
    s_add_u32 m0, s52, 28672
    s_nop 0
    buffer_load_dwordx4 v11, s[88:91], s65 offen  lds
    ds_read_b64_tr_b16 v[152:153], v13 offset:32768
    ds_read_b64_tr_b16 v[154:155], v13 offset:36864
    ds_read_b64_tr_b16 v[160:161], v14 offset:32768
    ds_read_b64_tr_b16 v[162:163], v14 offset:36864
    s_waitcnt vmcnt(8)
    s_waitcnt lgkmcnt(0)
    s_barrier
    s_add_u32 s65, s72, 0xc0000
    s_add_u32 m0, s52, 32768
    s_nop 0
    buffer_load_dwordx4 v11, s[88:91], s65 offen  lds
    s_add_u32 s65, s72, 0xc4000
    s_add_u32 m0, s52, 36864
    s_nop 0
    buffer_load_dwordx4 v11, s[88:91], s65 offen  lds
    ds_read_b64_tr_b16 v[156:157], v13 offset:40960
    ds_read_b64_tr_b16 v[158:159], v13 offset:45056
    ds_read_b64_tr_b16 v[164:165], v14 offset:40960
    ds_read_b64_tr_b16 v[166:167], v14 offset:45056
    s_waitcnt vmcnt(8)
    s_waitcnt lgkmcnt(0)
    s_barrier
    s_add_u32 s65, s72, 0x1c0000
    s_add_u32 m0, s52, 40960
    s_nop 0
    buffer_load_dwordx4 v11, s[88:91], s65 offen  lds
    s_add_u32 s65, s72, 0x1c4000
    s_add_u32 m0, s52, 45056
    s_nop 0
    buffer_load_dwordx4 v11, s[88:91], s65 offen  lds
    ds_read_b64_tr_b16 v[56:57], v13 offset:0
    ds_read_b64_tr_b16 v[58:59], v13 offset:4096
    ds_read_b64_tr_b16 v[64:65], v14 offset:0
    ds_read_b64_tr_b16 v[66:67], v14 offset:4096
    s_waitcnt vmcnt(8)
    s_waitcnt lgkmcnt(0)
    s_barrier
    s_add_u32 s65, s72, 0x2c0000
    s_add_u32 m0, s52, 0
    s_nop 0
    buffer_load_dwordx4 v11, s[88:91], s65 offen  lds
    s_add_u32 s65, s72, 0x2c4000
    s_add_u32 m0, s52, 4096
    s_nop 0
    buffer_load_dwordx4 v11, s[88:91], s65 offen  lds
    ds_read_b64_tr_b16 v[60:61], v13 offset:8192
    ds_read_b64_tr_b16 v[62:63], v13 offset:12288
    ds_read_b64_tr_b16 v[68:69], v14 offset:8192
    ds_read_b64_tr_b16 v[70:71], v14 offset:12288
    ds_write_b128 v94, v[56:59] offset:14336
    s_waitcnt lgkmcnt(3)
    ds_write_b128 v94, v[60:63] offset:15360
    ds_write_b128 v94, v[64:67] offset:16384
    s_waitcnt lgkmcnt(3)
    ds_write_b128 v94, v[68:71] offset:17408
    s_waitcnt vmcnt(8)
    s_barrier
    s_add_u32 s65, s72, 0x3c0000
    s_add_u32 m0, s52, 8192
    s_nop 0
    buffer_load_dwordx4 v11, s[88:91], s65 offen  lds
    s_add_u32 s65, s72, 0x3c4000
    s_add_u32 m0, s52, 12288
    s_nop 0
    buffer_load_dwordx4 v11, s[88:91], s65 offen  lds
    ds_read_b64_tr_b16 v[168:169], v13 offset:16384
    ds_read_b64_tr_b16 v[170:171], v13 offset:20480
    ds_read_b64_tr_b16 v[176:177], v14 offset:16384
    ds_read_b64_tr_b16 v[178:179], v14 offset:20480
    s_waitcnt vmcnt(8)
    s_waitcnt lgkmcnt(0)
    s_barrier
    s_xor_b32 s68, s3, 0
    s_lshl_b32 s68, s68, 15
    s_add_u32 s68, s68, s59
    s_add_u32 s65, s68, 0
    s_add_u32 m0, s52, 16384
    s_nop 0
    buffer_load_dwordx4 v12, s[8:11], s65 offen  lds
    s_add_u32 s65, s68, 4096
    s_add_u32 m0, s52, 20480
    s_nop 0
    buffer_load_dwordx4 v12, s[8:11], s65 offen  lds
    ds_read_b64_tr_b16 v[172:173], v13 offset:24576
    ds_read_b64_tr_b16 v[174:175], v13 offset:28672
    ds_read_b64_tr_b16 v[180:181], v14 offset:24576
    ds_read_b64_tr_b16 v[182:183], v14 offset:28672
    s_waitcnt vmcnt(8)
    s_waitcnt lgkmcnt(0)
    s_barrier
    s_add_u32 s65, s68, 2048
    s_add_u32 m0, s52, 24576
    s_nop 0
    buffer_load_dwordx4 v12, s[8:11], s65 offen  lds
    s_add_u32 s65, s68, 6144
    s_add_u32 m0, s52, 28672
    s_nop 0
    buffer_load_dwordx4 v12, s[8:11], s65 offen  lds
    ds_read_b64_tr_b16 v[184:185], v13 offset:32768
    ds_read_b64_tr_b16 v[186:187], v13 offset:36864
    ds_read_b64_tr_b16 v[192:193], v14 offset:32768
    ds_read_b64_tr_b16 v[194:195], v14 offset:36864
    s_waitcnt vmcnt(8)
    s_waitcnt lgkmcnt(0)
    s_barrier
    s_add_u32 s65, s68, 8192
    s_add_u32 m0, s52, 32768
    s_nop 0
    buffer_load_dwordx4 v12, s[8:11], s65 offen  lds
    s_add_u32 s65, s68, 12288
    s_add_u32 m0, s52, 36864
    s_nop 0
    buffer_load_dwordx4 v12, s[8:11], s65 offen  lds
    ds_read_b64_tr_b16 v[188:189], v13 offset:40960
    ds_read_b64_tr_b16 v[190:191], v13 offset:45056
    ds_read_b64_tr_b16 v[196:197], v14 offset:40960
    ds_read_b64_tr_b16 v[198:199], v14 offset:45056
    s_waitcnt vmcnt(8)
    s_waitcnt lgkmcnt(0)
    s_barrier
    s_add_u32 s65, s68, 10240
    s_add_u32 m0, s52, 40960
    s_nop 0
    buffer_load_dwordx4 v12, s[8:11], s65 offen  lds
    s_add_u32 s65, s68, 14336
    s_add_u32 m0, s52, 45056
    s_nop 0
    buffer_load_dwordx4 v12, s[8:11], s65 offen  lds
    ds_read_b64_tr_b16 v[200:201], v13 offset:0
    ds_read_b64_tr_b16 v[202:203], v13 offset:4096
    ds_read_b64_tr_b16 v[208:209], v14 offset:0
    ds_read_b64_tr_b16 v[210:211], v14 offset:4096
    s_waitcnt vmcnt(8)
    s_waitcnt lgkmcnt(0)
    s_barrier
    s_xor_b32 s68, s3, 1
    s_lshl_b32 s68, s68, 15
    s_add_u32 s68, s68, s59
    s_add_u32 s65, s68, 0
    s_add_u32 m0, s52, 0
    s_nop 0
    buffer_load_dwordx4 v12, s[8:11], s65 offen  lds
    s_add_u32 s65, s68, 4096
    s_add_u32 m0, s52, 4096
    s_nop 0
    buffer_load_dwordx4 v12, s[8:11], s65 offen  lds
    ds_read_b64_tr_b16 v[204:205], v13 offset:8192
    ds_read_b64_tr_b16 v[206:207], v13 offset:12288
    ds_read_b64_tr_b16 v[212:213], v14 offset:8192
    ds_read_b64_tr_b16 v[214:215], v14 offset:12288
    s_waitcnt vmcnt(8)
    s_waitcnt lgkmcnt(0)
    s_barrier
    s_add_u32 s65, s68, 2048
    s_add_u32 m0, s52, 8192
    s_nop 0
    buffer_load_dwordx4 v12, s[8:11], s65 offen  lds
    s_add_u32 s65, s68, 6144
    s_add_u32 m0, s52, 12288
    s_nop 0
    buffer_load_dwordx4 v12, s[8:11], s65 offen  lds
    ds_read_b64_tr_b16 a[168:169], v20 offset:16384
    ds_read_b64_tr_b16 a[184:185], v21 offset:16384
    ds_read_b64_tr_b16 a[216:217], v22 offset:16384
    ds_read_b64_tr_b16 a[232:233], v23 offset:16384
    buffer_load_dword v24, v25, s[12:15], 0 offen sc1
    s_waitcnt vmcnt(9)
    s_waitcnt lgkmcnt(0)
    s_barrier
    s_add_u32 s65, s68, 8192
    s_add_u32 m0, s52, 16384
    s_nop 0
    buffer_load_dwordx4 v12, s[8:11], s65 offen  lds
    s_add_u32 s65, s68, 12288
    s_add_u32 m0, s52, 20480
    s_nop 0
    buffer_load_dwordx4 v12, s[8:11], s65 offen  lds
    ds_read_b64_tr_b16 a[170:171], v20 offset:24576
    ds_read_b64_tr_b16 a[186:187], v21 offset:24576
    ds_read_b64_tr_b16 a[218:219], v22 offset:24576
    ds_read_b64_tr_b16 a[234:235], v23 offset:24576
    s_waitcnt vmcnt(9)
    s_waitcnt lgkmcnt(0)
    s_barrier
    s_add_u32 s65, s68, 10240
    s_add_u32 m0, s52, 24576
    s_nop 0
    buffer_load_dwordx4 v12, s[8:11], s65 offen  lds
    s_add_u32 s65, s68, 14336
    s_add_u32 m0, s52, 28672
    s_nop 0
    buffer_load_dwordx4 v12, s[8:11], s65 offen  lds
    ds_read_b64_tr_b16 a[172:173], v20 offset:32768
    ds_read_b64_tr_b16 a[188:189], v21 offset:32768
    ds_read_b64_tr_b16 a[220:221], v22 offset:32768
    ds_read_b64_tr_b16 a[236:237], v23 offset:32768
    s_waitcnt vmcnt(9)
    s_waitcnt lgkmcnt(0)
    s_barrier
    s_xor_b32 s68, s3, 2
    s_lshl_b32 s68, s68, 15
    s_add_u32 s68, s68, s59
    s_add_u32 s65, s68, 0
    s_add_u32 m0, s52, 32768
    s_nop 0
    buffer_load_dwordx4 v12, s[8:11], s65 offen  lds
    s_add_u32 s65, s68, 4096
    s_add_u32 m0, s52, 36864
    s_nop 0
    buffer_load_dwordx4 v12, s[8:11], s65 offen  lds
    ds_read_b64_tr_b16 a[174:175], v20 offset:40960
    ds_read_b64_tr_b16 a[190:191], v21 offset:40960
    ds_read_b64_tr_b16 a[222:223], v22 offset:40960
    ds_read_b64_tr_b16 a[238:239], v23 offset:40960
    s_waitcnt vmcnt(9)
    s_waitcnt lgkmcnt(0)
    s_barrier
    ds_read_b64_tr_b16 v[56:57], v20 offset:0
    ds_read_b64_tr_b16 a[192:193], v21 offset:0
    ds_read_b64_tr_b16 v[64:65], v22 offset:0
    ds_read_b64_tr_b16 a[240:241], v23 offset:0
    s_waitcnt vmcnt(7)
    s_waitcnt lgkmcnt(0)
    s_barrier
    s_add_u32 s65, s68, 2048
    s_add_u32 m0, s52, 0
    s_nop 0
    buffer_load_dwordx4 v12, s[8:11], s65 offen  lds
    s_add_u32 s65, s68, 6144
    s_add_u32 m0, s52, 4096
    s_nop 0
    buffer_load_dwordx4 v12, s[8:11], s65 offen  lds
    ds_read_b64_tr_b16 v[58:59], v20 offset:8192
    ds_read_b64_tr_b16 a[194:195], v21 offset:8192
    ds_read_b64_tr_b16 v[66:67], v22 offset:8192
    ds_read_b64_tr_b16 a[242:243], v23 offset:8192
    s_waitcnt vmcnt(6)
    s_waitcnt lgkmcnt(0)
    s_barrier
    s_add_u32 s65, s68, 8192
    s_add_u32 m0, s52, 8192
    s_nop 0
    buffer_load_dwordx4 v12, s[8:11], s65 offen  lds
    s_add_u32 s65, s68, 12288
    s_add_u32 m0, s52, 12288
    s_nop 0
    buffer_load_dwordx4 v12, s[8:11], s65 offen  lds
    ds_read_b64_tr_b16 v[60:61], v20 offset:16384
    ds_read_b64_tr_b16 a[196:197], v21 offset:16384
    ds_read_b64_tr_b16 v[68:69], v22 offset:16384
    ds_read_b64_tr_b16 a[244:245], v23 offset:16384
    v_and_b32 v18, 0x80808080, v24
    v_cmp_ne_u32 vcc, 0x80808080, v18
    s_cbranch_vccnz C_roster
C_roster_ok:
    buffer_load_dwordx2 v[26:27], off, s[4:7], s58 sc1
    s_waitcnt vmcnt(7)
    s_waitcnt lgkmcnt(0)
    s_barrier
    s_add_u32 s65, s68, 10240
    s_add_u32 m0, s52, 16384
    s_nop 0
    buffer_load_dwordx4 v12, s[8:11], s65 offen  lds
    s_add_u32 s65, s68, 14336
    s_add_u32 m0, s52, 20480
    s_nop 0
    buffer_load_dwordx4 v12, s[8:11], s65 offen  lds
    ds_read_b64_tr_b16 v[62:63], v20 offset:24576
    ds_read_b64_tr_b16 a[198:199], v21 offset:24576
    ds_read_b64_tr_b16 v[70:71], v22 offset:24576
    ds_read_b64_tr_b16 a[246:247], v23 offset:24576
    ds_write_b128 v94, v[56:59] offset:0
    s_waitcnt lgkmcnt(4)
    ds_write_b128 v94, v[60:63] offset:1024
    ds_write_b128 v94, v[64:67] offset:4096
    s_waitcnt lgkmcnt(4)
    ds_write_b128 v94, v[68:71] offset:5120
    s_waitcnt vmcnt(7)
    s_waitcnt lgkmcnt(4)
    s_barrier
    s_xor_b32 s68, s3, 3
    s_lshl_b32 s68, s68, 15
    s_add_u32 s68, s68, s59
    s_add_u32 s65, s68, 0
    s_add_u32 m0, s52, 24576
    s_nop 0
    buffer_load_dwordx4 v12, s[8:11], s65 offen  lds
    s_add_u32 s65, s68, 4096
    s_add_u32 m0, s52, 28672
    s_nop 0
    buffer_load_dwordx4 v12, s[8:11], s65 offen  lds
    ds_read_b64_tr_b16 v[56:57], v20 offset:32768
    ds_read_b64_tr_b16 a[200:201], v21 offset:32768
    ds_read_b64_tr_b16 a[224:225], v22 offset:32768
    ds_read_b64_tr_b16 a[248:249], v23 offset:32768
    s_waitcnt vmcnt(7)
    s_waitcnt lgkmcnt(0)
    s_barrier
    s_add_u32 s65, s68, 2048
    s_add_u32 m0, s52, 32768
    s_nop 0
    buffer_load_dwordx4 v12, s[8:11], s65 offen  lds
    s_add_u32 s65, s68, 6144
    s_add_u32 m0, s52, 36864
    s_nop 0
    buffer_load_dwordx4 v12, s[8:11], s65 offen  lds
    ds_read_b64_tr_b16 v[58:59], v20 offset:0
    ds_read_b64_tr_b16 a[202:203], v21 offset:0
    ds_read_b64_tr_b16 a[226:227], v22 offset:0
    ds_read_b64_tr_b16 a[250:251], v23 offset:0
    s_waitcnt vmcnt(7)
    s_waitcnt lgkmcnt(0)
    s_barrier
    s_add_u32 s65, s68, 8192
    s_add_u32 m0, s52, 0
    s_nop 0
    buffer_load_dwordx4 v12, s[8:11], s65 offen  lds
    s_add_u32 s65, s68, 12288
    s_add_u32 m0, s52, 4096
    s_nop 0
    buffer_load_dwordx4 v12, s[8:11], s65 offen  lds
    ds_read_b64_tr_b16 v[60:61], v20 offset:8192
    ds_read_b64_tr_b16 a[204:205], v21 offset:8192
    ds_read_b64_tr_b16 a[228:229], v22 offset:8192
    ds_read_b64_tr_b16 a[252:253], v23 offset:8192
    s_waitcnt vmcnt(6)
    s_waitcnt lgkmcnt(0)
    s_barrier
    s_add_u32 s65, s68, 10240
    s_add_u32 m0, s52, 8192
    s_nop 0
    buffer_load_dwordx4 v12, s[8:11], s65 offen  lds
    s_add_u32 s65, s68, 14336
    s_add_u32 m0, s52, 12288
    s_nop 0
    buffer_load_dwordx4 v12, s[8:11], s65 offen  lds
    ds_read_b64_tr_b16 v[62:63], v20 offset:16384
    ds_read_b64_tr_b16 a[206:207], v21 offset:16384
    ds_read_b64_tr_b16 a[230:231], v22 offset:16384
    ds_read_b64_tr_b16 a[254:255], v23 offset:16384
    ds_write_b128 v94, v[56:59] offset:2048
    s_waitcnt lgkmcnt(4)
    ds_write_b128 v94, v[60:63] offset:3072
    s_waitcnt vmcnt(6)
    s_waitcnt lgkmcnt(2)
    s_barrier
    ds_read_b64_tr_b16 a[176:177], v20 offset:24576
    ds_read_b64_tr_b16 a[208:209], v21 offset:24576
    ds_read_b64_tr_b16 v[56:57], v22 offset:24576
    ds_read_b64_tr_b16 v[64:65], v23 offset:24576
    v_min_u32 v18, v26, v27
    v_cmp_eq_u32 vcc, 0, v18
    s_cbranch_vccnz C_kv0
C_kv0_ok:
    buffer_load_dwordx4 v[104:107], v93, s[4:7], s56 offen offset:0 sc1
    buffer_load_dwordx4 v[108:111], v93, s[4:7], s56 offen offset:1024 sc1
    buffer_load_dwordx4 v[112:115], v93, s[4:7], s56 offen offset:2048 sc1
    buffer_load_dwordx4 v[116:119], v93, s[4:7], s56 offen offset:3072 sc1
    s_waitcnt vmcnt(8)
    s_waitcnt lgkmcnt(0)
    s_barrier
    ds_read_b64_tr_b16 a[178:179], v20 offset:32768
    ds_read_b64_tr_b16 a[210:211], v21 offset:32768
    ds_read_b64_tr_b16 v[58:59], v22 offset:32768
    ds_read_b64_tr_b16 v[66:67], v23 offset:32768
    s_waitcnt vmcnt(6)
    s_waitcnt lgkmcnt(0)
    s_barrier
    ds_read_b64_tr_b16 a[180:181], v20 offset:0
    ds_read_b64_tr_b16 a[212:213], v21 offset:0
    ds_read_b64_tr_b16 v[60:61], v22 offset:0
    ds_read_b64_tr_b16 v[68:69], v23 offset:0
    s_waitcnt vmcnt(4)
    s_waitcnt lgkmcnt(0)
    s_barrier
    ds_read_b64_tr_b16 a[182:183], v20 offset:8192
    ds_read_b64_tr_b16 a[214:215], v21 offset:8192
    ds_read_b64_tr_b16 v[62:63], v22 offset:8192
    ds_read_b64_tr_b16 v[70:71], v23 offset:8192
    ds_write_b128 v94, v[56:59] offset:6144
    s_waitcnt lgkmcnt(2)
    ds_write_b128 v94, v[60:63] offset:7168
    ds_write_b128 v94, v[64:67] offset:8192
    s_waitcnt lgkmcnt(3)
    ds_write_b128 v94, v[68:71] offset:9216
    s_waitcnt lgkmcnt(0)
    s_barrier
    s_lshl_b32 s65, s3, 11
    v_add_u32 v16, s65, v93
    ds_write_b128 v16, v[0:3] offset:0
    ds_write_b128 v16, v[4:7] offset:1024
    s_mov_b32 s60, 0
    v_mov_b32 v102, -1
    s_mov_b32 s51, 0xe4000
    s_xor_b32 s54, s51, 32768
    s_mov_b32 s55, 0x100000
    s_or_b32 s65, s71, 0x80
    s_mul_i32 s65, s65, 0x01010101
    v_cmp_ne_u32 vcc, s65, v24
    s_add_u32 s16, s42, s45
    s_mov_b32 s17, s43
    s_add_u32 s18, s42, s46
    s_mov_b32 s19, s43
    s_add_u32 s20, s42, s47
    s_mov_b32 s21, s43
    s_add_u32 s22, s42, s48
    s_mov_b32 s23, s43
    s_add_u32 s24, s42, s49
    s_mov_b32 s25, s43
    s_add_u32 s26, s42, s50
    s_mov_b32 s27, s43
    ds_read_b128 v[56:59], v94 offset:10240
    ds_read_b128 v[60:63], v94 offset:11264
    ds_read_b128 v[64:67], v94 offset:12288
    ds_read_b128 v[68:71], v94 offset:13312
    v_mov_b64 v[32:33], 0
    v_mov_b64 v[34:35], 0
    v_mov_b64 v[36:37], 0
    v_mov_b64 v[38:39], 0
    v_mov_b64 v[40:41], 0
    v_mov_b64 v[42:43], 0
    v_mov_b64 v[44:45], 0
    v_mov_b64 v[46:47], 0
    v_mov_b64 v[48:49], 0
    v_mov_b64 v[50:51], 0
    v_mov_b64 v[52:53], 0
    v_mov_b64 v[54:55], 0
    s_waitcnt vmcnt(3)
    v_mov_b64 v[72:73], v[104:105]
    v_mov_b64 v[74:75], v[106:107]
    s_waitcnt vmcnt(2)
    v_mov_b64 v[76:77], v[108:109]
    v_mov_b64 v[78:79], v[110:111]
    s_waitcnt vmcnt(1)
    v_mov_b64 v[80:81], v[112:113]
    v_mov_b64 v[82:83], v[114:115]
    s_waitcnt vmcnt(0)
    v_mov_b64 v[84:85], v[116:117]
    v_mov_b64 v[86:87], v[118:119]
    s_lshr_b64 s[90:91], vcc, 16
    s_add_u32 s56, s56, 0x80000
    s_add_u32 s58, s58, 8
    s_mov_b32 s59, 0
    s_mov_b32 s67, 0xe0000
    v_lshrrev_b32 v54, 2, v93
    v_mov_b32 v55, -1
    s_lshl_b32 s45, s44, 8
    s_lshl_b32 s65, s3, 11
    s_add_u32 m0, s65, 0
    s_mov_b32 s28, 0xf0000
    s_mov_b32 s29, 0
    s_mov_b32 s63, 0xffc00000
    s_mov_b32 s30, 0xaaaaaaaa
    s_mov_b32 s31, 0xaaaaaaaa
    s_waitcnt vmcnt(0) lgkmcnt(0)
    s_cmp_lg_u64 s[90:91], 0
    s_cbranch_scc1 C_safe
    s_cmp_eq_u32 s3, 0
    s_cbranch_scc1 C_poll2_f0
    s_cmp_eq_u32 s3, 1
    s_cbranch_scc1 C_poll2_f1
    s_cmp_eq_u32 s3, 2
    s_cbranch_scc1 C_poll2_f2
    s_branch C_poll2_f3
C_safe:
    s_cmp_eq_u32 s3, 0
    s_cbranch_scc1 C_poll2_s0
    s_cmp_eq_u32 s3, 1
    s_cbranch_scc1 C_poll2_s1
    s_cmp_eq_u32 s3, 2
    s_cbranch_scc1 C_poll2_s2
    s_branch C_poll2_s3
C_roster:
    buffer_load_dword v24, v25, s[12:15], 0 offen sc1
    s_sub_u32 s69, s69, 1
    s_cbranch_scc1 C_fail
    s_waitcnt vmcnt(0)
    v_and_b32 v18, 0x80808080, v24
    v_cmp_ne_u32 vcc, 0x80808080, v18
    s_cbranch_vccnz C_roster
    s_branch C_roster_ok
C_kv0:
    buffer_load_dwordx2 v[26:27], off, s[4:7], s58 sc1
    s_sub_u32 s69, s69, 1
    s_cbranch_scc1 C_fail
    s_waitcnt vmcnt(0)
    v_min_u32 v18, v26, v27
    v_cmp_eq_u32 vcc, 0, v18
    s_cbranch_vccnz C_kv0
    s_branch C_kv0_ok
C_done:
    s_mov_b64 exec, 0xffff
    buffer_store_dword v28, v103, s[4:7], s55 offen sc1
    s_mov_b64 exec, -1
    s_lshl_b32 s65, s44, 2
    s_add_u32 s65, s65, s3
    s_cmp_lg_u32 s65, 3
    s_cbranch_scc1 C_nowb
    s_waitcnt vmcnt(0)
    buffer_wbl2 sc1
C_nowb:
    s_endpgm
C_fail:
    s_endpgm
.p2align 6
C_base_f0:
    s_nop 0
    s_nop 0
    s_nop 0
C_trok_f0:
    buffer_load_dwordx4 v93, s[4:7], s52 offen offset:0 sc1 lds
    buffer_load_dwordx4 v93, s[4:7], s52 offen offset:1024 sc1 lds
    v_mov_b64 v[72:73], v[104:105]
    v_mov_b64 v[74:75], v[106:107]
    v_mov_b64 v[76:77], v[108:109]
    v_mov_b64 v[78:79], v[110:111]
    v_mov_b64 v[80:81], v[112:113]
    v_mov_b64 v[82:83], v[114:115]
    v_mov_b64 v[84:85], v[116:117]
    v_mov_b64 v[86:87], v[118:119]
C_poll2_f0:
    s_waitcnt vmcnt(0)
    s_barrier
    ds_read_b128 v[0:3], v93 offset:0
    ds_read_b128 v[4:7], v93 offset:1024
    global_store_dword v54, v55, s[26:27] offset:0
    global_store_dword v54, v55, s[26:27] offset:256
    global_store_dword v54, v55, s[26:27] offset:512
C_go1_f0:
    s_waitcnt lgkmcnt(1)
    v_smfmac_f32_16x16x64_bf16 v[32:35], v[0:3], v[56:63], v92
    buffer_load_dwordx4 v[104:107], v93, s[4:7], s56 offen offset:0 sc1
    s_waitcnt lgkmcnt(0)
    v_smfmac_f32_16x16x64_bf16 v[32:35], v[4:7], v[120:127], v92
    s_barrier
    v_smfmac_f32_16x16x64_bf16 v[36:39], v[0:3], v[64:71], v92
    v_smfmac_f32_16x16x64_bf16 v[40:43], v[0:3], v[216:223], v92
    ds_read_b128 v[8:11], v93 offset:2048
    v_smfmac_f32_16x16x64_bf16 v[36:39], v[4:7], v[128:135], v92
    ds_read_b128 v[12:15], v93 offset:3072
    buffer_load_dwordx4 v[108:111], v93, s[4:7], s56 offen offset:1024 sc1
    v_smfmac_f32_16x16x64_bf16 v[40:43], v[4:7], v[232:239], v92
    ds_read_b128 v[56:59], v94 offset:14336
    v_smfmac_f32_16x16x64_bf16 v[44:47], v[0:3], v[224:231], v92
    ds_read_b128 v[60:63], v94 offset:15360
    v_smfmac_f32_16x16x64_bf16 v[44:47], v[4:7], v[240:247], v92
    s_barrier
    ds_read_b128 v[16:19], v93 offset:4096
    s_waitcnt lgkmcnt(4)
    v_smfmac_f32_16x16x64_bf16 v[32:35], v[8:11], v[136:143], v92
    ds_read_b128 v[20:23], v93 offset:5120
    buffer_load_dwordx4 v[112:115], v93, s[4:7], s56 offen offset:2048 sc1
    s_waitcnt lgkmcnt(4)
    v_smfmac_f32_16x16x64_bf16 v[32:35], v[12:15], v[152:159], v92
    ds_read_b128 v[64:67], v94 offset:16384
    v_smfmac_f32_16x16x64_bf16 v[36:39], v[8:11], v[144:151], v92
    ds_read_b128 v[68:71], v94 offset:17408
    v_smfmac_f32_16x16x64_bf16 v[36:39], v[12:15], v[160:167], v92
    s_barrier
    s_waitcnt lgkmcnt(3)
    v_smfmac_f32_16x16x64_bf16 v[32:35], v[16:19], v[56:63], v92
    ds_read_b128 v[24:27], v93 offset:6144
    buffer_load_dwordx4 v[116:119], v93, s[4:7], s56 offen offset:3072 sc1
    s_waitcnt lgkmcnt(3)
    v_smfmac_f32_16x16x64_bf16 v[32:35], v[20:23], v[168:175], v92
    ds_read_b128 v[28:31], v93 offset:7168
C_go2_f0:
    v_smfmac_f32_16x16x64_bf16 v[36:39], v[20:23], v[176:183], v92
    ds_read_b128 v[56:59], v94 offset:22528
    s_waitcnt lgkmcnt(3)
    v_smfmac_f32_16x16x64_bf16 v[36:39], v[16:19], v[64:71], v92
    ds_read_b128 v[60:63], v94 offset:23552
    s_waitcnt lgkmcnt(3)
    v_smfmac_f32_16x16x64_bf16 v[32:35], v[24:27], v[184:191], v92
    ds_read_b128 v[64:67], v94 offset:24576
    global_store_dword v54, v55, s[26:27] offset:768
    s_waitcnt lgkmcnt(3)
    v_smfmac_f32_16x16x64_bf16 v[32:35], v[28:31], v[200:207], v92
    ds_read_b128 v[68:71], v94 offset:25600
    v_mov_b64 v[48:49], 0
    v_smfmac_f32_16x16x64_bf16 v[36:39], v[24:27], v[192:199], v92
    global_store_dword v54, v55, s[26:27] offset:1024
    v_mov_b64 v[50:51], 0
    v_smfmac_f32_16x16x64_bf16 v[36:39], v[28:31], v[208:215], v92
    global_store_dword v54, v55, s[26:27] offset:1280
    s_waitcnt lgkmcnt(2)
    v_mul_f32 v33, s62, v33
    v_mul_f32 v35, s62, v35
    v_smfmac_f32_16x16x64_bf16 v[40:43], v[16:19], v[56:63], v92
    global_store_dword v54, v55, s[26:27] offset:1536
    v_fma_f32 v32, v32, s62, v33
    v_fma_f32 v34, v34, s62, v35
    v_smfmac_f32_16x16x64_bf16 v[40:43], v[8:11], v[248:255], v92
    ds_read_b128 v[56:59], v94 offset:26624
    v_mul_f32 v37, s62, v37
    v_mul_f32 v39, s62, v39
    v_smfmac_f32_16x16x64_bf16 v[40:43], v[12:15], a[8:15], v92
    ds_read_b128 v[60:63], v94 offset:27648
    v_fma_f32 v36, v36, s62, v37
    v_fma_f32 v38, v38, s62, v39
    v_smfmac_f32_16x16x64_bf16 v[40:43], v[24:27], a[24:31], v92
    global_store_dword v54, v55, s[26:27] offset:1792
    s_waitcnt lgkmcnt(2)
    v_cvt_pk_bf16_f32 v32, v32, v36
    v_cvt_pk_bf16_f32 v33, v34, v38
    v_smfmac_f32_16x16x64_bf16 v[44:47], v[16:19], v[64:71], v92
    ds_write2_b32 v96, v32, v33 offset0:0 offset1:72
    v_smfmac_f32_16x16x64_bf16 v[40:43], v[28:31], a[40:47], v92
    ds_read_b128 v[64:67], v94 offset:28672
    v_cmp_u_f32 vcc, v36, v38
    v_smfmac_f32_16x16x64_bf16 v[44:47], v[8:11], a[0:7], v92
    ds_read_b128 v[68:71], v94 offset:29696
    s_waitcnt lgkmcnt(3)
    v_mov_b64 v[32:33], 0
    v_smfmac_f32_16x16x64_bf16 v[40:43], v[20:23], v[56:63], v92
    buffer_store_dword v55, v103, s[4:7], s54 offen
    v_smfmac_f32_16x16x64_bf16 v[44:47], v[12:15], a[16:23], v92
    s_cbranch_vccnz C_retry2_f0
C_ok2_f0:
    v_mov_b64 v[34:35], 0
    v_mov_b64 v[54:55], 0
    v_smfmac_f32_16x16x64_bf16 v[44:47], v[24:27], a[32:39], v92
    s_waitcnt lgkmcnt(2)
    s_barrier
    ds_read_b128 v[56:59], v98 offset:0
    v_smfmac_f32_16x16x64_bf16 v[44:47], v[28:31], a[48:55], v92
    ds_read_b128 v[60:63], v98 offset:64
    s_waitcnt lgkmcnt(2)
    v_add_f32 v40, v40, v41
    v_smfmac_f32_16x16x64_bf16 v[44:47], v[20:23], v[64:71], v92
    ds_read_b128 v[64:67], v98 offset:128
    v_add_f32 v42, v42, v43
    v_smfmac_f32_16x16x64_bf16 v[48:51], v[0:3], a[56:63], v92
    ds_read_b128 v[68:71], v98 offset:192
    v_smfmac_f32_16x16x64_bf16 v[48:51], v[4:7], a[72:79], v92
    v_add_f32 v44, v44, v45
    v_add_f32 v46, v46, v47
    v_smfmac_f32_16x16x64_bf16 v[52:55], v[0:3], a[64:71], v92
    s_waitcnt lgkmcnt(2)
    v_cvt_pk_bf16_f32 v40, v40, v44
    v_cvt_pk_bf16_f32 v41, v42, v46
    v_smfmac_f32_16x16x64_bf16 v[32:35], v[72:75], v[56:63], v92
    ds_write2_b32 v97, v40, v41 offset0:0 offset1:80
    s_waitcnt lgkmcnt(1)
    v_smfmac_f32_16x16x64_bf16 v[32:35], v[76:79], v[64:71], v92
    ds_read_b128 v[0:3], v94 offset:18432
    v_mov_b64 v[36:37], 0
    v_smfmac_f32_16x16x64_bf16 v[52:55], v[4:7], a[80:87], v92
    ds_read_b128 v[4:7], v94 offset:19456
    v_mov_b64 v[38:39], 0
    v_smfmac_f32_16x16x64_bf16 v[48:51], v[8:11], a[88:95], v92
    v_add_f32 v32, v32, v33
    v_add_f32 v33, v34, v35
    v_smfmac_f32_16x16x64_bf16 v[48:51], v[12:15], a[104:111], v92
    s_waitcnt lgkmcnt(2)
    s_barrier
    v_exp_f32 v34, v32
    v_smfmac_f32_16x16x64_bf16 v[48:51], v[16:19], a[120:127], v92
    ds_read_b128 v[72:75], v99
    s_waitcnt lgkmcnt(1)
    v_smfmac_f32_16x16x64_bf16 v[48:51], v[28:31], v[0:7], v92
    ds_read_b128 v[76:79], v99 offset:128
    v_exp_f32 v35, v33
    v_smfmac_f32_16x16x64_bf16 v[48:51], v[20:23], a[136:143], v92
    v_cvt_pk_bf16_f32 v34, v34, v35
    v_smfmac_f32_16x16x64_bf16 v[48:51], v[24:27], a[152:159], v92
    ds_write_b32 v100, v34
    s_waitcnt lgkmcnt(2)
    v_smfmac_f32_16x16x64_bf16 v[36:39], v[72:75], v[56:63], v92
    s_waitcnt lgkmcnt(1)
    v_mov_b64 v[0:1], 0
    v_smfmac_f32_16x16x64_bf16 v[36:39], v[76:79], v[64:71], v92
    ds_read_b128 v[56:59], v94 offset:20480
    v_cvt_pk_bf16_f32 v48, v48, v50
    v_smfmac_f32_16x16x64_bf16 v[52:55], v[8:11], a[96:103], v92
    ds_read_b128 v[60:63], v94 offset:21504
    v_cvt_pk_bf16_f32 v49, v49, v51
    v_smfmac_f32_16x16x64_bf16 v[52:55], v[12:15], a[112:119], v92
    s_waitcnt lgkmcnt(2)
    s_barrier
    ds_read_b128 v[40:43], v93 offset:13056
    v_add_f32 v36, v36, v37
    v_smfmac_f32_16x16x64_bf16 v[52:55], v[16:19], a[128:135], v92
    ds_read_b128 v[64:67], v94 offset:0
    ds_read_b128 v[68:71], v94 offset:1024
    v_add_f32 v37, v38, v39
    v_smfmac_f32_16x16x64_bf16 v[52:55], v[20:23], a[144:151], v92
    s_waitcnt lgkmcnt(3)
    v_exp_f32 v38, v36
    v_smfmac_f32_16x16x64_bf16 v[52:55], v[28:31], v[56:63], v92
    ds_read_b128 v[8:11], v94 offset:2048
    v_exp_f32 v39, v37
    v_smfmac_f32_16x16x64_bf16 v[52:55], v[24:27], a[160:167], v92
    ds_read_b128 v[12:15], v94 offset:3072
    s_waitcnt lgkmcnt(4)
    v_mfma_f32_16x16x32_bf16 v[72:75], v[80:83], v[40:43], 0
    v_cvt_pk_bf16_f32 v17, v38, v39
    v_mov_b64 v[2:3], 0
    v_mfma_f32_16x16x32_bf16 v[76:79], v[84:87], v[40:43], 0
    v_cvt_pk_bf16_f32 v16, v38, v39
    v_cvt_pk_bf16_f32 v52, v52, v54
    v_cvt_pk_bf16_f32 v53, v53, v55
    v_mfma_f32_16x16x16_bf16 v[72:75], v[48:49], v[16:17], v[72:75]
    v_cvt_pk_bf16_f32 v18, v38, v39
    v_mov_b32 v19, 0
    v_mfma_f32_16x16x16_bf16 v[76:79], v[52:53], v[16:17], v[76:79]
    v_mov_b64 v[4:5], 0
    v_mov_b64 v[6:7], 0
    v_mfma_f32_16x16x32_bf16 v[44:47], v[40:43], v[88:91], 0
    v_cvt_pk_bf16_f32 v20, v72, v73
    v_cvt_pk_bf16_f32 v21, v74, v75
    s_mov_b64 exec, s[30:31]
    v_cvt_pk_bf16_f32 v20, v76, v77
    v_cvt_pk_bf16_f32 v21, v78, v79
    s_mov_b64 exec, -1
    ds_write_b64 v95, v[20:21] offset:14080
    v_mfma_f32_16x16x16_bf16 v[44:47], v[18:19], v[88:89], v[44:47]
    v_cvt_pk_bf16_f32 v72, v72, v73
    v_cvt_pk_bf16_f32 v73, v74, v75
    v_cvt_pk_bf16_f32 v74, v76, v77
    v_cvt_pk_bf16_f32 v75, v78, v79
    v_mov_b64 v[56:57], 0
    v_mov_b64 v[58:59], 0
    v_smfmac_f32_16x16x64_bf16 v[0:3], v[72:75], a[168:175], v92
    v_and_b32 v50, 0x1f0, v95
    v_smfmac_f32_16x16x64_bf16 v[4:7], v[72:75], a[184:191], v92
    s_waitcnt lgkmcnt(0)
    s_barrier
    ds_read_b128 v[20:23], v50 offset:14592
    v_mov_b64 v[60:61], 0
    v_mov_b64 v[62:63], 0
    v_smfmac_f32_16x16x64_bf16 v[56:59], v[72:75], a[216:223], v92
    ds_read_b128 v[24:27], v50 offset:15104
    v_lshrrev_b32 v54, 2, v93
    v_smfmac_f32_16x16x64_bf16 v[60:63], v[72:75], a[232:239], v92
    ds_read_b128 v[28:31], v50 offset:15616
    v_rcp_f32 v34, v44
    v_rcp_f32 v35, v46
    s_nop 0
    s_waitcnt lgkmcnt(2)
    v_smfmac_f32_16x16x64_bf16 v[0:3], v[20:23], v[64:71], v92
    ds_read_b128 v[72:75], v94 offset:4096
    s_waitcnt lgkmcnt(2)
    v_max3_f32 v39, v44, v46, v34
    v_smfmac_f32_16x16x64_bf16 v[0:3], v[24:27], v[8:15], v92
    ds_read_b128 v[76:79], v94 offset:5120
    s_waitcnt lgkmcnt(2)
    v_max_f32 v39, v39, v35
    v_smfmac_f32_16x16x64_bf16 v[0:3], v[28:31], a[176:183], v92
    ds_read_b128 v[40:43], v94 offset:6144
    v_cmp_lt_f32 vcc, s64, v39
    v_smfmac_f32_16x16x64_bf16 v[4:7], v[20:23], a[192:199], v92
    ds_read_b128 v[44:47], v94 offset:7168
    v_smfmac_f32_16x16x64_bf16 v[4:7], v[24:27], a[200:207], v92
    s_cbranch_vccnz C_slow_f0
C_after_f0:
    v_mul_f32 v0, v0, v34
    v_mul_f32 v1, v1, v34
    v_mul_f32 v2, v2, v35
    v_mul_f32 v3, v3, v35
    v_cvt_pk_bf16_f32 v0, v0, v1
    v_cvt_pk_bf16_f32 v1, v2, v3
    v_smfmac_f32_16x16x64_bf16 v[4:7], v[28:31], a[208:215], v92
    global_store_dword v101, v0, s[16:17]
    global_store_dword v101, v1, s[16:17] offset:2048
    s_waitcnt lgkmcnt(2)
    v_smfmac_f32_16x16x64_bf16 v[56:59], v[20:23], v[72:79], v92
    ds_read_b128 v[80:83], v94 offset:8192
    v_mov_b64 v[16:17], 0
    v_smfmac_f32_16x16x64_bf16 v[56:59], v[24:27], a[224:231], v92
    ds_read_b128 v[84:87], v94 offset:9216
    s_waitcnt lgkmcnt(2)
    v_mul_f32 v4, v4, v34
    v_mul_f32 v5, v5, v34
    v_mul_f32 v6, v6, v35
    v_mul_f32 v7, v7, v35
    v_cvt_pk_bf16_f32 v4, v4, v5
    v_cvt_pk_bf16_f32 v5, v6, v7
    v_smfmac_f32_16x16x64_bf16 v[56:59], v[28:31], v[40:47], v92
    global_store_dword v101, v4, s[18:19]
    global_store_dword v101, v5, s[18:19] offset:2048
    v_smfmac_f32_16x16x64_bf16 v[60:63], v[20:23], a[240:247], v92
    v_mov_b64 v[18:19], 0
    v_smfmac_f32_16x16x64_bf16 v[60:63], v[24:27], a[248:255], v92
    s_waitcnt lgkmcnt(0)
    v_mul_f32 v56, v56, v34
    v_mul_f32 v57, v57, v34
    v_mul_f32 v58, v58, v35
    v_mul_f32 v59, v59, v35
    v_cvt_pk_bf16_f32 v56, v56, v57
    v_cvt_pk_bf16_f32 v57, v58, v59
    v_smfmac_f32_16x16x64_bf16 v[60:63], v[28:31], v[80:87], v92
    global_store_dword v101, v56, s[20:21]
    global_store_dword v101, v57, s[20:21] offset:2048
    v_mov_b64 v[4:5], 0
    v_mov_b64 v[6:7], 0
    v_and_b32 v51, 0x80, v54
    v_lshl_add_u32 v51, v51, 23, v54
    v_mov_b32 v49, -1
    s_nop 0
    v_mul_f32 v60, v60, v34
    v_mul_f32 v61, v61, v34
    v_mul_f32 v62, v62, v35
    v_mul_f32 v63, v63, v35
    v_cvt_pk_bf16_f32 v60, v60, v61
    v_cvt_pk_bf16_f32 v61, v62, v63
    global_store_dword v101, v60, s[22:23]
    global_store_dword v101, v61, s[22:23] offset:2048
    s_add_u32 s55, s55, 16384
    s_add_u32 s72, s51, s73
    s_add_u32 s52, s51, 0
    s_mov_b32 s26, s24
    s_waitcnt vmcnt(6)
C_ld1_f0:
    global_load_dword v8, v54, s[24:25] offset:0 sc1
    global_load_dword v9, v54, s[24:25] offset:256 sc1
    global_load_dword v10, v54, s[24:25] offset:512 sc1
    global_load_dword v11, v54, s[24:25] offset:768 sc1
    global_load_dword v12, v54, s[24:25] offset:1024 sc1
    global_load_dword v13, v54, s[24:25] offset:1280 sc1
    global_load_dword v14, v54, s[24:25] offset:1536 sc1
    global_load_dword v15, v54, s[24:25] offset:1792 sc1
C_red_f0:
    s_waitcnt vmcnt(0)
    v_smfmac_f32_16x16x64_bf16 v[16:19], v[88:91], v[8:15], v92 abid:1
    s_mov_b64 exec, s[28:29]
    s_nop 6
    buffer_store_dword v16, v103, s[4:7], s51 offen
    s_mov_b64 exec, 0xffff
    v_cvt_pk_bf16_f32 v28, v16, v17
    buffer_store_dword v28, v103, s[4:7], s51 offen
    v_cmp_u_f32 vcc, v16, v17
    s_mov_b64 exec, -1
    s_cbranch_vccnz C_retry0_f0
C_ok1_f0:
    s_add_u32 s60, s60, 1
    s_cmp_eq_u32 s60, 63
    s_cbranch_scc1 C_done
C_flagok_f0:
    v_mov_b32 v55, -1
    v_mov_b64 v[40:41], 0
    buffer_load_dword v49, v51, s[4:7], s72 offen sc1
    v_mov_b64 v[42:43], 0
    v_mov_b64 v[44:45], 0
    v_mov_b64 v[46:47], 0
    v_mov_b64 v[52:53], 0
    v_mov_b64 v[32:33], 0
    v_mov_b64 v[34:35], 0
    v_mov_b64 v[36:37], 0
    buffer_load_dword v49, v51, s[4:7], s72 offen sc1
    v_mov_b64 v[38:39], 0
    s_xor_b32 s16, s16, 0x80000
    s_xor_b32 s18, s18, 0x80000
    s_xor_b32 s20, s20, 0x80000
    s_xor_b32 s22, s22, 0x80000
    s_add_u32 s56, s56, 0x80000
    ds_read_b128 v[56:59], v94 offset:10240
    buffer_load_dword v49, v51, s[4:7], s72 offen sc1
    s_mov_b32 s67, s51
    s_add_u32 s51, s51, 16384
    ds_read_b128 v[60:63], v94 offset:11264
    s_bitset0_b32 s51, 16
    s_xor_b32 s54, s51, 32768
    ds_read_b128 v[64:67], v94 offset:12288
    s_xor_b32 s24, s24, 0x80000
    buffer_load_dword v49, v51, s[4:7], s72 offen sc1
    ds_read_b128 v[68:71], v94 offset:13312
    buffer_load_dword v49, v51, s[4:7], s72 offen sc1
C_tr_f0:
    s_waitcnt vmcnt(4)
    v_cmp_le_u32 vcc, s63, v49
    buffer_load_dword v49, v51, s[4:7], s72 offen sc1
    s_cbranch_vccz C_trok_f0
    s_waitcnt vmcnt(4)
    v_cmp_le_u32 vcc, s63, v49
    buffer_load_dword v49, v51, s[4:7], s72 offen sc1
    s_cbranch_vccz C_trok_f0
    s_waitcnt vmcnt(4)
    v_cmp_le_u32 vcc, s63, v49
    buffer_load_dword v49, v51, s[4:7], s72 offen sc1
    s_cbranch_vccz C_trok_f0
    s_waitcnt vmcnt(4)
    v_cmp_le_u32 vcc, s63, v49
    buffer_load_dword v49, v51, s[4:7], s72 offen sc1
    s_cbranch_vccz C_trok_f0
    s_waitcnt vmcnt(4)
    v_cmp_le_u32 vcc, s63, v49
    buffer_load_dword v49, v51, s[4:7], s72 offen sc1
    s_cbranch_vccz C_trok_f0
    s_waitcnt vmcnt(4)
    v_cmp_le_u32 vcc, s63, v49
    buffer_load_dword v49, v51, s[4:7], s72 offen sc1
    s_cbranch_vccz C_trok_f0
    s_sub_u32 s69, s69, 1
    s_cbranch_scc0 C_tr_f0
    s_branch C_fail
C_retry2_f0:
    v_max_u32 v37, v0, v1
    v_max3_u32 v37, v37, v2, v3
    v_max3_u32 v37, v37, v4, v5
    v_max3_u32 v37, v37, v6, v7
    v_max3_u32 v37, v37, v8, v9
    v_max3_u32 v37, v37, v10, v11
    v_max3_u32 v37, v37, v12, v13
    v_max3_u32 v37, v37, v14, v15
    v_max3_u32 v37, v37, v16, v17
    v_max3_u32 v37, v37, v18, v19
    v_max3_u32 v37, v37, v20, v21
    v_max3_u32 v37, v37, v22, v23
    v_max3_u32 v37, v37, v24, v25
    v_max3_u32 v37, v37, v26, v27
    v_max3_u32 v37, v37, v28, v29
    v_max3_u32 v37, v37, v30, v31
    v_cmp_le_u32 vcc, s61, v37
    s_cbranch_vccz C_ok2_f0
C_rr_f0:
    s_mov_b32 m0, 0
    s_add_u32 s65, s67, 0
    buffer_load_dwordx4 v93, s[4:7], s65 offen offset:0 sc1 lds
    buffer_load_dwordx4 v93, s[4:7], s65 offen offset:1024 sc1 lds
    buffer_load_dwordx4 v93, s[4:7], s65 offen offset:2048 sc1 lds
    buffer_load_dwordx4 v93, s[4:7], s65 offen offset:3072 sc1 lds
    s_mov_b32 m0, 4096
    s_add_u32 s65, s67, 4096
    buffer_load_dwordx4 v93, s[4:7], s65 offen offset:0 sc1 lds
    buffer_load_dwordx4 v93, s[4:7], s65 offen offset:1024 sc1 lds
    buffer_load_dwordx4 v93, s[4:7], s65 offen offset:2048 sc1 lds
    buffer_load_dwordx4 v93, s[4:7], s65 offen offset:3072 sc1 lds
    s_sub_u32 s69, s69, 1
    s_cbranch_scc1 C_fail
    s_waitcnt vmcnt(0) lgkmcnt(0)
    ds_read_b128 v[0:3], v93 offset:0
    ds_read_b128 v[4:7], v93 offset:1024
    ds_read_b128 v[8:11], v93 offset:2048
    ds_read_b128 v[12:15], v93 offset:3072
    ds_read_b128 v[16:19], v93 offset:4096
    ds_read_b128 v[20:23], v93 offset:5120
    ds_read_b128 v[24:27], v93 offset:6144
    ds_read_b128 v[28:31], v93 offset:7168
    s_waitcnt lgkmcnt(0)
    v_max_u32 v37, v0, v1
    v_max3_u32 v37, v37, v2, v3
    v_max3_u32 v37, v37, v4, v5
    v_max3_u32 v37, v37, v6, v7
    v_max3_u32 v37, v37, v8, v9
    v_max3_u32 v37, v37, v10, v11
    v_max3_u32 v37, v37, v12, v13
    v_max3_u32 v37, v37, v14, v15
    v_max3_u32 v37, v37, v16, v17
    v_max3_u32 v37, v37, v18, v19
    v_max3_u32 v37, v37, v20, v21
    v_max3_u32 v37, v37, v22, v23
    v_max3_u32 v37, v37, v24, v25
    v_max3_u32 v37, v37, v26, v27
    v_max3_u32 v37, v37, v28, v29
    v_max3_u32 v37, v37, v30, v31
    v_cmp_le_u32 vcc, s61, v37
    s_cbranch_vccz C_rg_f0
    s_branch C_rr_f0
C_rg_f0:
    v_mov_b64 v[32:33], 0
    v_mov_b64 v[34:35], 0
    v_mov_b64 v[36:37], 0
    v_mov_b64 v[38:39], 0
    v_mov_b64 v[40:41], 0
    v_mov_b64 v[42:43], 0
    v_mov_b64 v[44:45], 0
    v_mov_b64 v[46:47], 0
    s_mov_b32 m0, 0
    ds_read_b128 v[56:59], v94 offset:10240
    ds_read_b128 v[60:63], v94 offset:11264
    s_waitcnt lgkmcnt(0)
    v_smfmac_f32_16x16x64_bf16 v[32:35], v[0:3], v[56:63], v92
    ds_read_b128 v[64:67], v94 offset:12288
    ds_read_b128 v[68:71], v94 offset:13312
    s_waitcnt lgkmcnt(0)
    v_smfmac_f32_16x16x64_bf16 v[36:39], v[0:3], v[64:71], v92
    v_smfmac_f32_16x16x64_bf16 v[32:35], v[4:7], v[120:127], v92
    v_smfmac_f32_16x16x64_bf16 v[36:39], v[4:7], v[128:135], v92
    v_smfmac_f32_16x16x64_bf16 v[40:43], v[0:3], v[216:223], v92
    v_smfmac_f32_16x16x64_bf16 v[40:43], v[4:7], v[232:239], v92
    v_smfmac_f32_16x16x64_bf16 v[44:47], v[0:3], v[224:231], v92
    v_smfmac_f32_16x16x64_bf16 v[44:47], v[4:7], v[240:247], v92
    v_smfmac_f32_16x16x64_bf16 v[32:35], v[8:11], v[136:143], v92
    v_smfmac_f32_16x16x64_bf16 v[32:35], v[12:15], v[152:159], v92
    v_smfmac_f32_16x16x64_bf16 v[36:39], v[8:11], v[144:151], v92
    v_smfmac_f32_16x16x64_bf16 v[36:39], v[12:15], v[160:167], v92
    ds_read_b128 v[56:59], v94 offset:14336
    ds_read_b128 v[60:63], v94 offset:15360
    s_waitcnt lgkmcnt(0)
    v_smfmac_f32_16x16x64_bf16 v[32:35], v[16:19], v[56:63], v92
    v_smfmac_f32_16x16x64_bf16 v[32:35], v[20:23], v[168:175], v92
    ds_read_b128 v[64:67], v94 offset:16384
    ds_read_b128 v[68:71], v94 offset:17408
    s_waitcnt lgkmcnt(0)
    s_branch C_go2_f0
C_retry0_f0:
    global_load_dword v20, v54, s[24:25] offset:0 sc1
    global_load_dword v21, v54, s[24:25] offset:256 sc1
    global_load_dword v22, v54, s[24:25] offset:512 sc1
    global_load_dword v23, v54, s[24:25] offset:768 sc1
    global_load_dword v24, v54, s[24:25] offset:1024 sc1
    global_load_dword v25, v54, s[24:25] offset:1280 sc1
    global_load_dword v26, v54, s[24:25] offset:1536 sc1
    global_load_dword v27, v54, s[24:25] offset:1792 sc1
    s_waitcnt vmcnt(0)
C_retry1_f0:
    s_waitcnt vmcnt(1)
C_r1b_f0:
    v_smfmac_f32_16x16x64_bf16 v[4:7], v[88:91], v[20:27], v92 abid:1
    global_load_dword v8, v54, s[24:25] offset:0 sc1
    global_load_dword v9, v54, s[24:25] offset:256 sc1
    global_load_dword v10, v54, s[24:25] offset:512 sc1
    global_load_dword v11, v54, s[24:25] offset:768 sc1
    global_load_dword v12, v54, s[24:25] offset:1024 sc1
    global_load_dword v13, v54, s[24:25] offset:1280 sc1
    global_load_dword v14, v54, s[24:25] offset:1536 sc1
    global_load_dword v15, v54, s[24:25] offset:1792 sc1
    v_mov_b64 v[16:17], 0
    v_mov_b64 v[18:19], 0
    v_cvt_pk_bf16_f32 v28, v4, v5
    buffer_store_dword v28, v103, s[4:7], s51 offen
    v_cmp_u_f32 vcc, v4, v5
    s_cbranch_vccz C_ok1_f0
    v_max3_u32 v6, v20, v21, v22
    v_max3_u32 v7, v23, v24, v25
    v_max3_u32 v6, v6, v26, v27
    v_max_u32 v6, v6, v7
    v_cmp_eq_u32 vcc, -1, v6
    global_load_dword v20, v54, s[24:25] offset:0 sc1
    global_load_dword v21, v54, s[24:25] offset:256 sc1
    global_load_dword v22, v54, s[24:25] offset:512 sc1
    global_load_dword v23, v54, s[24:25] offset:768 sc1
    global_load_dword v24, v54, s[24:25] offset:1024 sc1
    global_load_dword v25, v54, s[24:25] offset:1280 sc1
    global_load_dword v26, v54, s[24:25] offset:1536 sc1
    global_load_dword v27, v54, s[24:25] offset:1792 sc1
    s_cbranch_vccz C_nan1_f0
    v_mov_b64 v[4:5], 0
    v_mov_b64 v[6:7], 0
    s_sub_u32 s69, s69, 1
    s_cbranch_scc1 C_fail
    s_waitcnt vmcnt(9)
    v_smfmac_f32_16x16x64_bf16 v[16:19], v[88:91], v[8:15], v92 abid:1
    s_nop 7
    v_cvt_pk_bf16_f32 v28, v16, v17
    buffer_store_dword v28, v103, s[4:7], s51 offen
    v_cmp_u_f32 vcc, v16, v17
    s_cbranch_vccz C_ok1_f0
    s_branch C_retry1_f0
C_nan1_f0:
    v_cmp_le_u32 vcc, s63, v28
    v_and_b32 v6, 0x7fffffff, v28
    s_nop 0
    v_cndmask_b32 v28, v28, v6, vcc
    buffer_store_dword v28, v103, s[4:7], s51 offen
    s_waitcnt vmcnt(0)
    s_branch C_ok1_f0
C_flag_f0:
    buffer_load_dword v102, off, s[4:7], s58 sc1
    s_sub_u32 s69, s69, 1
    s_cbranch_scc1 C_fail
    s_waitcnt vmcnt(0)
    v_readfirstlane_b32 s70, v102
    s_nop 3
    s_cmp_le_u32 s70, s59
    s_cbranch_scc1 C_flag_f0
    s_branch C_flagok_f0
C_slow_f0:
    s_waitcnt lgkmcnt(0)
    s_nop 7
    v_max3_f32 v77, v32, v33, v36
    v_max_f32 v77, v77, v37
    v_bfe_u32 v76, v93, 4, 4
    v_lshlrev_b32 v76, 6, v76
    v_lshrrev_b32 v78, 8, v93
    v_lshl_add_u32 v78, v78, 2, v76
    ds_write_b32 v78, v77 offset:8192
    s_waitcnt lgkmcnt(0)
    s_barrier
    ds_read_b128 v[20:23], v76 offset:8192
    ds_read_b128 v[24:27], v76 offset:8208
    ds_read_b128 v[28:31], v76 offset:8224
    ds_read_b128 v[72:75], v76 offset:8240
    s_waitcnt lgkmcnt(3)
    v_max3_f32 v77, v77, v20, v21
    v_max3_f32 v77, v77, v22, v23
    s_waitcnt lgkmcnt(2)
    v_max3_f32 v77, v77, v24, v25
    v_max3_f32 v77, v77, v26, v27
    s_waitcnt lgkmcnt(1)
    v_max3_f32 v77, v77, v28, v29
    v_max3_f32 v77, v77, v30, v31
    s_waitcnt lgkmcnt(0)
    v_max3_f32 v77, v77, v72, v73
    v_max3_f32 v77, v77, v74, v75
    v_sub_f32 v34, v32, v77
    v_sub_f32 v35, v33, v77
    v_sub_f32 v38, v36, v77
    v_sub_f32 v39, v37, v77
    v_exp_f32 v34, v34
    v_exp_f32 v35, v35
    v_exp_f32 v38, v38
    v_exp_f32 v39, v39
    v_cvt_pk_bf16_f32 v34, v34, v35
    v_cvt_pk_bf16_f32 v16, v38, v39
    v_cvt_pk_bf16_f32 v17, v38, v39
    v_cvt_pk_bf16_f32 v18, v38, v39
    ds_write_b32 v100, v34
    s_waitcnt lgkmcnt(0)
    s_barrier
    ds_read_b128 v[40:43], v93 offset:13056
    v_mov_b64 v[0:1], 0
    v_mov_b64 v[2:3], 0
    v_mov_b64 v[4:5], 0
    v_mov_b64 v[6:7], 0
    v_mov_b64 v[56:57], 0
    v_mov_b64 v[58:59], 0
    v_mov_b64 v[60:61], 0
    v_mov_b64 v[62:63], 0
    s_waitcnt lgkmcnt(0)
    v_mfma_f32_16x16x32_bf16 v[44:47], v[40:43], v[88:91], 0
    v_mfma_f32_16x16x32_bf16 v[72:75], v[80:83], v[40:43], 0
    v_mfma_f32_16x16x32_bf16 v[76:79], v[84:87], v[40:43], 0
    v_mfma_f32_16x16x16_bf16 v[44:47], v[18:19], v[88:89], v[44:47]
    v_mfma_f32_16x16x16_bf16 v[72:75], v[48:49], v[16:17], v[72:75]
    v_mfma_f32_16x16x16_bf16 v[76:79], v[52:53], v[16:17], v[76:79]
    s_nop 7
    v_cvt_pk_bf16_f32 v20, v72, v73
    v_cvt_pk_bf16_f32 v21, v74, v75
    s_mov_b64 exec, s[30:31]
    v_cvt_pk_bf16_f32 v20, v76, v77
    v_cvt_pk_bf16_f32 v21, v78, v79
    s_mov_b64 exec, -1
    ds_write_b64 v95, v[20:21] offset:14080
    v_cvt_pk_bf16_f32 v72, v72, v73
    v_cvt_pk_bf16_f32 v73, v74, v75
    v_cvt_pk_bf16_f32 v74, v76, v77
    v_cvt_pk_bf16_f32 v75, v78, v79
    s_nop 1
    v_smfmac_f32_16x16x64_bf16 v[0:3], v[72:75], a[168:175], v92
    v_and_b32 v50, 0x1f0, v95
    v_smfmac_f32_16x16x64_bf16 v[4:7], v[72:75], a[184:191], v92
    s_waitcnt lgkmcnt(0)
    s_barrier
    ds_read_b128 v[20:23], v50 offset:14592
    v_mov_b64 v[60:61], 0
    v_mov_b64 v[62:63], 0
    v_smfmac_f32_16x16x64_bf16 v[56:59], v[72:75], a[216:223], v92
    ds_read_b128 v[24:27], v50 offset:15104
    v_lshrrev_b32 v54, 2, v93
    v_smfmac_f32_16x16x64_bf16 v[60:63], v[72:75], a[232:239], v92
    ds_read_b128 v[28:31], v50 offset:15616
    v_rcp_f32 v34, v44
    v_rcp_f32 v35, v46
    s_nop 0
    s_waitcnt lgkmcnt(2)
    v_smfmac_f32_16x16x64_bf16 v[0:3], v[20:23], v[64:71], v92
    ds_read_b128 v[72:75], v94 offset:4096
    v_max3_f32 v39, v44, v46, v34
    s_waitcnt lgkmcnt(2)
    v_smfmac_f32_16x16x64_bf16 v[0:3], v[24:27], v[8:15], v92
    ds_read_b128 v[76:79], v94 offset:5120
    v_max_f32 v39, v39, v35
    s_waitcnt lgkmcnt(2)
    v_smfmac_f32_16x16x64_bf16 v[0:3], v[28:31], a[176:183], v92
    ds_read_b128 v[40:43], v94 offset:6144
    v_cmp_lt_f32 vcc, s64, v39
    v_smfmac_f32_16x16x64_bf16 v[4:7], v[20:23], a[192:199], v92
    ds_read_b128 v[44:47], v94 offset:7168
    v_smfmac_f32_16x16x64_bf16 v[4:7], v[24:27], a[200:207], v92
    s_waitcnt lgkmcnt(0)
    s_branch C_after_f0
.p2align 6
C_base_f1:
    s_nop 0
    s_nop 0
    s_nop 0
C_trok_f1:
    buffer_load_dwordx4 v93, s[4:7], s52 offen offset:0 sc1 lds
    buffer_load_dwordx4 v93, s[4:7], s52 offen offset:1024 sc1 lds
    v_mov_b64 v[82:83], v[114:115]
    v_mov_b64 v[84:85], v[116:117]
    v_mov_b64 v[86:87], v[118:119]
C_poll2_f1:
    s_barrier
    ds_read_b128 v[0:3], v93 offset:0
    ds_read_b128 v[4:7], v93 offset:1024
    global_store_dword v54, v55, s[26:27] offset:0
    global_store_dword v54, v55, s[26:27] offset:256
    global_store_dword v54, v55, s[26:27] offset:512
C_go1_f1:
    s_waitcnt lgkmcnt(1)
    v_smfmac_f32_16x16x64_bf16 v[32:35], v[0:3], v[56:63], v92
    buffer_load_dword v102, off, s[4:7], s58 sc1
    s_waitcnt lgkmcnt(0)
    v_smfmac_f32_16x16x64_bf16 v[32:35], v[4:7], v[120:127], v92
    s_waitcnt vmcnt(4)
    s_barrier
    buffer_load_dwordx4 v[104:107], v93, s[4:7], s56 offen offset:0 sc1
    v_smfmac_f32_16x16x64_bf16 v[36:39], v[0:3], v[64:71], v92
    v_smfmac_f32_16x16x64_bf16 v[40:43], v[0:3], v[216:223], v92
    ds_read_b128 v[8:11], v93 offset:2048
    v_smfmac_f32_16x16x64_bf16 v[36:39], v[4:7], v[128:135], v92
    ds_read_b128 v[12:15], v93 offset:3072
    v_smfmac_f32_16x16x64_bf16 v[40:43], v[4:7], v[232:239], v92
    ds_read_b128 v[56:59], v94 offset:14336
    buffer_load_dwordx4 v[108:111], v93, s[4:7], s56 offen offset:1024 sc1
    v_smfmac_f32_16x16x64_bf16 v[44:47], v[0:3], v[224:231], v92
    ds_read_b128 v[60:63], v94 offset:15360
    v_smfmac_f32_16x16x64_bf16 v[44:47], v[4:7], v[240:247], v92
    s_barrier
    ds_read_b128 v[16:19], v93 offset:4096
    s_waitcnt lgkmcnt(4)
    v_smfmac_f32_16x16x64_bf16 v[32:35], v[8:11], v[136:143], v92
    ds_read_b128 v[20:23], v93 offset:5120
    s_waitcnt lgkmcnt(4)
    v_smfmac_f32_16x16x64_bf16 v[32:35], v[12:15], v[152:159], v92
    ds_read_b128 v[64:67], v94 offset:16384
    buffer_load_dwordx4 v[112:115], v93, s[4:7], s56 offen offset:2048 sc1
    v_smfmac_f32_16x16x64_bf16 v[36:39], v[8:11], v[144:151], v92
    ds_read_b128 v[68:71], v94 offset:17408
    v_smfmac_f32_16x16x64_bf16 v[36:39], v[12:15], v[160:167], v92
    s_barrier
    s_waitcnt lgkmcnt(3)
    v_smfmac_f32_16x16x64_bf16 v[32:35], v[16:19], v[56:63], v92
    ds_read_b128 v[24:27], v93 offset:6144
    s_waitcnt lgkmcnt(3)
    v_smfmac_f32_16x16x64_bf16 v[32:35], v[20:23], v[168:175], v92
    ds_read_b128 v[28:31], v93 offset:7168
    buffer_load_dwordx4 v[116:119], v93, s[4:7], s56 offen offset:3072 sc1
C_go2_f1:
    v_smfmac_f32_16x16x64_bf16 v[36:39], v[20:23], v[176:183], v92
    ds_read_b128 v[56:59], v94 offset:22528
    s_waitcnt lgkmcnt(3)
    v_smfmac_f32_16x16x64_bf16 v[36:39], v[16:19], v[64:71], v92
    ds_read_b128 v[60:63], v94 offset:23552
    s_waitcnt lgkmcnt(3)
    v_smfmac_f32_16x16x64_bf16 v[32:35], v[24:27], v[184:191], v92
    ds_read_b128 v[64:67], v94 offset:24576
    global_store_dword v54, v55, s[26:27] offset:768
    s_waitcnt lgkmcnt(3)
    v_smfmac_f32_16x16x64_bf16 v[32:35], v[28:31], v[200:207], v92
    ds_read_b128 v[68:71], v94 offset:25600
    v_mov_b64 v[48:49], 0
    v_smfmac_f32_16x16x64_bf16 v[36:39], v[24:27], v[192:199], v92
    global_store_dword v54, v55, s[26:27] offset:1024
    v_mov_b64 v[50:51], 0
    v_smfmac_f32_16x16x64_bf16 v[36:39], v[28:31], v[208:215], v92
    global_store_dword v54, v55, s[26:27] offset:1280
    s_waitcnt lgkmcnt(2)
    v_mul_f32 v33, s62, v33
    v_mul_f32 v35, s62, v35
    v_smfmac_f32_16x16x64_bf16 v[40:43], v[16:19], v[56:63], v92
    global_store_dword v54, v55, s[26:27] offset:1536
    v_fma_f32 v32, v32, s62, v33
    v_fma_f32 v34, v34, s62, v35
    v_smfmac_f32_16x16x64_bf16 v[40:43], v[8:11], v[248:255], v92
    ds_read_b128 v[56:59], v94 offset:26624
    v_mul_f32 v37, s62, v37
    v_mul_f32 v39, s62, v39
    v_smfmac_f32_16x16x64_bf16 v[40:43], v[12:15], a[8:15], v92
    ds_read_b128 v[60:63], v94 offset:27648
    v_fma_f32 v36, v36, s62, v37
    v_fma_f32 v38, v38, s62, v39
    v_smfmac_f32_16x16x64_bf16 v[40:43], v[24:27], a[24:31], v92
    global_store_dword v54, v55, s[26:27] offset:1792
    s_waitcnt lgkmcnt(2)
    v_cvt_pk_bf16_f32 v32, v32, v36
    v_cvt_pk_bf16_f32 v33, v34, v38
    v_smfmac_f32_16x16x64_bf16 v[44:47], v[16:19], v[64:71], v92
    ds_write2_b32 v96, v32, v33 offset0:0 offset1:72
    v_smfmac_f32_16x16x64_bf16 v[40:43], v[28:31], a[40:47], v92
    ds_read_b128 v[64:67], v94 offset:28672
    v_cmp_u_f32 vcc, v36, v38
    v_smfmac_f32_16x16x64_bf16 v[44:47], v[8:11], a[0:7], v92
    ds_read_b128 v[68:71], v94 offset:29696
    s_waitcnt lgkmcnt(3)
    v_mov_b64 v[32:33], 0
    v_smfmac_f32_16x16x64_bf16 v[40:43], v[20:23], v[56:63], v92
    buffer_store_dword v55, v103, s[4:7], s54 offen
    v_smfmac_f32_16x16x64_bf16 v[44:47], v[12:15], a[16:23], v92
    s_cbranch_vccnz C_retry2_f1
C_ok2_f1:
    v_mov_b64 v[34:35], 0
    v_mov_b64 v[54:55], 0
    v_smfmac_f32_16x16x64_bf16 v[44:47], v[24:27], a[32:39], v92
    s_waitcnt lgkmcnt(2)
    s_barrier
    ds_read_b128 v[56:59], v98 offset:0
    v_smfmac_f32_16x16x64_bf16 v[44:47], v[28:31], a[48:55], v92
    ds_read_b128 v[60:63], v98 offset:64
    s_waitcnt lgkmcnt(2)
    v_add_f32 v40, v40, v41
    v_smfmac_f32_16x16x64_bf16 v[44:47], v[20:23], v[64:71], v92
    ds_read_b128 v[64:67], v98 offset:128
    v_add_f32 v42, v42, v43
    v_smfmac_f32_16x16x64_bf16 v[48:51], v[0:3], a[56:63], v92
    ds_read_b128 v[68:71], v98 offset:192
    v_smfmac_f32_16x16x64_bf16 v[48:51], v[4:7], a[72:79], v92
    v_add_f32 v44, v44, v45
    v_add_f32 v46, v46, v47
    v_smfmac_f32_16x16x64_bf16 v[52:55], v[0:3], a[64:71], v92
    s_waitcnt lgkmcnt(2)
    v_cvt_pk_bf16_f32 v40, v40, v44
    v_cvt_pk_bf16_f32 v41, v42, v46
    v_smfmac_f32_16x16x64_bf16 v[32:35], v[72:75], v[56:63], v92
    ds_write2_b32 v97, v40, v41 offset0:0 offset1:80
    s_waitcnt lgkmcnt(1)
    v_smfmac_f32_16x16x64_bf16 v[32:35], v[76:79], v[64:71], v92
    ds_read_b128 v[0:3], v94 offset:18432
    v_mov_b64 v[36:37], 0
    v_smfmac_f32_16x16x64_bf16 v[52:55], v[4:7], a[80:87], v92
    ds_read_b128 v[4:7], v94 offset:19456
    v_mov_b64 v[38:39], 0
    v_smfmac_f32_16x16x64_bf16 v[48:51], v[8:11], a[88:95], v92
    v_add_f32 v32, v32, v33
    v_add_f32 v33, v34, v35
    v_smfmac_f32_16x16x64_bf16 v[48:51], v[12:15], a[104:111], v92
    s_waitcnt lgkmcnt(2)
    s_barrier
    v_exp_f32 v34, v32
    v_smfmac_f32_16x16x64_bf16 v[48:51], v[16:19], a[120:127], v92
    ds_read_b128 v[72:75], v99
    s_waitcnt lgkmcnt(1)
    v_smfmac_f32_16x16x64_bf16 v[48:51], v[28:31], v[0:7], v92
    ds_read_b128 v[76:79], v99 offset:128
    v_exp_f32 v35, v33
    v_smfmac_f32_16x16x64_bf16 v[48:51], v[20:23], a[136:143], v92
    v_cvt_pk_bf16_f32 v34, v34, v35
    v_smfmac_f32_16x16x64_bf16 v[48:51], v[24:27], a[152:159], v92
    ds_write_b32 v100, v34
    s_waitcnt lgkmcnt(2)
    v_smfmac_f32_16x16x64_bf16 v[36:39], v[72:75], v[56:63], v92
    s_waitcnt lgkmcnt(1)
    v_mov_b64 v[0:1], 0
    v_smfmac_f32_16x16x64_bf16 v[36:39], v[76:79], v[64:71], v92
    ds_read_b128 v[56:59], v94 offset:20480
    v_cvt_pk_bf16_f32 v48, v48, v50
    v_smfmac_f32_16x16x64_bf16 v[52:55], v[8:11], a[96:103], v92
    ds_read_b128 v[60:63], v94 offset:21504
    v_cvt_pk_bf16_f32 v49, v49, v51
    v_smfmac_f32_16x16x64_bf16 v[52:55], v[12:15], a[112:119], v92
    s_waitcnt lgkmcnt(2)
    s_barrier
    ds_read_b128 v[40:43], v93 offset:13056
    v_add_f32 v36, v36, v37
    v_smfmac_f32_16x16x64_bf16 v[52:55], v[16:19], a[128:135], v92
    ds_read_b128 v[64:67], v94 offset:0
    ds_read_b128 v[68:71], v94 offset:1024
    v_add_f32 v37, v38, v39
    v_smfmac_f32_16x16x64_bf16 v[52:55], v[20:23], a[144:151], v92
    s_waitcnt lgkmcnt(3)
    v_exp_f32 v38, v36
    v_smfmac_f32_16x16x64_bf16 v[52:55], v[28:31], v[56:63], v92
    ds_read_b128 v[8:11], v94 offset:2048
    v_exp_f32 v39, v37
    v_smfmac_f32_16x16x64_bf16 v[52:55], v[24:27], a[160:167], v92
    ds_read_b128 v[12:15], v94 offset:3072
    s_waitcnt lgkmcnt(4)
    v_mfma_f32_16x16x32_bf16 v[72:75], v[80:83], v[40:43], 0
    v_cvt_pk_bf16_f32 v17, v38, v39
    v_mov_b64 v[2:3], 0
    v_mfma_f32_16x16x32_bf16 v[76:79], v[84:87], v[40:43], 0
    v_cvt_pk_bf16_f32 v16, v38, v39
    v_cvt_pk_bf16_f32 v52, v52, v54
    v_cvt_pk_bf16_f32 v53, v53, v55
    v_mfma_f32_16x16x16_bf16 v[72:75], v[48:49], v[16:17], v[72:75]
    v_cvt_pk_bf16_f32 v18, v38, v39
    v_mov_b32 v19, 0
    v_mfma_f32_16x16x16_bf16 v[76:79], v[52:53], v[16:17], v[76:79]
    v_mov_b64 v[4:5], 0
    v_mov_b64 v[6:7], 0
    v_mfma_f32_16x16x32_bf16 v[44:47], v[40:43], v[88:91], 0
    v_cvt_pk_bf16_f32 v20, v72, v73
    v_cvt_pk_bf16_f32 v21, v74, v75
    s_mov_b64 exec, s[30:31]
    v_cvt_pk_bf16_f32 v20, v76, v77
    v_cvt_pk_bf16_f32 v21, v78, v79
    s_mov_b64 exec, -1
    ds_write_b64 v95, v[20:21] offset:14592
    v_mfma_f32_16x16x16_bf16 v[44:47], v[18:19], v[88:89], v[44:47]
    v_cvt_pk_bf16_f32 v72, v72, v73
    v_cvt_pk_bf16_f32 v73, v74, v75
    v_cvt_pk_bf16_f32 v74, v76, v77
    v_cvt_pk_bf16_f32 v75, v78, v79
    v_mov_b64 v[56:57], 0
    v_mov_b64 v[58:59], 0
    v_smfmac_f32_16x16x64_bf16 v[0:3], v[72:75], a[168:175], v92
    v_and_b32 v50, 0x1f0, v95
    v_smfmac_f32_16x16x64_bf16 v[4:7], v[72:75], a[184:191], v92
    s_waitcnt lgkmcnt(0)
    s_barrier
    ds_read_b128 v[20:23], v50 offset:14080
    v_mov_b64 v[60:61], 0
    v_mov_b64 v[62:63], 0
    v_smfmac_f32_16x16x64_bf16 v[56:59], v[72:75], a[216:223], v92
    ds_read_b128 v[24:27], v50 offset:15616
    v_lshrrev_b32 v54, 2, v93
    v_smfmac_f32_16x16x64_bf16 v[60:63], v[72:75], a[232:239], v92
    ds_read_b128 v[28:31], v50 offset:15104
    v_rcp_f32 v34, v44
    v_rcp_f32 v35, v46
    s_nop 0
    s_waitcnt lgkmcnt(2)
    v_smfmac_f32_16x16x64_bf16 v[0:3], v[20:23], v[64:71], v92
    ds_read_b128 v[72:75], v94 offset:4096
    s_waitcnt lgkmcnt(2)
    v_max3_f32 v39, v44, v46, v34
    v_smfmac_f32_16x16x64_bf16 v[0:3], v[24:27], v[8:15], v92
    ds_read_b128 v[76:79], v94 offset:5120
    s_waitcnt lgkmcnt(2)
    v_max_f32 v39, v39, v35
    v_smfmac_f32_16x16x64_bf16 v[0:3], v[28:31], a[176:183], v92
    ds_read_b128 v[40:43], v94 offset:6144
    v_cmp_lt_f32 vcc, s64, v39
    v_smfmac_f32_16x16x64_bf16 v[4:7], v[20:23], a[192:199], v92
    ds_read_b128 v[44:47], v94 offset:7168
    v_smfmac_f32_16x16x64_bf16 v[4:7], v[24:27], a[200:207], v92
    s_cbranch_vccnz C_slow_f1
C_after_f1:
    v_mul_f32 v0, v0, v34
    v_mul_f32 v1, v1, v34
    v_mul_f32 v2, v2, v35
    v_mul_f32 v3, v3, v35
    v_cvt_pk_bf16_f32 v0, v0, v1
    v_cvt_pk_bf16_f32 v1, v2, v3
    v_smfmac_f32_16x16x64_bf16 v[4:7], v[28:31], a[208:215], v92
    global_store_dword v101, v0, s[16:17]
    global_store_dword v101, v1, s[16:17] offset:2048
    s_waitcnt lgkmcnt(2)
    v_smfmac_f32_16x16x64_bf16 v[56:59], v[20:23], v[72:79], v92
    ds_read_b128 v[80:83], v94 offset:8192
    v_mov_b64 v[16:17], 0
    v_smfmac_f32_16x16x64_bf16 v[56:59], v[24:27], a[224:231], v92
    ds_read_b128 v[84:87], v94 offset:9216
    s_waitcnt lgkmcnt(2)
    v_mul_f32 v4, v4, v34
    v_mul_f32 v5, v5, v34
    v_mul_f32 v6, v6, v35
    v_mul_f32 v7, v7, v35
    v_cvt_pk_bf16_f32 v4, v4, v5
    v_cvt_pk_bf16_f32 v5, v6, v7
    v_smfmac_f32_16x16x64_bf16 v[56:59], v[28:31], v[40:47], v92
    global_store_dword v101, v4, s[18:19]
    global_store_dword v101, v5, s[18:19] offset:2048
    v_smfmac_f32_16x16x64_bf16 v[60:63], v[20:23], a[240:247], v92
    v_mov_b64 v[18:19], 0
    v_smfmac_f32_16x16x64_bf16 v[60:63], v[24:27], a[248:255], v92
    s_waitcnt lgkmcnt(0)
    v_mul_f32 v56, v56, v34
    v_mul_f32 v57, v57, v34
    v_mul_f32 v58, v58, v35
    v_mul_f32 v59, v59, v35
    v_cvt_pk_bf16_f32 v56, v56, v57
    v_cvt_pk_bf16_f32 v57, v58, v59
    v_smfmac_f32_16x16x64_bf16 v[60:63], v[28:31], v[80:87], v92
    global_store_dword v101, v56, s[20:21]
    global_store_dword v101, v57, s[20:21] offset:2048
    v_mov_b64 v[4:5], 0
    v_mov_b64 v[6:7], 0
    v_and_b32 v51, 0x80, v54
    v_lshl_add_u32 v51, v51, 23, v54
    v_mov_b32 v49, -1
    s_nop 0
    v_mul_f32 v60, v60, v34
    v_mul_f32 v61, v61, v34
    v_mul_f32 v62, v62, v35
    v_mul_f32 v63, v63, v35
    v_cvt_pk_bf16_f32 v60, v60, v61
    v_cvt_pk_bf16_f32 v61, v62, v63
    global_store_dword v101, v60, s[22:23]
    global_store_dword v101, v61, s[22:23] offset:2048
    s_add_u32 s55, s55, 16384
    s_add_u32 s72, s51, s73
    s_add_u32 s52, s51, 2048
    s_mov_b32 s26, s24
    s_waitcnt vmcnt(4)
    v_mov_b32 v55, -1
    v_mov_b64 v[40:41], 0
    v_mov_b64 v[42:43], 0
    v_mov_b64 v[44:45], 0
    v_mov_b64 v[46:47], 0
C_ld1_f1:
    global_load_dword v8, v54, s[24:25] offset:0 sc1
    global_load_dword v9, v54, s[24:25] offset:256 sc1
    global_load_dword v10, v54, s[24:25] offset:512 sc1
    global_load_dword v11, v54, s[24:25] offset:768 sc1
    global_load_dword v12, v54, s[24:25] offset:1024 sc1
    global_load_dword v13, v54, s[24:25] offset:1280 sc1
    global_load_dword v14, v54, s[24:25] offset:1536 sc1
    global_load_dword v15, v54, s[24:25] offset:1792 sc1
C_red_f1:
    s_waitcnt vmcnt(0)
    v_smfmac_f32_16x16x64_bf16 v[16:19], v[88:91], v[8:15], v92 abid:1
    v_readfirstlane_b32 s70, v102
    s_mov_b64 exec, s[28:29]
    s_nop 3
    buffer_store_dword v16, v103, s[4:7], s51 offen
    s_mov_b64 exec, 0xffff
    v_cvt_pk_bf16_f32 v28, v16, v17
    buffer_store_dword v28, v103, s[4:7], s51 offen
    v_cmp_u_f32 vcc, v16, v17
    s_mov_b64 exec, -1
    s_cbranch_vccnz C_retry0_f1
C_ok1_f1:
    s_add_u32 s60, s60, 1
    s_cmp_eq_u32 s60, 63
    s_cbranch_scc1 C_done
    s_cmp_le_u32 s70, s59
    s_cbranch_scc1 C_flag_f1
C_flagok_f1:
    v_mov_b64 v[52:53], 0
    v_mov_b64 v[32:33], 0
    buffer_load_dword v49, v51, s[4:7], s72 offen sc1
    v_mov_b64 v[34:35], 0
    v_mov_b64 v[36:37], 0
    v_mov_b64 v[38:39], 0
    s_xor_b32 s16, s16, 0x80000
    s_xor_b32 s18, s18, 0x80000
    s_xor_b32 s20, s20, 0x80000
    s_xor_b32 s22, s22, 0x80000
    buffer_load_dword v49, v51, s[4:7], s72 offen sc1
    s_add_u32 s56, s56, 0x80000
    ds_read_b128 v[56:59], v94 offset:10240
    s_mov_b32 s67, s51
    s_add_u32 s51, s51, 16384
    ds_read_b128 v[60:63], v94 offset:11264
    s_bitset0_b32 s51, 16
    s_xor_b32 s54, s51, 32768
    buffer_load_dword v49, v51, s[4:7], s72 offen sc1
    ds_read_b128 v[64:67], v94 offset:12288
    s_xor_b32 s24, s24, 0x80000
    s_add_u32 s65, s60, 2
    ds_read_b128 v[68:71], v94 offset:13312
    s_lshr_b32 s59, s65, 2
    s_and_b32 s65, s65, 3
    s_lshl_b32 s65, s65, 2
    buffer_load_dword v49, v51, s[4:7], s72 offen sc1
    s_andn2_b32 s58, s58, 15
    s_or_b32 s58, s58, s65
    v_mov_b64 v[72:73], v[104:105]
    v_mov_b64 v[74:75], v[106:107]
    v_mov_b64 v[76:77], v[108:109]
    v_mov_b64 v[78:79], v[110:111]
    v_mov_b64 v[80:81], v[112:113]
    buffer_load_dword v49, v51, s[4:7], s72 offen sc1
C_tr_f1:
    s_waitcnt vmcnt(4)
    v_cmp_le_u32 vcc, s63, v49
    buffer_load_dword v49, v51, s[4:7], s72 offen sc1
    s_cbranch_vccz C_trok_f1
    s_waitcnt vmcnt(4)
    v_cmp_le_u32 vcc, s63, v49
    buffer_load_dword v49, v51, s[4:7], s72 offen sc1
    s_cbranch_vccz C_trok_f1
    s_waitcnt vmcnt(4)
    v_cmp_le_u32 vcc, s63, v49
    buffer_load_dword v49, v51, s[4:7], s72 offen sc1
    s_cbranch_vccz C_trok_f1
    s_waitcnt vmcnt(4)
    v_cmp_le_u32 vcc, s63, v49
    buffer_load_dword v49, v51, s[4:7], s72 offen sc1
    s_cbranch_vccz C_trok_f1
    s_waitcnt vmcnt(4)
    v_cmp_le_u32 vcc, s63, v49
    buffer_load_dword v49, v51, s[4:7], s72 offen sc1
    s_cbranch_vccz C_trok_f1
    s_waitcnt vmcnt(4)
    v_cmp_le_u32 vcc, s63, v49
    buffer_load_dword v49, v51, s[4:7], s72 offen sc1
    s_cbranch_vccz C_trok_f1
    s_sub_u32 s69, s69, 1
    s_cbranch_scc0 C_tr_f1
    s_branch C_fail
C_retry2_f1:
    v_max_u32 v37, v0, v1
    v_max3_u32 v37, v37, v2, v3
    v_max3_u32 v37, v37, v4, v5
    v_max3_u32 v37, v37, v6, v7
    v_max3_u32 v37, v37, v8, v9
    v_max3_u32 v37, v37, v10, v11
    v_max3_u32 v37, v37, v12, v13
    v_max3_u32 v37, v37, v14, v15
    v_max3_u32 v37, v37, v16, v17
    v_max3_u32 v37, v37, v18, v19
    v_max3_u32 v37, v37, v20, v21
    v_max3_u32 v37, v37, v22, v23
    v_max3_u32 v37, v37, v24, v25
    v_max3_u32 v37, v37, v26, v27
    v_max3_u32 v37, v37, v28, v29
    v_max3_u32 v37, v37, v30, v31
    v_cmp_le_u32 vcc, s61, v37
    s_cbranch_vccz C_ok2_f1
C_rr_f1:
    s_mov_b32 m0, 0
    s_add_u32 s65, s67, 0
    buffer_load_dwordx4 v93, s[4:7], s65 offen offset:0 sc1 lds
    buffer_load_dwordx4 v93, s[4:7], s65 offen offset:1024 sc1 lds
    buffer_load_dwordx4 v93, s[4:7], s65 offen offset:2048 sc1 lds
    buffer_load_dwordx4 v93, s[4:7], s65 offen offset:3072 sc1 lds
    s_mov_b32 m0, 4096
    s_add_u32 s65, s67, 4096
    buffer_load_dwordx4 v93, s[4:7], s65 offen offset:0 sc1 lds
    buffer_load_dwordx4 v93, s[4:7], s65 offen offset:1024 sc1 lds
    buffer_load_dwordx4 v93, s[4:7], s65 offen offset:2048 sc1 lds
    buffer_load_dwordx4 v93, s[4:7], s65 offen offset:3072 sc1 lds
    s_sub_u32 s69, s69, 1
    s_cbranch_scc1 C_fail
    s_waitcnt vmcnt(0) lgkmcnt(0)
    ds_read_b128 v[0:3], v93 offset:0
    ds_read_b128 v[4:7], v93 offset:1024
    ds_read_b128 v[8:11], v93 offset:2048
    ds_read_b128 v[12:15], v93 offset:3072
    ds_read_b128 v[16:19], v93 offset:4096
    ds_read_b128 v[20:23], v93 offset:5120
    ds_read_b128 v[24:27], v93 offset:6144
    ds_read_b128 v[28:31], v93 offset:7168
    s_waitcnt lgkmcnt(0)
    v_max_u32 v37, v0, v1
    v_max3_u32 v37, v37, v2, v3
    v_max3_u32 v37, v37, v4, v5
    v_max3_u32 v37, v37, v6, v7
    v_max3_u32 v37, v37, v8, v9
    v_max3_u32 v37, v37, v10, v11
    v_max3_u32 v37, v37, v12, v13
    v_max3_u32 v37, v37, v14, v15
    v_max3_u32 v37, v37, v16, v17
    v_max3_u32 v37, v37, v18, v19
    v_max3_u32 v37, v37, v20, v21
    v_max3_u32 v37, v37, v22, v23
    v_max3_u32 v37, v37, v24, v25
    v_max3_u32 v37, v37, v26, v27
    v_max3_u32 v37, v37, v28, v29
    v_max3_u32 v37, v37, v30, v31
    v_cmp_le_u32 vcc, s61, v37
    s_cbranch_vccz C_rg_f1
    s_branch C_rr_f1
C_rg_f1:
    v_mov_b64 v[32:33], 0
    v_mov_b64 v[34:35], 0
    v_mov_b64 v[36:37], 0
    v_mov_b64 v[38:39], 0
    v_mov_b64 v[40:41], 0
    v_mov_b64 v[42:43], 0
    v_mov_b64 v[44:45], 0
    v_mov_b64 v[46:47], 0
    s_mov_b32 m0, 2048
    ds_read_b128 v[56:59], v94 offset:10240
    ds_read_b128 v[60:63], v94 offset:11264
    s_waitcnt lgkmcnt(0)
    v_smfmac_f32_16x16x64_bf16 v[32:35], v[0:3], v[56:63], v92
    ds_read_b128 v[64:67], v94 offset:12288
    ds_read_b128 v[68:71], v94 offset:13312
    s_waitcnt lgkmcnt(0)
    v_smfmac_f32_16x16x64_bf16 v[36:39], v[0:3], v[64:71], v92
    v_smfmac_f32_16x16x64_bf16 v[32:35], v[4:7], v[120:127], v92
    v_smfmac_f32_16x16x64_bf16 v[36:39], v[4:7], v[128:135], v92
    v_smfmac_f32_16x16x64_bf16 v[40:43], v[0:3], v[216:223], v92
    v_smfmac_f32_16x16x64_bf16 v[40:43], v[4:7], v[232:239], v92
    v_smfmac_f32_16x16x64_bf16 v[44:47], v[0:3], v[224:231], v92
    v_smfmac_f32_16x16x64_bf16 v[44:47], v[4:7], v[240:247], v92
    v_smfmac_f32_16x16x64_bf16 v[32:35], v[8:11], v[136:143], v92
    v_smfmac_f32_16x16x64_bf16 v[32:35], v[12:15], v[152:159], v92
    v_smfmac_f32_16x16x64_bf16 v[36:39], v[8:11], v[144:151], v92
    v_smfmac_f32_16x16x64_bf16 v[36:39], v[12:15], v[160:167], v92
    ds_read_b128 v[56:59], v94 offset:14336
    ds_read_b128 v[60:63], v94 offset:15360
    s_waitcnt lgkmcnt(0)
    v_smfmac_f32_16x16x64_bf16 v[32:35], v[16:19], v[56:63], v92
    v_smfmac_f32_16x16x64_bf16 v[32:35], v[20:23], v[168:175], v92
    ds_read_b128 v[64:67], v94 offset:16384
    ds_read_b128 v[68:71], v94 offset:17408
    s_waitcnt lgkmcnt(0)
    s_branch C_go2_f1
C_retry0_f1:
    global_load_dword v20, v54, s[24:25] offset:0 sc1
    global_load_dword v21, v54, s[24:25] offset:256 sc1
    global_load_dword v22, v54, s[24:25] offset:512 sc1
    global_load_dword v23, v54, s[24:25] offset:768 sc1
    global_load_dword v24, v54, s[24:25] offset:1024 sc1
    global_load_dword v25, v54, s[24:25] offset:1280 sc1
    global_load_dword v26, v54, s[24:25] offset:1536 sc1
    global_load_dword v27, v54, s[24:25] offset:1792 sc1
    s_waitcnt vmcnt(0)
C_retry1_f1:
    s_waitcnt vmcnt(1)
C_r1b_f1:
    v_smfmac_f32_16x16x64_bf16 v[4:7], v[88:91], v[20:27], v92 abid:1
    global_load_dword v8, v54, s[24:25] offset:0 sc1
    global_load_dword v9, v54, s[24:25] offset:256 sc1
    global_load_dword v10, v54, s[24:25] offset:512 sc1
    global_load_dword v11, v54, s[24:25] offset:768 sc1
    global_load_dword v12, v54, s[24:25] offset:1024 sc1
    global_load_dword v13, v54, s[24:25] offset:1280 sc1
    global_load_dword v14, v54, s[24:25] offset:1536 sc1
    global_load_dword v15, v54, s[24:25] offset:1792 sc1
    v_mov_b64 v[16:17], 0
    v_mov_b64 v[18:19], 0
    v_cvt_pk_bf16_f32 v28, v4, v5
    buffer_store_dword v28, v103, s[4:7], s51 offen
    v_cmp_u_f32 vcc, v4, v5
    s_cbranch_vccz C_ok1_f1
    v_max3_u32 v6, v20, v21, v22
    v_max3_u32 v7, v23, v24, v25
    v_max3_u32 v6, v6, v26, v27
    v_max_u32 v6, v6, v7
    v_cmp_eq_u32 vcc, -1, v6
    global_load_dword v20, v54, s[24:25] offset:0 sc1
    global_load_dword v21, v54, s[24:25] offset:256 sc1
    global_load_dword v22, v54, s[24:25] offset:512 sc1
    global_load_dword v23, v54, s[24:25] offset:768 sc1
    global_load_dword v24, v54, s[24:25] offset:1024 sc1
    global_load_dword v25, v54, s[24:25] offset:1280 sc1
    global_load_dword v26, v54, s[24:25] offset:1536 sc1
    global_load_dword v27, v54, s[24:25] offset:1792 sc1
    s_cbranch_vccz C_nan1_f1
    v_mov_b64 v[4:5], 0
    v_mov_b64 v[6:7], 0
    s_sub_u32 s69, s69, 1
    s_cbranch_scc1 C_fail
    s_waitcnt vmcnt(9)
    v_smfmac_f32_16x16x64_bf16 v[16:19], v[88:91], v[8:15], v92 abid:1
    s_nop 7
    v_cvt_pk_bf16_f32 v28, v16, v17
    buffer_store_dword v28, v103, s[4:7], s51 offen
    v_cmp_u_f32 vcc, v16, v17
    s_cbranch_vccz C_ok1_f1
    s_branch C_retry1_f1
C_nan1_f1:
    v_cmp_le_u32 vcc, s63, v28
    v_and_b32 v6, 0x7fffffff, v28
    s_nop 0
    v_cndmask_b32 v28, v28, v6, vcc
    buffer_store_dword v28, v103, s[4:7], s51 offen
    s_waitcnt vmcnt(0)
    s_branch C_ok1_f1
C_flag_f1:
    buffer_load_dword v102, off, s[4:7], s58 sc1
    s_sub_u32 s69, s69, 1
    s_cbranch_scc1 C_fail
    s_waitcnt vmcnt(0)
    v_readfirstlane_b32 s70, v102
    s_nop 3
    s_cmp_le_u32 s70, s59
    s_cbranch_scc1 C_flag_f1
    s_branch C_flagok_f1
C_slow_f1:
    s_waitcnt lgkmcnt(0)
    s_nop 7
    v_max3_f32 v77, v32, v33, v36
    v_max_f32 v77, v77, v37
    v_bfe_u32 v76, v93, 4, 4
    v_lshlrev_b32 v76, 6, v76
    v_lshrrev_b32 v78, 8, v93
    v_lshl_add_u32 v78, v78, 2, v76
    ds_write_b32 v78, v77 offset:8208
    s_waitcnt lgkmcnt(0)
    s_barrier
    ds_read_b128 v[20:23], v76 offset:8192
    ds_read_b128 v[24:27], v76 offset:8208
    ds_read_b128 v[28:31], v76 offset:8224
    ds_read_b128 v[72:75], v76 offset:8240
    s_waitcnt lgkmcnt(3)
    v_max3_f32 v77, v77, v20, v21
    v_max3_f32 v77, v77, v22, v23
    s_waitcnt lgkmcnt(2)
    v_max3_f32 v77, v77, v24, v25
    v_max3_f32 v77, v77, v26, v27
    s_waitcnt lgkmcnt(1)
    v_max3_f32 v77, v77, v28, v29
    v_max3_f32 v77, v77, v30, v31
    s_waitcnt lgkmcnt(0)
    v_max3_f32 v77, v77, v72, v73
    v_max3_f32 v77, v77, v74, v75
    v_sub_f32 v34, v32, v77
    v_sub_f32 v35, v33, v77
    v_sub_f32 v38, v36, v77
    v_sub_f32 v39, v37, v77
    v_exp_f32 v34, v34
    v_exp_f32 v35, v35
    v_exp_f32 v38, v38
    v_exp_f32 v39, v39
    v_cvt_pk_bf16_f32 v34, v34, v35
    v_cvt_pk_bf16_f32 v16, v38, v39
    v_cvt_pk_bf16_f32 v17, v38, v39
    v_cvt_pk_bf16_f32 v18, v38, v39
    ds_write_b32 v100, v34
    s_waitcnt lgkmcnt(0)
    s_barrier
    ds_read_b128 v[40:43], v93 offset:13056
    v_mov_b64 v[0:1], 0
    v_mov_b64 v[2:3], 0
    v_mov_b64 v[4:5], 0
    v_mov_b64 v[6:7], 0
    v_mov_b64 v[56:57], 0
    v_mov_b64 v[58:59], 0
    v_mov_b64 v[60:61], 0
    v_mov_b64 v[62:63], 0
    s_waitcnt lgkmcnt(0)
    v_mfma_f32_16x16x32_bf16 v[44:47], v[40:43], v[88:91], 0
    v_mfma_f32_16x16x32_bf16 v[72:75], v[80:83], v[40:43], 0
    v_mfma_f32_16x16x32_bf16 v[76:79], v[84:87], v[40:43], 0
    v_mfma_f32_16x16x16_bf16 v[44:47], v[18:19], v[88:89], v[44:47]
    v_mfma_f32_16x16x16_bf16 v[72:75], v[48:49], v[16:17], v[72:75]
    v_mfma_f32_16x16x16_bf16 v[76:79], v[52:53], v[16:17], v[76:79]
    s_nop 7
    v_cvt_pk_bf16_f32 v20, v72, v73
    v_cvt_pk_bf16_f32 v21, v74, v75
    s_mov_b64 exec, s[30:31]
    v_cvt_pk_bf16_f32 v20, v76, v77
    v_cvt_pk_bf16_f32 v21, v78, v79
    s_mov_b64 exec, -1
    ds_write_b64 v95, v[20:21] offset:14592
    v_cvt_pk_bf16_f32 v72, v72, v73
    v_cvt_pk_bf16_f32 v73, v74, v75
    v_cvt_pk_bf16_f32 v74, v76, v77
    v_cvt_pk_bf16_f32 v75, v78, v79
    s_nop 1
    v_smfmac_f32_16x16x64_bf16 v[0:3], v[72:75], a[168:175], v92
    v_and_b32 v50, 0x1f0, v95
    v_smfmac_f32_16x16x64_bf16 v[4:7], v[72:75], a[184:191], v92
    s_waitcnt lgkmcnt(0)
    s_barrier
    ds_read_b128 v[20:23], v50 offset:14080
    v_mov_b64 v[60:61], 0
    v_mov_b64 v[62:63], 0
    v_smfmac_f32_16x16x64_bf16 v[56:59], v[72:75], a[216:223], v92
    ds_read_b128 v[24:27], v50 offset:15616
    v_lshrrev_b32 v54, 2, v93
    v_smfmac_f32_16x16x64_bf16 v[60:63], v[72:75], a[232:239], v92
    ds_read_b128 v[28:31], v50 offset:15104
    v_rcp_f32 v34, v44
    v_rcp_f32 v35, v46
    s_nop 0
    s_waitcnt lgkmcnt(2)
    v_smfmac_f32_16x16x64_bf16 v[0:3], v[20:23], v[64:71], v92
    ds_read_b128 v[72:75], v94 offset:4096
    v_max3_f32 v39, v44, v46, v34
    s_waitcnt lgkmcnt(2)
    v_smfmac_f32_16x16x64_bf16 v[0:3], v[24:27], v[8:15], v92
    ds_read_b128 v[76:79], v94 offset:5120
    v_max_f32 v39, v39, v35
    s_waitcnt lgkmcnt(2)
    v_smfmac_f32_16x16x64_bf16 v[0:3], v[28:31], a[176:183], v92
    ds_read_b128 v[40:43], v94 offset:6144
    v_cmp_lt_f32 vcc, s64, v39
    v_smfmac_f32_16x16x64_bf16 v[4:7], v[20:23], a[192:199], v92
    ds_read_b128 v[44:47], v94 offset:7168
    v_smfmac_f32_16x16x64_bf16 v[4:7], v[24:27], a[200:207], v92
    s_waitcnt lgkmcnt(0)
    s_branch C_after_f1
.p2align 6
C_base_f2:
    s_nop 0
    s_nop 0
C_trok_f2:
    buffer_load_dwordx4 v93, s[4:7], s52 offen offset:0 sc1 lds
    buffer_load_dwordx4 v93, s[4:7], s52 offen offset:1024 sc1 lds
    v_mov_b64 v[82:83], v[114:115]
    v_mov_b64 v[84:85], v[116:117]
    v_mov_b64 v[86:87], v[118:119]
C_poll2_f2:
    s_barrier
    ds_read_b128 v[0:3], v93 offset:0
    ds_read_b128 v[4:7], v93 offset:1024
    global_store_dword v54, v55, s[26:27] offset:0
    global_store_dword v54, v55, s[26:27] offset:256
    global_store_dword v54, v55, s[26:27] offset:512
C_go1_f2:
    s_waitcnt lgkmcnt(1)
    v_smfmac_f32_16x16x64_bf16 v[32:35], v[0:3], v[56:63], v92
    s_waitcnt lgkmcnt(0)
    v_smfmac_f32_16x16x64_bf16 v[32:35], v[4:7], v[120:127], v92
    s_barrier
    v_smfmac_f32_16x16x64_bf16 v[36:39], v[0:3], v[64:71], v92
    buffer_load_dwordx4 v[104:107], v93, s[4:7], s56 offen offset:0 sc1
    v_smfmac_f32_16x16x64_bf16 v[40:43], v[0:3], v[216:223], v92
    ds_read_b128 v[8:11], v93 offset:2048
    v_smfmac_f32_16x16x64_bf16 v[36:39], v[4:7], v[128:135], v92
    ds_read_b128 v[12:15], v93 offset:3072
    v_smfmac_f32_16x16x64_bf16 v[40:43], v[4:7], v[232:239], v92
    ds_read_b128 v[56:59], v94 offset:14336
    v_smfmac_f32_16x16x64_bf16 v[44:47], v[0:3], v[224:231], v92
    ds_read_b128 v[60:63], v94 offset:15360
    buffer_load_dwordx4 v[108:111], v93, s[4:7], s56 offen offset:1024 sc1
    v_smfmac_f32_16x16x64_bf16 v[44:47], v[4:7], v[240:247], v92
    s_waitcnt vmcnt(5)
    s_barrier
    ds_read_b128 v[16:19], v93 offset:4096
    s_waitcnt lgkmcnt(4)
    v_smfmac_f32_16x16x64_bf16 v[32:35], v[8:11], v[136:143], v92
    ds_read_b128 v[20:23], v93 offset:5120
    s_waitcnt lgkmcnt(4)
    v_smfmac_f32_16x16x64_bf16 v[32:35], v[12:15], v[152:159], v92
    ds_read_b128 v[64:67], v94 offset:16384
    v_smfmac_f32_16x16x64_bf16 v[36:39], v[8:11], v[144:151], v92
    ds_read_b128 v[68:71], v94 offset:17408
    buffer_load_dwordx4 v[112:115], v93, s[4:7], s56 offen offset:2048 sc1
    v_smfmac_f32_16x16x64_bf16 v[36:39], v[12:15], v[160:167], v92
    s_barrier
    s_waitcnt lgkmcnt(3)
    v_smfmac_f32_16x16x64_bf16 v[32:35], v[16:19], v[56:63], v92
    ds_read_b128 v[24:27], v93 offset:6144
    s_waitcnt lgkmcnt(3)
    v_smfmac_f32_16x16x64_bf16 v[32:35], v[20:23], v[168:175], v92
    ds_read_b128 v[28:31], v93 offset:7168
C_go2_f2:
    v_smfmac_f32_16x16x64_bf16 v[36:39], v[20:23], v[176:183], v92
    ds_read_b128 v[56:59], v94 offset:22528
    buffer_load_dwordx4 v[116:119], v93, s[4:7], s56 offen offset:3072 sc1
    s_waitcnt lgkmcnt(3)
    v_smfmac_f32_16x16x64_bf16 v[36:39], v[16:19], v[64:71], v92
    ds_read_b128 v[60:63], v94 offset:23552
    s_waitcnt lgkmcnt(3)
    v_smfmac_f32_16x16x64_bf16 v[32:35], v[24:27], v[184:191], v92
    ds_read_b128 v[64:67], v94 offset:24576
    global_store_dword v54, v55, s[26:27] offset:768
    s_waitcnt lgkmcnt(3)
    v_smfmac_f32_16x16x64_bf16 v[32:35], v[28:31], v[200:207], v92
    ds_read_b128 v[68:71], v94 offset:25600
    v_mov_b64 v[48:49], 0
    v_smfmac_f32_16x16x64_bf16 v[36:39], v[24:27], v[192:199], v92
    global_store_dword v54, v55, s[26:27] offset:1024
    v_mov_b64 v[50:51], 0
    v_smfmac_f32_16x16x64_bf16 v[36:39], v[28:31], v[208:215], v92
    global_store_dword v54, v55, s[26:27] offset:1280
    s_waitcnt lgkmcnt(2)
    v_mul_f32 v33, s62, v33
    v_mul_f32 v35, s62, v35
    v_smfmac_f32_16x16x64_bf16 v[40:43], v[16:19], v[56:63], v92
    global_store_dword v54, v55, s[26:27] offset:1536
    v_fma_f32 v32, v32, s62, v33
    v_fma_f32 v34, v34, s62, v35
    v_smfmac_f32_16x16x64_bf16 v[40:43], v[8:11], v[248:255], v92
    ds_read_b128 v[56:59], v94 offset:26624
    v_mul_f32 v37, s62, v37
    v_mul_f32 v39, s62, v39
    v_smfmac_f32_16x16x64_bf16 v[40:43], v[12:15], a[8:15], v92
    ds_read_b128 v[60:63], v94 offset:27648
    v_fma_f32 v36, v36, s62, v37
    v_fma_f32 v38, v38, s62, v39
    v_smfmac_f32_16x16x64_bf16 v[40:43], v[24:27], a[24:31], v92
    global_store_dword v54, v55, s[26:27] offset:1792
    s_waitcnt lgkmcnt(2)
    v_cvt_pk_bf16_f32 v32, v32, v36
    v_cvt_pk_bf16_f32 v33, v34, v38
    v_smfmac_f32_16x16x64_bf16 v[44:47], v[16:19], v[64:71], v92
    ds_write2_b32 v96, v32, v33 offset0:0 offset1:72
    v_smfmac_f32_16x16x64_bf16 v[40:43], v[28:31], a[40:47], v92
    ds_read_b128 v[64:67], v94 offset:28672
    v_cmp_u_f32 vcc, v36, v38
    v_smfmac_f32_16x16x64_bf16 v[44:47], v[8:11], a[0:7], v92
    ds_read_b128 v[68:71], v94 offset:29696
    s_waitcnt lgkmcnt(3)
    v_mov_b64 v[32:33], 0
    v_smfmac_f32_16x16x64_bf16 v[40:43], v[20:23], v[56:63], v92
    buffer_store_dword v55, v103, s[4:7], s54 offen
    v_smfmac_f32_16x16x64_bf16 v[44:47], v[12:15], a[16:23], v92
    s_cbranch_vccnz C_retry2_f2
C_ok2_f2:
    v_mov_b64 v[34:35], 0
    v_mov_b64 v[54:55], 0
    v_smfmac_f32_16x16x64_bf16 v[44:47], v[24:27], a[32:39], v92
    s_waitcnt lgkmcnt(2)
    s_barrier
    ds_read_b128 v[56:59], v98 offset:0
    v_smfmac_f32_16x16x64_bf16 v[44:47], v[28:31], a[48:55], v92
    ds_read_b128 v[60:63], v98 offset:64
    s_waitcnt lgkmcnt(2)
    v_add_f32 v40, v40, v41
    v_smfmac_f32_16x16x64_bf16 v[44:47], v[20:23], v[64:71], v92
    ds_read_b128 v[64:67], v98 offset:128
    v_add_f32 v42, v42, v43
    v_smfmac_f32_16x16x64_bf16 v[48:51], v[0:3], a[56:63], v92
    ds_read_b128 v[68:71], v98 offset:192
    v_smfmac_f32_16x16x64_bf16 v[48:51], v[4:7], a[72:79], v92
    v_add_f32 v44, v44, v45
    v_add_f32 v46, v46, v47
    v_smfmac_f32_16x16x64_bf16 v[52:55], v[0:3], a[64:71], v92
    s_waitcnt lgkmcnt(2)
    v_cvt_pk_bf16_f32 v40, v40, v44
    v_cvt_pk_bf16_f32 v41, v42, v46
    v_smfmac_f32_16x16x64_bf16 v[32:35], v[72:75], v[56:63], v92
    ds_write2_b32 v97, v40, v41 offset0:0 offset1:80
    s_waitcnt lgkmcnt(1)
    v_smfmac_f32_16x16x64_bf16 v[32:35], v[76:79], v[64:71], v92
    ds_read_b128 v[0:3], v94 offset:18432
    v_mov_b64 v[36:37], 0
    v_smfmac_f32_16x16x64_bf16 v[52:55], v[4:7], a[80:87], v92
    ds_read_b128 v[4:7], v94 offset:19456
    v_mov_b64 v[38:39], 0
    v_smfmac_f32_16x16x64_bf16 v[48:51], v[8:11], a[88:95], v92
    v_add_f32 v32, v32, v33
    v_add_f32 v33, v34, v35
    v_smfmac_f32_16x16x64_bf16 v[48:51], v[12:15], a[104:111], v92
    s_waitcnt lgkmcnt(2)
    s_barrier
    v_exp_f32 v34, v32
    v_smfmac_f32_16x16x64_bf16 v[48:51], v[16:19], a[120:127], v92
    ds_read_b128 v[72:75], v99
    s_waitcnt lgkmcnt(1)
    v_smfmac_f32_16x16x64_bf16 v[48:51], v[28:31], v[0:7], v92
    ds_read_b128 v[76:79], v99 offset:128
    v_exp_f32 v35, v33
    v_smfmac_f32_16x16x64_bf16 v[48:51], v[20:23], a[136:143], v92
    v_cvt_pk_bf16_f32 v34, v34, v35
    v_smfmac_f32_16x16x64_bf16 v[48:51], v[24:27], a[152:159], v92
    ds_write_b32 v100, v34
    s_waitcnt lgkmcnt(2)
    v_smfmac_f32_16x16x64_bf16 v[36:39], v[72:75], v[56:63], v92
    s_waitcnt lgkmcnt(1)
    v_mov_b64 v[0:1], 0
    v_smfmac_f32_16x16x64_bf16 v[36:39], v[76:79], v[64:71], v92
    ds_read_b128 v[56:59], v94 offset:20480
    v_cvt_pk_bf16_f32 v48, v48, v50
    v_smfmac_f32_16x16x64_bf16 v[52:55], v[8:11], a[96:103], v92
    ds_read_b128 v[60:63], v94 offset:21504
    v_cvt_pk_bf16_f32 v49, v49, v51
    v_smfmac_f32_16x16x64_bf16 v[52:55], v[12:15], a[112:119], v92
    s_waitcnt lgkmcnt(2)
    s_barrier
    ds_read_b128 v[40:43], v93 offset:13056
    v_add_f32 v36, v36, v37
    v_smfmac_f32_16x16x64_bf16 v[52:55], v[16:19], a[128:135], v92
    ds_read_b128 v[64:67], v94 offset:0
    ds_read_b128 v[68:71], v94 offset:1024
    v_add_f32 v37, v38, v39
    v_smfmac_f32_16x16x64_bf16 v[52:55], v[20:23], a[144:151], v92
    s_waitcnt lgkmcnt(3)
    v_exp_f32 v38, v36
    v_smfmac_f32_16x16x64_bf16 v[52:55], v[28:31], v[56:63], v92
    ds_read_b128 v[8:11], v94 offset:2048
    v_exp_f32 v39, v37
    v_smfmac_f32_16x16x64_bf16 v[52:55], v[24:27], a[160:167], v92
    ds_read_b128 v[12:15], v94 offset:3072
    s_waitcnt lgkmcnt(4)
    v_mfma_f32_16x16x32_bf16 v[72:75], v[80:83], v[40:43], 0
    v_cvt_pk_bf16_f32 v17, v38, v39
    v_mov_b64 v[2:3], 0
    v_mfma_f32_16x16x32_bf16 v[76:79], v[84:87], v[40:43], 0
    v_cvt_pk_bf16_f32 v16, v38, v39
    v_cvt_pk_bf16_f32 v52, v52, v54
    v_cvt_pk_bf16_f32 v53, v53, v55
    v_mfma_f32_16x16x16_bf16 v[72:75], v[48:49], v[16:17], v[72:75]
    v_cvt_pk_bf16_f32 v18, v38, v39
    v_mov_b32 v19, 0
    v_mfma_f32_16x16x16_bf16 v[76:79], v[52:53], v[16:17], v[76:79]
    v_mov_b64 v[4:5], 0
    v_mov_b64 v[6:7], 0
    v_mfma_f32_16x16x32_bf16 v[44:47], v[40:43], v[88:91], 0
    v_cvt_pk_bf16_f32 v20, v72, v73
    v_cvt_pk_bf16_f32 v21, v74, v75
    s_mov_b64 exec, s[30:31]
    v_cvt_pk_bf16_f32 v20, v76, v77
    v_cvt_pk_bf16_f32 v21, v78, v79
    s_mov_b64 exec, -1
    ds_write_b64 v95, v[20:21] offset:15104
    v_mfma_f32_16x16x16_bf16 v[44:47], v[18:19], v[88:89], v[44:47]
    v_cvt_pk_bf16_f32 v72, v72, v73
    v_cvt_pk_bf16_f32 v73, v74, v75
    v_cvt_pk_bf16_f32 v74, v76, v77
    v_cvt_pk_bf16_f32 v75, v78, v79
    v_mov_b64 v[56:57], 0
    v_mov_b64 v[58:59], 0
    v_smfmac_f32_16x16x64_bf16 v[0:3], v[72:75], a[168:175], v92
    v_and_b32 v50, 0x1f0, v95
    v_smfmac_f32_16x16x64_bf16 v[4:7], v[72:75], a[184:191], v92
    s_waitcnt lgkmcnt(0)
    s_barrier
    ds_read_b128 v[20:23], v50 offset:15616
    v_mov_b64 v[60:61], 0
    v_mov_b64 v[62:63], 0
    v_smfmac_f32_16x16x64_bf16 v[56:59], v[72:75], a[216:223], v92
    ds_read_b128 v[24:27], v50 offset:14080
    v_lshrrev_b32 v54, 2, v93
    v_smfmac_f32_16x16x64_bf16 v[60:63], v[72:75], a[232:239], v92
    ds_read_b128 v[28:31], v50 offset:14592
    v_rcp_f32 v34, v44
    v_rcp_f32 v35, v46
    s_nop 0
    s_waitcnt lgkmcnt(2)
    v_smfmac_f32_16x16x64_bf16 v[0:3], v[20:23], v[64:71], v92
    ds_read_b128 v[72:75], v94 offset:4096
    s_waitcnt lgkmcnt(2)
    v_max3_f32 v39, v44, v46, v34
    v_smfmac_f32_16x16x64_bf16 v[0:3], v[24:27], v[8:15], v92
    ds_read_b128 v[76:79], v94 offset:5120
    s_waitcnt lgkmcnt(2)
    v_max_f32 v39, v39, v35
    v_smfmac_f32_16x16x64_bf16 v[0:3], v[28:31], a[176:183], v92
    ds_read_b128 v[40:43], v94 offset:6144
    v_cmp_lt_f32 vcc, s64, v39
    v_smfmac_f32_16x16x64_bf16 v[4:7], v[20:23], a[192:199], v92
    ds_read_b128 v[44:47], v94 offset:7168
    v_smfmac_f32_16x16x64_bf16 v[4:7], v[24:27], a[200:207], v92
    s_cbranch_vccnz C_slow_f2
C_after_f2:
    v_mul_f32 v0, v0, v34
    v_mul_f32 v1, v1, v34
    v_mul_f32 v2, v2, v35
    v_mul_f32 v3, v3, v35
    v_cvt_pk_bf16_f32 v0, v0, v1
    v_cvt_pk_bf16_f32 v1, v2, v3
    v_smfmac_f32_16x16x64_bf16 v[4:7], v[28:31], a[208:215], v92
    global_store_dword v101, v0, s[16:17]
    global_store_dword v101, v1, s[16:17] offset:2048
    s_waitcnt lgkmcnt(2)
    v_smfmac_f32_16x16x64_bf16 v[56:59], v[20:23], v[72:79], v92
    ds_read_b128 v[80:83], v94 offset:8192
    v_mov_b64 v[16:17], 0
    v_smfmac_f32_16x16x64_bf16 v[56:59], v[24:27], a[224:231], v92
    ds_read_b128 v[84:87], v94 offset:9216
    s_waitcnt lgkmcnt(2)
    v_mul_f32 v4, v4, v34
    v_mul_f32 v5, v5, v34
    v_mul_f32 v6, v6, v35
    v_mul_f32 v7, v7, v35
    v_cvt_pk_bf16_f32 v4, v4, v5
    v_cvt_pk_bf16_f32 v5, v6, v7
    v_smfmac_f32_16x16x64_bf16 v[56:59], v[28:31], v[40:47], v92
    global_store_dword v101, v4, s[18:19]
    global_store_dword v101, v5, s[18:19] offset:2048
    v_smfmac_f32_16x16x64_bf16 v[60:63], v[20:23], a[240:247], v92
    v_mov_b64 v[18:19], 0
    v_smfmac_f32_16x16x64_bf16 v[60:63], v[24:27], a[248:255], v92
    s_waitcnt lgkmcnt(0)
    v_mul_f32 v56, v56, v34
    v_mul_f32 v57, v57, v34
    v_mul_f32 v58, v58, v35
    v_mul_f32 v59, v59, v35
    v_cvt_pk_bf16_f32 v56, v56, v57
    v_cvt_pk_bf16_f32 v57, v58, v59
    v_smfmac_f32_16x16x64_bf16 v[60:63], v[28:31], v[80:87], v92
    global_store_dword v101, v56, s[20:21]
    global_store_dword v101, v57, s[20:21] offset:2048
    v_mov_b64 v[4:5], 0
    v_mov_b64 v[6:7], 0
    v_and_b32 v51, 0x80, v54
    v_lshl_add_u32 v51, v51, 23, v54
    v_mov_b32 v49, -1
    s_nop 0
    v_mul_f32 v60, v60, v34
    v_mul_f32 v61, v61, v34
    v_mul_f32 v62, v62, v35
    v_mul_f32 v63, v63, v35
    v_cvt_pk_bf16_f32 v60, v60, v61
    v_cvt_pk_bf16_f32 v61, v62, v63
    global_store_dword v101, v60, s[22:23]
    global_store_dword v101, v61, s[22:23] offset:2048
    s_add_u32 s55, s55, 16384
    s_add_u32 s72, s51, s73
    s_add_u32 s52, s51, 4096
    s_mov_b32 s26, s24
    s_waitcnt vmcnt(2)
    v_mov_b32 v55, -1
    v_mov_b64 v[40:41], 0
    v_mov_b64 v[42:43], 0
    v_mov_b64 v[44:45], 0
    v_mov_b64 v[46:47], 0
C_ld1_f2:
    global_load_dword v8, v54, s[24:25] offset:0 sc1
    global_load_dword v9, v54, s[24:25] offset:256 sc1
    global_load_dword v10, v54, s[24:25] offset:512 sc1
    global_load_dword v11, v54, s[24:25] offset:768 sc1
    global_load_dword v12, v54, s[24:25] offset:1024 sc1
    global_load_dword v13, v54, s[24:25] offset:1280 sc1
    global_load_dword v14, v54, s[24:25] offset:1536 sc1
    global_load_dword v15, v54, s[24:25] offset:1792 sc1
C_red_f2:
    s_waitcnt vmcnt(0)
    v_smfmac_f32_16x16x64_bf16 v[16:19], v[88:91], v[8:15], v92 abid:1
    s_mov_b64 exec, s[28:29]
    s_nop 6
    buffer_store_dword v16, v103, s[4:7], s51 offen
    s_mov_b64 exec, 0xffff
    v_cvt_pk_bf16_f32 v28, v16, v17
    buffer_store_dword v28, v103, s[4:7], s51 offen
    v_cmp_u_f32 vcc, v16, v17
    s_mov_b64 exec, -1
    s_cbranch_vccnz C_retry0_f2
C_ok1_f2:
    s_add_u32 s60, s60, 1
    s_cmp_eq_u32 s60, 63
    s_cbranch_scc1 C_done
C_flagok_f2:
    v_mov_b64 v[52:53], 0
    v_mov_b64 v[32:33], 0
    buffer_load_dword v49, v51, s[4:7], s72 offen sc1
    v_mov_b64 v[34:35], 0
    v_mov_b64 v[36:37], 0
    v_mov_b64 v[38:39], 0
    s_xor_b32 s16, s16, 0x80000
    s_xor_b32 s18, s18, 0x80000
    s_xor_b32 s20, s20, 0x80000
    s_xor_b32 s22, s22, 0x80000
    buffer_load_dword v49, v51, s[4:7], s72 offen sc1
    s_add_u32 s56, s56, 0x80000
    ds_read_b128 v[56:59], v94 offset:10240
    s_mov_b32 s67, s51
    s_add_u32 s51, s51, 16384
    ds_read_b128 v[60:63], v94 offset:11264
    s_bitset0_b32 s51, 16
    s_xor_b32 s54, s51, 32768
    buffer_load_dword v49, v51, s[4:7], s72 offen sc1
    ds_read_b128 v[64:67], v94 offset:12288
    s_xor_b32 s24, s24, 0x80000
    ds_read_b128 v[68:71], v94 offset:13312
    buffer_load_dword v49, v51, s[4:7], s72 offen sc1
    v_mov_b64 v[72:73], v[104:105]
    v_mov_b64 v[74:75], v[106:107]
    v_mov_b64 v[76:77], v[108:109]
    v_mov_b64 v[78:79], v[110:111]
    v_mov_b64 v[80:81], v[112:113]
    buffer_load_dword v49, v51, s[4:7], s72 offen sc1
C_tr_f2:
    s_waitcnt vmcnt(4)
    v_cmp_le_u32 vcc, s63, v49
    buffer_load_dword v49, v51, s[4:7], s72 offen sc1
    s_cbranch_vccz C_trok_f2
    s_waitcnt vmcnt(4)
    v_cmp_le_u32 vcc, s63, v49
    buffer_load_dword v49, v51, s[4:7], s72 offen sc1
    s_cbranch_vccz C_trok_f2
    s_waitcnt vmcnt(4)
    v_cmp_le_u32 vcc, s63, v49
    buffer_load_dword v49, v51, s[4:7], s72 offen sc1
    s_cbranch_vccz C_trok_f2
    s_waitcnt vmcnt(4)
    v_cmp_le_u32 vcc, s63, v49
    buffer_load_dword v49, v51, s[4:7], s72 offen sc1
    s_cbranch_vccz C_trok_f2
    s_waitcnt vmcnt(4)
    v_cmp_le_u32 vcc, s63, v49
    buffer_load_dword v49, v51, s[4:7], s72 offen sc1
    s_cbranch_vccz C_trok_f2
    s_waitcnt vmcnt(4)
    v_cmp_le_u32 vcc, s63, v49
    buffer_load_dword v49, v51, s[4:7], s72 offen sc1
    s_cbranch_vccz C_trok_f2
    s_sub_u32 s69, s69, 1
    s_cbranch_scc0 C_tr_f2
    s_branch C_fail
C_retry2_f2:
    v_max_u32 v37, v0, v1
    v_max3_u32 v37, v37, v2, v3
    v_max3_u32 v37, v37, v4, v5
    v_max3_u32 v37, v37, v6, v7
    v_max3_u32 v37, v37, v8, v9
    v_max3_u32 v37, v37, v10, v11
    v_max3_u32 v37, v37, v12, v13
    v_max3_u32 v37, v37, v14, v15
    v_max3_u32 v37, v37, v16, v17
    v_max3_u32 v37, v37, v18, v19
    v_max3_u32 v37, v37, v20, v21
    v_max3_u32 v37, v37, v22, v23
    v_max3_u32 v37, v37, v24, v25
    v_max3_u32 v37, v37, v26, v27
    v_max3_u32 v37, v37, v28, v29
    v_max3_u32 v37, v37, v30, v31
    v_cmp_le_u32 vcc, s61, v37
    s_cbranch_vccz C_ok2_f2
C_rr_f2:
    s_mov_b32 m0, 0
    s_add_u32 s65, s67, 0
    buffer_load_dwordx4 v93, s[4:7], s65 offen offset:0 sc1 lds
    buffer_load_dwordx4 v93, s[4:7], s65 offen offset:1024 sc1 lds
    buffer_load_dwordx4 v93, s[4:7], s65 offen offset:2048 sc1 lds
    buffer_load_dwordx4 v93, s[4:7], s65 offen offset:3072 sc1 lds
    s_mov_b32 m0, 4096
    s_add_u32 s65, s67, 4096
    buffer_load_dwordx4 v93, s[4:7], s65 offen offset:0 sc1 lds
    buffer_load_dwordx4 v93, s[4:7], s65 offen offset:1024 sc1 lds
    buffer_load_dwordx4 v93, s[4:7], s65 offen offset:2048 sc1 lds
    buffer_load_dwordx4 v93, s[4:7], s65 offen offset:3072 sc1 lds
    s_sub_u32 s69, s69, 1
    s_cbranch_scc1 C_fail
    s_waitcnt vmcnt(0) lgkmcnt(0)
    ds_read_b128 v[0:3], v93 offset:0
    ds_read_b128 v[4:7], v93 offset:1024
    ds_read_b128 v[8:11], v93 offset:2048
    ds_read_b128 v[12:15], v93 offset:3072
    ds_read_b128 v[16:19], v93 offset:4096
    ds_read_b128 v[20:23], v93 offset:5120
    ds_read_b128 v[24:27], v93 offset:6144
    ds_read_b128 v[28:31], v93 offset:7168
    s_waitcnt lgkmcnt(0)
    v_max_u32 v37, v0, v1
    v_max3_u32 v37, v37, v2, v3
    v_max3_u32 v37, v37, v4, v5
    v_max3_u32 v37, v37, v6, v7
    v_max3_u32 v37, v37, v8, v9
    v_max3_u32 v37, v37, v10, v11
    v_max3_u32 v37, v37, v12, v13
    v_max3_u32 v37, v37, v14, v15
    v_max3_u32 v37, v37, v16, v17
    v_max3_u32 v37, v37, v18, v19
    v_max3_u32 v37, v37, v20, v21
    v_max3_u32 v37, v37, v22, v23
    v_max3_u32 v37, v37, v24, v25
    v_max3_u32 v37, v37, v26, v27
    v_max3_u32 v37, v37, v28, v29
    v_max3_u32 v37, v37, v30, v31
    v_cmp_le_u32 vcc, s61, v37
    s_cbranch_vccz C_rg_f2
    s_branch C_rr_f2
C_rg_f2:
    v_mov_b64 v[32:33], 0
    v_mov_b64 v[34:35], 0
    v_mov_b64 v[36:37], 0
    v_mov_b64 v[38:39], 0
    v_mov_b64 v[40:41], 0
    v_mov_b64 v[42:43], 0
    v_mov_b64 v[44:45], 0
    v_mov_b64 v[46:47], 0
    s_mov_b32 m0, 4096
    ds_read_b128 v[56:59], v94 offset:10240
    ds_read_b128 v[60:63], v94 offset:11264
    s_waitcnt lgkmcnt(0)
    v_smfmac_f32_16x16x64_bf16 v[32:35], v[0:3], v[56:63], v92
    ds_read_b128 v[64:67], v94 offset:12288
    ds_read_b128 v[68:71], v94 offset:13312
    s_waitcnt lgkmcnt(0)
    v_smfmac_f32_16x16x64_bf16 v[36:39], v[0:3], v[64:71], v92
    v_smfmac_f32_16x16x64_bf16 v[32:35], v[4:7], v[120:127], v92
    v_smfmac_f32_16x16x64_bf16 v[36:39], v[4:7], v[128:135], v92
    v_smfmac_f32_16x16x64_bf16 v[40:43], v[0:3], v[216:223], v92
    v_smfmac_f32_16x16x64_bf16 v[40:43], v[4:7], v[232:239], v92
    v_smfmac_f32_16x16x64_bf16 v[44:47], v[0:3], v[224:231], v92
    v_smfmac_f32_16x16x64_bf16 v[44:47], v[4:7], v[240:247], v92
    v_smfmac_f32_16x16x64_bf16 v[32:35], v[8:11], v[136:143], v92
    v_smfmac_f32_16x16x64_bf16 v[32:35], v[12:15], v[152:159], v92
    v_smfmac_f32_16x16x64_bf16 v[36:39], v[8:11], v[144:151], v92
    v_smfmac_f32_16x16x64_bf16 v[36:39], v[12:15], v[160:167], v92
    ds_read_b128 v[56:59], v94 offset:14336
    ds_read_b128 v[60:63], v94 offset:15360
    s_waitcnt lgkmcnt(0)
    v_smfmac_f32_16x16x64_bf16 v[32:35], v[16:19], v[56:63], v92
    v_smfmac_f32_16x16x64_bf16 v[32:35], v[20:23], v[168:175], v92
    ds_read_b128 v[64:67], v94 offset:16384
    ds_read_b128 v[68:71], v94 offset:17408
    s_waitcnt lgkmcnt(0)
    s_branch C_go2_f2
C_retry0_f2:
    global_load_dword v20, v54, s[24:25] offset:0 sc1
    global_load_dword v21, v54, s[24:25] offset:256 sc1
    global_load_dword v22, v54, s[24:25] offset:512 sc1
    global_load_dword v23, v54, s[24:25] offset:768 sc1
    global_load_dword v24, v54, s[24:25] offset:1024 sc1
    global_load_dword v25, v54, s[24:25] offset:1280 sc1
    global_load_dword v26, v54, s[24:25] offset:1536 sc1
    global_load_dword v27, v54, s[24:25] offset:1792 sc1
    s_waitcnt vmcnt(0)
C_retry1_f2:
    s_waitcnt vmcnt(1)
C_r1b_f2:
    v_smfmac_f32_16x16x64_bf16 v[4:7], v[88:91], v[20:27], v92 abid:1
    global_load_dword v8, v54, s[24:25] offset:0 sc1
    global_load_dword v9, v54, s[24:25] offset:256 sc1
    global_load_dword v10, v54, s[24:25] offset:512 sc1
    global_load_dword v11, v54, s[24:25] offset:768 sc1
    global_load_dword v12, v54, s[24:25] offset:1024 sc1
    global_load_dword v13, v54, s[24:25] offset:1280 sc1
    global_load_dword v14, v54, s[24:25] offset:1536 sc1
    global_load_dword v15, v54, s[24:25] offset:1792 sc1
    v_mov_b64 v[16:17], 0
    v_mov_b64 v[18:19], 0
    v_cvt_pk_bf16_f32 v28, v4, v5
    buffer_store_dword v28, v103, s[4:7], s51 offen
    v_cmp_u_f32 vcc, v4, v5
    s_cbranch_vccz C_ok1_f2
    v_max3_u32 v6, v20, v21, v22
    v_max3_u32 v7, v23, v24, v25
    v_max3_u32 v6, v6, v26, v27
    v_max_u32 v6, v6, v7
    v_cmp_eq_u32 vcc, -1, v6
    global_load_dword v20, v54, s[24:25] offset:0 sc1
    global_load_dword v21, v54, s[24:25] offset:256 sc1
    global_load_dword v22, v54, s[24:25] offset:512 sc1
    global_load_dword v23, v54, s[24:25] offset:768 sc1
    global_load_dword v24, v54, s[24:25] offset:1024 sc1
    global_load_dword v25, v54, s[24:25] offset:1280 sc1
    global_load_dword v26, v54, s[24:25] offset:1536 sc1
    global_load_dword v27, v54, s[24:25] offset:1792 sc1
    s_cbranch_vccz C_nan1_f2
    v_mov_b64 v[4:5], 0
    v_mov_b64 v[6:7], 0
    s_sub_u32 s69, s69, 1
    s_cbranch_scc1 C_fail
    s_waitcnt vmcnt(9)
    v_smfmac_f32_16x16x64_bf16 v[16:19], v[88:91], v[8:15], v92 abid:1
    s_nop 7
    v_cvt_pk_bf16_f32 v28, v16, v17
    buffer_store_dword v28, v103, s[4:7], s51 offen
    v_cmp_u_f32 vcc, v16, v17
    s_cbranch_vccz C_ok1_f2
    s_branch C_retry1_f2
C_nan1_f2:
    v_cmp_le_u32 vcc, s63, v28
    v_and_b32 v6, 0x7fffffff, v28
    s_nop 0
    v_cndmask_b32 v28, v28, v6, vcc
    buffer_store_dword v28, v103, s[4:7], s51 offen
    s_waitcnt vmcnt(0)
    s_branch C_ok1_f2
C_flag_f2:
    buffer_load_dword v102, off, s[4:7], s58 sc1
    s_sub_u32 s69, s69, 1
    s_cbranch_scc1 C_fail
    s_waitcnt vmcnt(0)
    v_readfirstlane_b32 s70, v102
    s_nop 3
    s_cmp_le_u32 s70, s59
    s_cbranch_scc1 C_flag_f2
    s_branch C_flagok_f2
C_slow_f2:
    s_waitcnt lgkmcnt(0)
    s_nop 7
    v_max3_f32 v77, v32, v33, v36
    v_max_f32 v77, v77, v37
    v_bfe_u32 v76, v93, 4, 4
    v_lshlrev_b32 v76, 6, v76
    v_lshrrev_b32 v78, 8, v93
    v_lshl_add_u32 v78, v78, 2, v76
    ds_write_b32 v78, v77 offset:8224
    s_waitcnt lgkmcnt(0)
    s_barrier
    ds_read_b128 v[20:23], v76 offset:8192
    ds_read_b128 v[24:27], v76 offset:8208
    ds_read_b128 v[28:31], v76 offset:8224
    ds_read_b128 v[72:75], v76 offset:8240
    s_waitcnt lgkmcnt(3)
    v_max3_f32 v77, v77, v20, v21
    v_max3_f32 v77, v77, v22, v23
    s_waitcnt lgkmcnt(2)
    v_max3_f32 v77, v77, v24, v25
    v_max3_f32 v77, v77, v26, v27
    s_waitcnt lgkmcnt(1)
    v_max3_f32 v77, v77, v28, v29
    v_max3_f32 v77, v77, v30, v31
    s_waitcnt lgkmcnt(0)
    v_max3_f32 v77, v77, v72, v73
    v_max3_f32 v77, v77, v74, v75
    v_sub_f32 v34, v32, v77
    v_sub_f32 v35, v33, v77
    v_sub_f32 v38, v36, v77
    v_sub_f32 v39, v37, v77
    v_exp_f32 v34, v34
    v_exp_f32 v35, v35
    v_exp_f32 v38, v38
    v_exp_f32 v39, v39
    v_cvt_pk_bf16_f32 v34, v34, v35
    v_cvt_pk_bf16_f32 v16, v38, v39
    v_cvt_pk_bf16_f32 v17, v38, v39
    v_cvt_pk_bf16_f32 v18, v38, v39
    ds_write_b32 v100, v34
    s_waitcnt lgkmcnt(0)
    s_barrier
    ds_read_b128 v[40:43], v93 offset:13056
    v_mov_b64 v[0:1], 0
    v_mov_b64 v[2:3], 0
    v_mov_b64 v[4:5], 0
    v_mov_b64 v[6:7], 0
    v_mov_b64 v[56:57], 0
    v_mov_b64 v[58:59], 0
    v_mov_b64 v[60:61], 0
    v_mov_b64 v[62:63], 0
    s_waitcnt lgkmcnt(0)
    v_mfma_f32_16x16x32_bf16 v[44:47], v[40:43], v[88:91], 0
    v_mfma_f32_16x16x32_bf16 v[72:75], v[80:83], v[40:43], 0
    v_mfma_f32_16x16x32_bf16 v[76:79], v[84:87], v[40:43], 0
    v_mfma_f32_16x16x16_bf16 v[44:47], v[18:19], v[88:89], v[44:47]
    v_mfma_f32_16x16x16_bf16 v[72:75], v[48:49], v[16:17], v[72:75]
    v_mfma_f32_16x16x16_bf16 v[76:79], v[52:53], v[16:17], v[76:79]
    s_nop 7
    v_cvt_pk_bf16_f32 v20, v72, v73
    v_cvt_pk_bf16_f32 v21, v74, v75
    s_mov_b64 exec, s[30:31]
    v_cvt_pk_bf16_f32 v20, v76, v77
    v_cvt_pk_bf16_f32 v21, v78, v79
    s_mov_b64 exec, -1
    ds_write_b64 v95, v[20:21] offset:15104
    v_cvt_pk_bf16_f32 v72, v72, v73
    v_cvt_pk_bf16_f32 v73, v74, v75
    v_cvt_pk_bf16_f32 v74, v76, v77
    v_cvt_pk_bf16_f32 v75, v78, v79
    s_nop 1
    v_smfmac_f32_16x16x64_bf16 v[0:3], v[72:75], a[168:175], v92
    v_and_b32 v50, 0x1f0, v95
    v_smfmac_f32_16x16x64_bf16 v[4:7], v[72:75], a[184:191], v92
    s_waitcnt lgkmcnt(0)
    s_barrier
    ds_read_b128 v[20:23], v50 offset:15616
    v_mov_b64 v[60:61], 0
    v_mov_b64 v[62:63], 0
    v_smfmac_f32_16x16x64_bf16 v[56:59], v[72:75], a[216:223], v92
    ds_read_b128 v[24:27], v50 offset:14080
    v_lshrrev_b32 v54, 2, v93
    v_smfmac_f32_16x16x64_bf16 v[60:63], v[72:75], a[232:239], v92
    ds_read_b128 v[28:31], v50 offset:14592
    v_rcp_f32 v34, v44
    v_rcp_f32 v35, v46
    s_nop 0
    s_waitcnt lgkmcnt(2)
    v_smfmac_f32_16x16x64_bf16 v[0:3], v[20:23], v[64:71], v92
    ds_read_b128 v[72:75], v94 offset:4096
    v_max3_f32 v39, v44, v46, v34
    s_waitcnt lgkmcnt(2)
    v_smfmac_f32_16x16x64_bf16 v[0:3], v[24:27], v[8:15], v92
    ds_read_b128 v[76:79], v94 offset:5120
    v_max_f32 v39, v39, v35
    s_waitcnt lgkmcnt(2)
    v_smfmac_f32_16x16x64_bf16 v[0:3], v[28:31], a[176:183], v92
    ds_read_b128 v[40:43], v94 offset:6144
    v_cmp_lt_f32 vcc, s64, v39
    v_smfmac_f32_16x16x64_bf16 v[4:7], v[20:23], a[192:199], v92
    ds_read_b128 v[44:47], v94 offset:7168
    v_smfmac_f32_16x16x64_bf16 v[4:7], v[24:27], a[200:207], v92
    s_waitcnt lgkmcnt(0)
    s_branch C_after_f2
.p2align 6
C_base_f3:
    s_nop 0
    s_nop 0
C_trok_f3:
    buffer_load_dwordx4 v93, s[4:7], s52 offen offset:0 sc1 lds
    buffer_load_dwordx4 v93, s[4:7], s52 offen offset:1024 sc1 lds
    v_mov_b64 v[78:79], v[110:111]
    v_mov_b64 v[80:81], v[112:113]
    v_mov_b64 v[82:83], v[114:115]
    v_mov_b64 v[84:85], v[116:117]
    v_mov_b64 v[86:87], v[118:119]
C_poll2_f3:
    s_barrier
    ds_read_b128 v[0:3], v93 offset:0
    ds_read_b128 v[4:7], v93 offset:1024
    global_store_dword v54, v55, s[26:27] offset:0
    global_store_dword v54, v55, s[26:27] offset:256
    global_store_dword v54, v55, s[26:27] offset:512
C_go1_f3:
    s_waitcnt lgkmcnt(1)
    v_smfmac_f32_16x16x64_bf16 v[32:35], v[0:3], v[56:63], v92
    s_waitcnt lgkmcnt(0)
    v_smfmac_f32_16x16x64_bf16 v[32:35], v[4:7], v[120:127], v92
    s_barrier
    v_smfmac_f32_16x16x64_bf16 v[36:39], v[0:3], v[64:71], v92
    v_smfmac_f32_16x16x64_bf16 v[40:43], v[0:3], v[216:223], v92
    ds_read_b128 v[8:11], v93 offset:2048
    buffer_load_dwordx4 v[104:107], v93, s[4:7], s56 offen offset:0 sc1
    v_smfmac_f32_16x16x64_bf16 v[36:39], v[4:7], v[128:135], v92
    ds_read_b128 v[12:15], v93 offset:3072
    v_smfmac_f32_16x16x64_bf16 v[40:43], v[4:7], v[232:239], v92
    ds_read_b128 v[56:59], v94 offset:14336
    v_smfmac_f32_16x16x64_bf16 v[44:47], v[0:3], v[224:231], v92
    ds_read_b128 v[60:63], v94 offset:15360
    v_smfmac_f32_16x16x64_bf16 v[44:47], v[4:7], v[240:247], v92
    s_barrier
    ds_read_b128 v[16:19], v93 offset:4096
    buffer_load_dwordx4 v[108:111], v93, s[4:7], s56 offen offset:1024 sc1
    s_waitcnt lgkmcnt(4)
    v_smfmac_f32_16x16x64_bf16 v[32:35], v[8:11], v[136:143], v92
    ds_read_b128 v[20:23], v93 offset:5120
    s_waitcnt lgkmcnt(4)
    v_smfmac_f32_16x16x64_bf16 v[32:35], v[12:15], v[152:159], v92
    ds_read_b128 v[64:67], v94 offset:16384
    v_smfmac_f32_16x16x64_bf16 v[36:39], v[8:11], v[144:151], v92
    ds_read_b128 v[68:71], v94 offset:17408
    v_smfmac_f32_16x16x64_bf16 v[36:39], v[12:15], v[160:167], v92
    s_waitcnt vmcnt(5)
    s_barrier
    buffer_load_dwordx4 v[112:115], v93, s[4:7], s56 offen offset:2048 sc1
    s_waitcnt lgkmcnt(3)
    v_smfmac_f32_16x16x64_bf16 v[32:35], v[16:19], v[56:63], v92
    ds_read_b128 v[24:27], v93 offset:6144
    s_waitcnt lgkmcnt(3)
    v_smfmac_f32_16x16x64_bf16 v[32:35], v[20:23], v[168:175], v92
    ds_read_b128 v[28:31], v93 offset:7168
    v_add_u32 v52, s45, v54
C_go2_f3:
    v_smfmac_f32_16x16x64_bf16 v[36:39], v[20:23], v[176:183], v92
    ds_read_b128 v[56:59], v94 offset:22528
    s_waitcnt lgkmcnt(3)
    v_smfmac_f32_16x16x64_bf16 v[36:39], v[16:19], v[64:71], v92
    ds_read_b128 v[60:63], v94 offset:23552
    buffer_load_dwordx4 v[116:119], v93, s[4:7], s56 offen offset:3072 sc1
    s_waitcnt lgkmcnt(3)
    v_smfmac_f32_16x16x64_bf16 v[32:35], v[24:27], v[184:191], v92
    ds_read_b128 v[64:67], v94 offset:24576
    global_store_dword v54, v55, s[26:27] offset:768
    s_waitcnt lgkmcnt(3)
    v_smfmac_f32_16x16x64_bf16 v[32:35], v[28:31], v[200:207], v92
    ds_read_b128 v[68:71], v94 offset:25600
    v_mov_b64 v[48:49], 0
    v_smfmac_f32_16x16x64_bf16 v[36:39], v[24:27], v[192:199], v92
    global_store_dword v54, v55, s[26:27] offset:1024
    ds_read_b32 v53, v52 offset:0
    v_mov_b64 v[50:51], 0
    v_smfmac_f32_16x16x64_bf16 v[36:39], v[28:31], v[208:215], v92
    global_store_dword v54, v55, s[26:27] offset:1280
    s_waitcnt lgkmcnt(3)
    v_mul_f32 v33, s62, v33
    v_mul_f32 v35, s62, v35
    v_smfmac_f32_16x16x64_bf16 v[40:43], v[16:19], v[56:63], v92
    global_store_dword v54, v55, s[26:27] offset:1536
    v_fma_f32 v32, v32, s62, v33
    v_fma_f32 v34, v34, s62, v35
    v_smfmac_f32_16x16x64_bf16 v[40:43], v[8:11], v[248:255], v92
    ds_read_b128 v[56:59], v94 offset:26624
    v_mul_f32 v37, s62, v37
    v_mul_f32 v39, s62, v39
    v_smfmac_f32_16x16x64_bf16 v[40:43], v[12:15], a[8:15], v92
    ds_read_b128 v[60:63], v94 offset:27648
    v_fma_f32 v36, v36, s62, v37
    v_fma_f32 v38, v38, s62, v39
    v_smfmac_f32_16x16x64_bf16 v[40:43], v[24:27], a[24:31], v92
    global_store_dword v54, v55, s[26:27] offset:1792
    s_waitcnt lgkmcnt(2)
    buffer_store_dword v53, v52, s[4:7], s55 offen sc1
    v_cvt_pk_bf16_f32 v32, v32, v36
    v_cvt_pk_bf16_f32 v33, v34, v38
    v_smfmac_f32_16x16x64_bf16 v[44:47], v[16:19], v[64:71], v92
    ds_write2_b32 v96, v32, v33 offset0:0 offset1:72
    v_smfmac_f32_16x16x64_bf16 v[40:43], v[28:31], a[40:47], v92
    ds_read_b128 v[64:67], v94 offset:28672
    v_cmp_u_f32 vcc, v36, v38
    v_smfmac_f32_16x16x64_bf16 v[44:47], v[8:11], a[0:7], v92
    ds_read_b128 v[68:71], v94 offset:29696
    s_waitcnt lgkmcnt(3)
    v_mov_b64 v[32:33], 0
    v_smfmac_f32_16x16x64_bf16 v[40:43], v[20:23], v[56:63], v92
    buffer_store_dword v55, v103, s[4:7], s54 offen
    v_smfmac_f32_16x16x64_bf16 v[44:47], v[12:15], a[16:23], v92
    s_cbranch_vccnz C_retry2_f3
C_ok2_f3:
    v_mov_b64 v[34:35], 0
    v_mov_b64 v[54:55], 0
    v_smfmac_f32_16x16x64_bf16 v[44:47], v[24:27], a[32:39], v92
    s_waitcnt lgkmcnt(2)
    s_barrier
    ds_read_b128 v[56:59], v98 offset:0
    v_smfmac_f32_16x16x64_bf16 v[44:47], v[28:31], a[48:55], v92
    ds_read_b128 v[60:63], v98 offset:64
    s_waitcnt lgkmcnt(2)
    v_add_f32 v40, v40, v41
    v_smfmac_f32_16x16x64_bf16 v[44:47], v[20:23], v[64:71], v92
    ds_read_b128 v[64:67], v98 offset:128
    v_add_f32 v42, v42, v43
    v_smfmac_f32_16x16x64_bf16 v[48:51], v[0:3], a[56:63], v92
    ds_read_b128 v[68:71], v98 offset:192
    v_mov_b64 v[52:53], 0
    v_smfmac_f32_16x16x64_bf16 v[48:51], v[4:7], a[72:79], v92
    v_add_f32 v44, v44, v45
    v_add_f32 v46, v46, v47
    v_smfmac_f32_16x16x64_bf16 v[52:55], v[0:3], a[64:71], v92
    s_waitcnt lgkmcnt(2)
    v_cvt_pk_bf16_f32 v40, v40, v44
    v_cvt_pk_bf16_f32 v41, v42, v46
    v_smfmac_f32_16x16x64_bf16 v[32:35], v[72:75], v[56:63], v92
    ds_write2_b32 v97, v40, v41 offset0:0 offset1:80
    s_waitcnt lgkmcnt(1)
    v_smfmac_f32_16x16x64_bf16 v[32:35], v[76:79], v[64:71], v92
    ds_read_b128 v[0:3], v94 offset:18432
    v_mov_b64 v[36:37], 0
    v_smfmac_f32_16x16x64_bf16 v[52:55], v[4:7], a[80:87], v92
    ds_read_b128 v[4:7], v94 offset:19456
    v_mov_b64 v[38:39], 0
    v_smfmac_f32_16x16x64_bf16 v[48:51], v[8:11], a[88:95], v92
    v_add_f32 v32, v32, v33
    v_add_f32 v33, v34, v35
    v_smfmac_f32_16x16x64_bf16 v[48:51], v[12:15], a[104:111], v92
    s_waitcnt lgkmcnt(2)
    s_barrier
    v_exp_f32 v34, v32
    v_smfmac_f32_16x16x64_bf16 v[48:51], v[16:19], a[120:127], v92
    ds_read_b128 v[72:75], v99
    s_waitcnt lgkmcnt(1)
    v_smfmac_f32_16x16x64_bf16 v[48:51], v[28:31], v[0:7], v92
    ds_read_b128 v[76:79], v99 offset:128
    v_exp_f32 v35, v33
    v_smfmac_f32_16x16x64_bf16 v[48:51], v[20:23], a[136:143], v92
    v_cvt_pk_bf16_f32 v34, v34, v35
    v_smfmac_f32_16x16x64_bf16 v[48:51], v[24:27], a[152:159], v92
    ds_write_b32 v100, v34
    s_waitcnt lgkmcnt(2)
    v_smfmac_f32_16x16x64_bf16 v[36:39], v[72:75], v[56:63], v92
    s_waitcnt lgkmcnt(1)
    v_mov_b64 v[0:1], 0
    v_smfmac_f32_16x16x64_bf16 v[36:39], v[76:79], v[64:71], v92
    ds_read_b128 v[56:59], v94 offset:20480
    v_cvt_pk_bf16_f32 v48, v48, v50
    v_smfmac_f32_16x16x64_bf16 v[52:55], v[8:11], a[96:103], v92
    ds_read_b128 v[60:63], v94 offset:21504
    v_cvt_pk_bf16_f32 v49, v49, v51
    v_smfmac_f32_16x16x64_bf16 v[52:55], v[12:15], a[112:119], v92
    s_waitcnt lgkmcnt(2)
    s_barrier
    ds_read_b128 v[40:43], v93 offset:13056
    v_add_f32 v36, v36, v37
    v_smfmac_f32_16x16x64_bf16 v[52:55], v[16:19], a[128:135], v92
    ds_read_b128 v[64:67], v94 offset:0
    ds_read_b128 v[68:71], v94 offset:1024
    v_add_f32 v37, v38, v39
    v_smfmac_f32_16x16x64_bf16 v[52:55], v[20:23], a[144:151], v92
    s_waitcnt lgkmcnt(3)
    v_exp_f32 v38, v36
    v_smfmac_f32_16x16x64_bf16 v[52:55], v[28:31], v[56:63], v92
    ds_read_b128 v[8:11], v94 offset:2048
    v_exp_f32 v39, v37
    v_smfmac_f32_16x16x64_bf16 v[52:55], v[24:27], a[160:167], v92
    ds_read_b128 v[12:15], v94 offset:3072
    s_waitcnt lgkmcnt(4)
    v_mfma_f32_16x16x32_bf16 v[72:75], v[80:83], v[40:43], 0
    v_cvt_pk_bf16_f32 v17, v38, v39
    v_mov_b64 v[2:3], 0
    v_mfma_f32_16x16x32_bf16 v[76:79], v[84:87], v[40:43], 0
    v_cvt_pk_bf16_f32 v16, v38, v39
    v_cvt_pk_bf16_f32 v52, v52, v54
    v_cvt_pk_bf16_f32 v53, v53, v55
    v_mfma_f32_16x16x16_bf16 v[72:75], v[48:49], v[16:17], v[72:75]
    v_cvt_pk_bf16_f32 v18, v38, v39
    v_mov_b32 v19, 0
    v_mfma_f32_16x16x16_bf16 v[76:79], v[52:53], v[16:17], v[76:79]
    v_mov_b64 v[4:5], 0
    v_mov_b64 v[6:7], 0
    v_mfma_f32_16x16x32_bf16 v[44:47], v[40:43], v[88:91], 0
    v_cvt_pk_bf16_f32 v20, v72, v73
    v_cvt_pk_bf16_f32 v21, v74, v75
    s_mov_b64 exec, s[30:31]
    v_cvt_pk_bf16_f32 v20, v76, v77
    v_cvt_pk_bf16_f32 v21, v78, v79
    s_mov_b64 exec, -1
    ds_write_b64 v95, v[20:21] offset:15616
    v_mfma_f32_16x16x16_bf16 v[44:47], v[18:19], v[88:89], v[44:47]
    v_cvt_pk_bf16_f32 v72, v72, v73
    v_cvt_pk_bf16_f32 v73, v74, v75
    v_cvt_pk_bf16_f32 v74, v76, v77
    v_cvt_pk_bf16_f32 v75, v78, v79
    v_mov_b64 v[56:57], 0
    v_mov_b64 v[58:59], 0
    v_smfmac_f32_16x16x64_bf16 v[0:3], v[72:75], a[168:175], v92
    v_and_b32 v50, 0x1f0, v95
    v_smfmac_f32_16x16x64_bf16 v[4:7], v[72:75], a[184:191], v92
    s_waitcnt lgkmcnt(0)
    s_barrier
    ds_read_b128 v[20:23], v50 offset:15104
    v_mov_b64 v[60:61], 0
    v_mov_b64 v[62:63], 0
    v_smfmac_f32_16x16x64_bf16 v[56:59], v[72:75], a[216:223], v92
    ds_read_b128 v[24:27], v50 offset:14592
    v_lshrrev_b32 v54, 2, v93
    v_smfmac_f32_16x16x64_bf16 v[60:63], v[72:75], a[232:239], v92
    ds_read_b128 v[28:31], v50 offset:14080
    v_rcp_f32 v34, v44
    v_rcp_f32 v35, v46
    s_nop 0
    s_waitcnt lgkmcnt(2)
    v_smfmac_f32_16x16x64_bf16 v[0:3], v[20:23], v[64:71], v92
    ds_read_b128 v[72:75], v94 offset:4096
    s_waitcnt lgkmcnt(2)
    v_max3_f32 v39, v44, v46, v34
    v_smfmac_f32_16x16x64_bf16 v[0:3], v[24:27], v[8:15], v92
    ds_read_b128 v[76:79], v94 offset:5120
    s_waitcnt lgkmcnt(2)
    v_max_f32 v39, v39, v35
    v_smfmac_f32_16x16x64_bf16 v[0:3], v[28:31], a[176:183], v92
    ds_read_b128 v[40:43], v94 offset:6144
    v_cmp_lt_f32 vcc, s64, v39
    v_smfmac_f32_16x16x64_bf16 v[4:7], v[20:23], a[192:199], v92
    ds_read_b128 v[44:47], v94 offset:7168
    v_smfmac_f32_16x16x64_bf16 v[4:7], v[24:27], a[200:207], v92
    s_cbranch_vccnz C_slow_f3
C_after_f3:
    v_mul_f32 v0, v0, v34
    v_mul_f32 v1, v1, v34
    v_mul_f32 v2, v2, v35
    v_mul_f32 v3, v3, v35
    v_cvt_pk_bf16_f32 v0, v0, v1
    v_cvt_pk_bf16_f32 v1, v2, v3
    v_smfmac_f32_16x16x64_bf16 v[4:7], v[28:31], a[208:215], v92
    global_store_dword v101, v0, s[16:17]
    global_store_dword v101, v1, s[16:17] offset:2048
    s_waitcnt lgkmcnt(2)
    v_smfmac_f32_16x16x64_bf16 v[56:59], v[20:23], v[72:79], v92
    ds_read_b128 v[80:83], v94 offset:8192
    v_mov_b64 v[16:17], 0
    v_smfmac_f32_16x16x64_bf16 v[56:59], v[24:27], a[224:231], v92
    ds_read_b128 v[84:87], v94 offset:9216
    s_waitcnt lgkmcnt(2)
    v_mul_f32 v4, v4, v34
    v_mul_f32 v5, v5, v34
    v_mul_f32 v6, v6, v35
    v_mul_f32 v7, v7, v35
    v_cvt_pk_bf16_f32 v4, v4, v5
    v_cvt_pk_bf16_f32 v5, v6, v7
    v_smfmac_f32_16x16x64_bf16 v[56:59], v[28:31], v[40:47], v92
    global_store_dword v101, v4, s[18:19]
    global_store_dword v101, v5, s[18:19] offset:2048
    v_smfmac_f32_16x16x64_bf16 v[60:63], v[20:23], a[240:247], v92
    v_mov_b64 v[18:19], 0
    v_smfmac_f32_16x16x64_bf16 v[60:63], v[24:27], a[248:255], v92
    s_waitcnt lgkmcnt(0)
    v_mul_f32 v56, v56, v34
    v_mul_f32 v57, v57, v34
    v_mul_f32 v58, v58, v35
    v_mul_f32 v59, v59, v35
    v_cvt_pk_bf16_f32 v56, v56, v57
    v_cvt_pk_bf16_f32 v57, v58, v59
    v_smfmac_f32_16x16x64_bf16 v[60:63], v[28:31], v[80:87], v92
    global_store_dword v101, v56, s[20:21]
    global_store_dword v101, v57, s[20:21] offset:2048
    v_mov_b64 v[4:5], 0
    v_mov_b64 v[6:7], 0
    v_and_b32 v51, 0x80, v54
    v_lshl_add_u32 v51, v51, 23, v54
    v_mov_b32 v49, -1
    s_nop 0
    v_mul_f32 v60, v60, v34
    v_mul_f32 v61, v61, v34
    v_mul_f32 v62, v62, v35
    v_mul_f32 v63, v63, v35
    v_cvt_pk_bf16_f32 v60, v60, v61
    v_cvt_pk_bf16_f32 v61, v62, v63
    global_store_dword v101, v60, s[22:23]
    global_store_dword v101, v61, s[22:23] offset:2048
    s_add_u32 s55, s55, 16384
    s_add_u32 s72, s51, s73
    s_add_u32 s52, s51, 6144
    s_mov_b32 s26, s24
    s_waitcnt vmcnt(0)
    v_mov_b32 v55, -1
    v_mov_b64 v[40:41], 0
    v_mov_b64 v[42:43], 0
C_ld1_f3:
    global_load_dword v8, v54, s[24:25] offset:0 sc1
    global_load_dword v9, v54, s[24:25] offset:256 sc1
    global_load_dword v10, v54, s[24:25] offset:512 sc1
    global_load_dword v11, v54, s[24:25] offset:768 sc1
    global_load_dword v12, v54, s[24:25] offset:1024 sc1
    global_load_dword v13, v54, s[24:25] offset:1280 sc1
    global_load_dword v14, v54, s[24:25] offset:1536 sc1
    global_load_dword v15, v54, s[24:25] offset:1792 sc1
C_red_f3:
    s_waitcnt vmcnt(0)
    v_smfmac_f32_16x16x64_bf16 v[16:19], v[88:91], v[8:15], v92 abid:1
    s_mov_b64 exec, s[28:29]
    s_nop 6
    buffer_store_dword v16, v103, s[4:7], s51 offen
    s_mov_b64 exec, 0xffff
    v_cvt_pk_bf16_f32 v28, v16, v17
    buffer_store_dword v28, v103, s[4:7], s51 offen
    v_cmp_u_f32 vcc, v16, v17
    s_mov_b64 exec, -1
    s_cbranch_vccnz C_retry0_f3
C_ok1_f3:
    s_add_u32 s60, s60, 1
    s_cmp_eq_u32 s60, 63
    s_cbranch_scc1 C_done
C_flagok_f3:
    v_mov_b64 v[44:45], 0
    v_mov_b64 v[46:47], 0
    buffer_load_dword v49, v51, s[4:7], s72 offen sc1
    v_mov_b64 v[52:53], 0
    v_mov_b64 v[32:33], 0
    v_mov_b64 v[34:35], 0
    v_mov_b64 v[36:37], 0
    v_mov_b64 v[38:39], 0
    s_xor_b32 s16, s16, 0x80000
    s_xor_b32 s18, s18, 0x80000
    buffer_load_dword v49, v51, s[4:7], s72 offen sc1
    s_xor_b32 s20, s20, 0x80000
    s_xor_b32 s22, s22, 0x80000
    s_add_u32 s56, s56, 0x80000
    ds_read_b128 v[56:59], v94 offset:10240
    s_mov_b32 s67, s51
    s_add_u32 s51, s51, 16384
    ds_read_b128 v[60:63], v94 offset:11264
    buffer_load_dword v49, v51, s[4:7], s72 offen sc1
    s_bitset0_b32 s51, 16
    s_xor_b32 s54, s51, 32768
    ds_read_b128 v[64:67], v94 offset:12288
    s_xor_b32 s24, s24, 0x80000
    ds_read_b128 v[68:71], v94 offset:13312
    buffer_load_dword v49, v51, s[4:7], s72 offen sc1
    v_mov_b64 v[72:73], v[104:105]
    v_mov_b64 v[74:75], v[106:107]
    v_mov_b64 v[76:77], v[108:109]
    buffer_load_dword v49, v51, s[4:7], s72 offen sc1
C_tr_f3:
    s_waitcnt vmcnt(4)
    v_cmp_le_u32 vcc, s63, v49
    buffer_load_dword v49, v51, s[4:7], s72 offen sc1
    s_cbranch_vccz C_trok_f3
    s_waitcnt vmcnt(4)
    v_cmp_le_u32 vcc, s63, v49
    buffer_load_dword v49, v51, s[4:7], s72 offen sc1
    s_cbranch_vccz C_trok_f3
    s_waitcnt vmcnt(4)
    v_cmp_le_u32 vcc, s63, v49
    buffer_load_dword v49, v51, s[4:7], s72 offen sc1
    s_cbranch_vccz C_trok_f3
    s_waitcnt vmcnt(4)
    v_cmp_le_u32 vcc, s63, v49
    buffer_load_dword v49, v51, s[4:7], s72 offen sc1
    s_cbranch_vccz C_trok_f3
    s_waitcnt vmcnt(4)
    v_cmp_le_u32 vcc, s63, v49
    buffer_load_dword v49, v51, s[4:7], s72 offen sc1
    s_cbranch_vccz C_trok_f3
    s_waitcnt vmcnt(4)
    v_cmp_le_u32 vcc, s63, v49
    buffer_load_dword v49, v51, s[4:7], s72 offen sc1
    s_cbranch_vccz C_trok_f3
    s_sub_u32 s69, s69, 1
    s_cbranch_scc0 C_tr_f3
    s_branch C_fail
C_retry2_f3:
    v_max_u32 v37, v0, v1
    v_max3_u32 v37, v37, v2, v3
    v_max3_u32 v37, v37, v4, v5
    v_max3_u32 v37, v37, v6, v7
    v_max3_u32 v37, v37, v8, v9
    v_max3_u32 v37, v37, v10, v11
    v_max3_u32 v37, v37, v12, v13
    v_max3_u32 v37, v37, v14, v15
    v_max3_u32 v37, v37, v16, v17
    v_max3_u32 v37, v37, v18, v19
    v_max3_u32 v37, v37, v20, v21
    v_max3_u32 v37, v37, v22, v23
    v_max3_u32 v37, v37, v24, v25
    v_max3_u32 v37, v37, v26, v27
    v_max3_u32 v37, v37, v28, v29
    v_max3_u32 v37, v37, v30, v31
    v_cmp_le_u32 vcc, s61, v37
    s_cbranch_vccz C_ok2_f3
C_rr_f3:
    s_mov_b32 m0, 0
    s_add_u32 s65, s67, 0
    buffer_load_dwordx4 v93, s[4:7], s65 offen offset:0 sc1 lds
    buffer_load_dwordx4 v93, s[4:7], s65 offen offset:1024 sc1 lds
    buffer_load_dwordx4 v93, s[4:7], s65 offen offset:2048 sc1 lds
    buffer_load_dwordx4 v93, s[4:7], s65 offen offset:3072 sc1 lds
    s_mov_b32 m0, 4096
    s_add_u32 s65, s67, 4096
    buffer_load_dwordx4 v93, s[4:7], s65 offen offset:0 sc1 lds
    buffer_load_dwordx4 v93, s[4:7], s65 offen offset:1024 sc1 lds
    buffer_load_dwordx4 v93, s[4:7], s65 offen offset:2048 sc1 lds
    buffer_load_dwordx4 v93, s[4:7], s65 offen offset:3072 sc1 lds
    s_sub_u32 s69, s69, 1
    s_cbranch_scc1 C_fail
    s_waitcnt vmcnt(0) lgkmcnt(0)
    ds_read_b128 v[0:3], v93 offset:0
    ds_read_b128 v[4:7], v93 offset:1024
    ds_read_b128 v[8:11], v93 offset:2048
    ds_read_b128 v[12:15], v93 offset:3072
    ds_read_b128 v[16:19], v93 offset:4096
    ds_read_b128 v[20:23], v93 offset:5120
    ds_read_b128 v[24:27], v93 offset:6144
    ds_read_b128 v[28:31], v93 offset:7168
    s_waitcnt lgkmcnt(0)
    v_max_u32 v37, v0, v1
    v_max3_u32 v37, v37, v2, v3
    v_max3_u32 v37, v37, v4, v5
    v_max3_u32 v37, v37, v6, v7
    v_max3_u32 v37, v37, v8, v9
    v_max3_u32 v37, v37, v10, v11
    v_max3_u32 v37, v37, v12, v13
    v_max3_u32 v37, v37, v14, v15
    v_max3_u32 v37, v37, v16, v17
    v_max3_u32 v37, v37, v18, v19
    v_max3_u32 v37, v37, v20, v21
    v_max3_u32 v37, v37, v22, v23
    v_max3_u32 v37, v37, v24, v25
    v_max3_u32 v37, v37, v26, v27
    v_max3_u32 v37, v37, v28, v29
    v_max3_u32 v37, v37, v30, v31
    v_cmp_le_u32 vcc, s61, v37
    s_cbranch_vccz C_rg_f3
    s_branch C_rr_f3
C_rg_f3:
    v_mov_b64 v[32:33], 0
    v_mov_b64 v[34:35], 0
    v_mov_b64 v[36:37], 0
    v_mov_b64 v[38:39], 0
    v_mov_b64 v[40:41], 0
    v_mov_b64 v[42:43], 0
    v_mov_b64 v[44:45], 0
    v_mov_b64 v[46:47], 0
    s_mov_b32 m0, 6144
    ds_read_b128 v[56:59], v94 offset:10240
    ds_read_b128 v[60:63], v94 offset:11264
    s_waitcnt lgkmcnt(0)
    v_smfmac_f32_16x16x64_bf16 v[32:35], v[0:3], v[56:63], v92
    ds_read_b128 v[64:67], v94 offset:12288
    ds_read_b128 v[68:71], v94 offset:13312
    s_waitcnt lgkmcnt(0)
    v_smfmac_f32_16x16x64_bf16 v[36:39], v[0:3], v[64:71], v92
    v_smfmac_f32_16x16x64_bf16 v[32:35], v[4:7], v[120:127], v92
    v_smfmac_f32_16x16x64_bf16 v[36:39], v[4:7], v[128:135], v92
    v_smfmac_f32_16x16x64_bf16 v[40:43], v[0:3], v[216:223], v92
    v_smfmac_f32_16x16x64_bf16 v[40:43], v[4:7], v[232:239], v92
    v_smfmac_f32_16x16x64_bf16 v[44:47], v[0:3], v[224:231], v92
    v_smfmac_f32_16x16x64_bf16 v[44:47], v[4:7], v[240:247], v92
    v_smfmac_f32_16x16x64_bf16 v[32:35], v[8:11], v[136:143], v92
    v_smfmac_f32_16x16x64_bf16 v[32:35], v[12:15], v[152:159], v92
    v_smfmac_f32_16x16x64_bf16 v[36:39], v[8:11], v[144:151], v92
    v_smfmac_f32_16x16x64_bf16 v[36:39], v[12:15], v[160:167], v92
    ds_read_b128 v[56:59], v94 offset:14336
    ds_read_b128 v[60:63], v94 offset:15360
    s_waitcnt lgkmcnt(0)
    v_smfmac_f32_16x16x64_bf16 v[32:35], v[16:19], v[56:63], v92
    v_smfmac_f32_16x16x64_bf16 v[32:35], v[20:23], v[168:175], v92
    ds_read_b128 v[64:67], v94 offset:16384
    ds_read_b128 v[68:71], v94 offset:17408
    s_waitcnt lgkmcnt(0)
    s_branch C_go2_f3
C_retry0_f3:
    global_load_dword v20, v54, s[24:25] offset:0 sc1
    global_load_dword v21, v54, s[24:25] offset:256 sc1
    global_load_dword v22, v54, s[24:25] offset:512 sc1
    global_load_dword v23, v54, s[24:25] offset:768 sc1
    global_load_dword v24, v54, s[24:25] offset:1024 sc1
    global_load_dword v25, v54, s[24:25] offset:1280 sc1
    global_load_dword v26, v54, s[24:25] offset:1536 sc1
    global_load_dword v27, v54, s[24:25] offset:1792 sc1
    s_waitcnt vmcnt(0)
C_retry1_f3:
    s_waitcnt vmcnt(1)
C_r1b_f3:
    v_smfmac_f32_16x16x64_bf16 v[4:7], v[88:91], v[20:27], v92 abid:1
    global_load_dword v8, v54, s[24:25] offset:0 sc1
    global_load_dword v9, v54, s[24:25] offset:256 sc1
    global_load_dword v10, v54, s[24:25] offset:512 sc1
    global_load_dword v11, v54, s[24:25] offset:768 sc1
    global_load_dword v12, v54, s[24:25] offset:1024 sc1
    global_load_dword v13, v54, s[24:25] offset:1280 sc1
    global_load_dword v14, v54, s[24:25] offset:1536 sc1
    global_load_dword v15, v54, s[24:25] offset:1792 sc1
    v_mov_b64 v[16:17], 0
    v_mov_b64 v[18:19], 0
    v_cvt_pk_bf16_f32 v28, v4, v5
    buffer_store_dword v28, v103, s[4:7], s51 offen
    v_cmp_u_f32 vcc, v4, v5
    s_cbranch_vccz C_ok1_f3
    v_max3_u32 v6, v20, v21, v22
    v_max3_u32 v7, v23, v24, v25
    v_max3_u32 v6, v6, v26, v27
    v_max_u32 v6, v6, v7
    v_cmp_eq_u32 vcc, -1, v6
    global_load_dword v20, v54, s[24:25] offset:0 sc1
    global_load_dword v21, v54, s[24:25] offset:256 sc1
    global_load_dword v22, v54, s[24:25] offset:512 sc1
    global_load_dword v23, v54, s[24:25] offset:768 sc1
    global_load_dword v24, v54, s[24:25] offset:1024 sc1
    global_load_dword v25, v54, s[24:25] offset:1280 sc1
    global_load_dword v26, v54, s[24:25] offset:1536 sc1
    global_load_dword v27, v54, s[24:25] offset:1792 sc1
    s_cbranch_vccz C_nan1_f3
    v_mov_b64 v[4:5], 0
    v_mov_b64 v[6:7], 0
    s_sub_u32 s69, s69, 1
    s_cbranch_scc1 C_fail
    s_waitcnt vmcnt(9)
    v_smfmac_f32_16x16x64_bf16 v[16:19], v[88:91], v[8:15], v92 abid:1
    s_nop 7
    v_cvt_pk_bf16_f32 v28, v16, v17
    buffer_store_dword v28, v103, s[4:7], s51 offen
    v_cmp_u_f32 vcc, v16, v17
    s_cbranch_vccz C_ok1_f3
    s_branch C_retry1_f3
C_nan1_f3:
    v_cmp_le_u32 vcc, s63, v28
    v_and_b32 v6, 0x7fffffff, v28
    s_nop 0
    v_cndmask_b32 v28, v28, v6, vcc
    buffer_store_dword v28, v103, s[4:7], s51 offen
    s_waitcnt vmcnt(0)
    s_branch C_ok1_f3
C_flag_f3:
    buffer_load_dword v102, off, s[4:7], s58 sc1
    s_sub_u32 s69, s69, 1
    s_cbranch_scc1 C_fail
    s_waitcnt vmcnt(0)
    v_readfirstlane_b32 s70, v102
    s_nop 3
    s_cmp_le_u32 s70, s59
    s_cbranch_scc1 C_flag_f3
    s_branch C_flagok_f3
C_slow_f3:
    s_waitcnt lgkmcnt(0)
    s_nop 7
    v_max3_f32 v77, v32, v33, v36
    v_max_f32 v77, v77, v37
    v_bfe_u32 v76, v93, 4, 4
    v_lshlrev_b32 v76, 6, v76
    v_lshrrev_b32 v78, 8, v93
    v_lshl_add_u32 v78, v78, 2, v76
    ds_write_b32 v78, v77 offset:8240
    s_waitcnt lgkmcnt(0)
    s_barrier
    ds_read_b128 v[20:23], v76 offset:8192
    ds_read_b128 v[24:27], v76 offset:8208
    ds_read_b128 v[28:31], v76 offset:8224
    ds_read_b128 v[72:75], v76 offset:8240
    s_waitcnt lgkmcnt(3)
    v_max3_f32 v77, v77, v20, v21
    v_max3_f32 v77, v77, v22, v23
    s_waitcnt lgkmcnt(2)
    v_max3_f32 v77, v77, v24, v25
    v_max3_f32 v77, v77, v26, v27
    s_waitcnt lgkmcnt(1)
    v_max3_f32 v77, v77, v28, v29
    v_max3_f32 v77, v77, v30, v31
    s_waitcnt lgkmcnt(0)
    v_max3_f32 v77, v77, v72, v73
    v_max3_f32 v77, v77, v74, v75
    v_sub_f32 v34, v32, v77
    v_sub_f32 v35, v33, v77
    v_sub_f32 v38, v36, v77
    v_sub_f32 v39, v37, v77
    v_exp_f32 v34, v34
    v_exp_f32 v35, v35
    v_exp_f32 v38, v38
    v_exp_f32 v39, v39
    v_cvt_pk_bf16_f32 v34, v34, v35
    v_cvt_pk_bf16_f32 v16, v38, v39
    v_cvt_pk_bf16_f32 v17, v38, v39
    v_cvt_pk_bf16_f32 v18, v38, v39
    ds_write_b32 v100, v34
    s_waitcnt lgkmcnt(0)
    s_barrier
    ds_read_b128 v[40:43], v93 offset:13056
    v_mov_b64 v[0:1], 0
    v_mov_b64 v[2:3], 0
    v_mov_b64 v[4:5], 0
    v_mov_b64 v[6:7], 0
    v_mov_b64 v[56:57], 0
    v_mov_b64 v[58:59], 0
    v_mov_b64 v[60:61], 0
    v_mov_b64 v[62:63], 0
    s_waitcnt lgkmcnt(0)
    v_mfma_f32_16x16x32_bf16 v[44:47], v[40:43], v[88:91], 0
    v_mfma_f32_16x16x32_bf16 v[72:75], v[80:83], v[40:43], 0
    v_mfma_f32_16x16x32_bf16 v[76:79], v[84:87], v[40:43], 0
    v_mfma_f32_16x16x16_bf16 v[44:47], v[18:19], v[88:89], v[44:47]
    v_mfma_f32_16x16x16_bf16 v[72:75], v[48:49], v[16:17], v[72:75]
    v_mfma_f32_16x16x16_bf16 v[76:79], v[52:53], v[16:17], v[76:79]
    s_nop 7
    v_cvt_pk_bf16_f32 v20, v72, v73
    v_cvt_pk_bf16_f32 v21, v74, v75
    s_mov_b64 exec, s[30:31]
    v_cvt_pk_bf16_f32 v20, v76, v77
    v_cvt_pk_bf16_f32 v21, v78, v79
    s_mov_b64 exec, -1
    ds_write_b64 v95, v[20:21] offset:15616
    v_cvt_pk_bf16_f32 v72, v72, v73
    v_cvt_pk_bf16_f32 v73, v74, v75
    v_cvt_pk_bf16_f32 v74, v76, v77
    v_cvt_pk_bf16_f32 v75, v78, v79
    s_nop 1
    v_smfmac_f32_16x16x64_bf16 v[0:3], v[72:75], a[168:175], v92
    v_and_b32 v50, 0x1f0, v95
    v_smfmac_f32_16x16x64_bf16 v[4:7], v[72:75], a[184:191], v92
    s_waitcnt lgkmcnt(0)
    s_barrier
    ds_read_b128 v[20:23], v50 offset:15104
    v_mov_b64 v[60:61], 0
    v_mov_b64 v[62:63], 0
    v_smfmac_f32_16x16x64_bf16 v[56:59], v[72:75], a[216:223], v92
    ds_read_b128 v[24:27], v50 offset:14592
    v_lshrrev_b32 v54, 2, v93
    v_smfmac_f32_16x16x64_bf16 v[60:63], v[72:75], a[232:239], v92
    ds_read_b128 v[28:31], v50 offset:14080
    v_rcp_f32 v34, v44
    v_rcp_f32 v35, v46
    s_nop 0
    s_waitcnt lgkmcnt(2)
    v_smfmac_f32_16x16x64_bf16 v[0:3], v[20:23], v[64:71], v92
    ds_read_b128 v[72:75], v94 offset:4096
    v_max3_f32 v39, v44, v46, v34
    s_waitcnt lgkmcnt(2)
    v_smfmac_f32_16x16x64_bf16 v[0:3], v[24:27], v[8:15], v92
    ds_read_b128 v[76:79], v94 offset:5120
    v_max_f32 v39, v39, v35
    s_waitcnt lgkmcnt(2)
    v_smfmac_f32_16x16x64_bf16 v[0:3], v[28:31], a[176:183], v92
    ds_read_b128 v[40:43], v94 offset:6144
    v_cmp_lt_f32 vcc, s64, v39
    v_smfmac_f32_16x16x64_bf16 v[4:7], v[20:23], a[192:199], v92
    ds_read_b128 v[44:47], v94 offset:7168
    v_smfmac_f32_16x16x64_bf16 v[4:7], v[24:27], a[200:207], v92
    s_waitcnt lgkmcnt(0)
    s_branch C_after_f3
.p2align 6
C_base_s0:
    s_nop 0
    s_nop 0
    s_nop 0
C_trok_s0:
    buffer_load_dwordx4 v93, s[4:7], s52 offen offset:0 sc1 lds
    buffer_load_dwordx4 v93, s[4:7], s52 offen offset:1024 sc1 lds
    v_mov_b64 v[72:73], v[104:105]
    v_mov_b64 v[74:75], v[106:107]
    v_mov_b64 v[76:77], v[108:109]
    v_mov_b64 v[78:79], v[110:111]
    v_mov_b64 v[80:81], v[112:113]
    v_mov_b64 v[82:83], v[114:115]
    v_mov_b64 v[84:85], v[116:117]
    v_mov_b64 v[86:87], v[118:119]
C_poll2_s0:
    s_waitcnt vmcnt(0)
    s_barrier
    ds_read_b128 v[0:3], v93 offset:0
    ds_read_b128 v[4:7], v93 offset:1024
    global_store_dword v54, v55, s[26:27] offset:0 sc1
    global_store_dword v54, v55, s[26:27] offset:256 sc1
    global_store_dword v54, v55, s[26:27] offset:512 sc1
C_go1_s0:
    s_waitcnt lgkmcnt(1)
    v_smfmac_f32_16x16x64_bf16 v[32:35], v[0:3], v[56:63], v92
    buffer_load_dwordx4 v[104:107], v93, s[4:7], s56 offen offset:0 sc1
    s_waitcnt lgkmcnt(0)
    v_smfmac_f32_16x16x64_bf16 v[32:35], v[4:7], v[120:127], v92
    s_barrier
    v_smfmac_f32_16x16x64_bf16 v[36:39], v[0:3], v[64:71], v92
    v_smfmac_f32_16x16x64_bf16 v[40:43], v[0:3], v[216:223], v92
    ds_read_b128 v[8:11], v93 offset:2048
    v_smfmac_f32_16x16x64_bf16 v[36:39], v[4:7], v[128:135], v92
    ds_read_b128 v[12:15], v93 offset:3072
    buffer_load_dwordx4 v[108:111], v93, s[4:7], s56 offen offset:1024 sc1
    v_smfmac_f32_16x16x64_bf16 v[40:43], v[4:7], v[232:239], v92
    ds_read_b128 v[56:59], v94 offset:14336
    v_smfmac_f32_16x16x64_bf16 v[44:47], v[0:3], v[224:231], v92
    ds_read_b128 v[60:63], v94 offset:15360
    v_smfmac_f32_16x16x64_bf16 v[44:47], v[4:7], v[240:247], v92
    s_barrier
    ds_read_b128 v[16:19], v93 offset:4096
    s_waitcnt lgkmcnt(4)
    v_smfmac_f32_16x16x64_bf16 v[32:35], v[8:11], v[136:143], v92
    ds_read_b128 v[20:23], v93 offset:5120
    buffer_load_dwordx4 v[112:115], v93, s[4:7], s56 offen offset:2048 sc1
    s_waitcnt lgkmcnt(4)
    v_smfmac_f32_16x16x64_bf16 v[32:35], v[12:15], v[152:159], v92
    ds_read_b128 v[64:67], v94 offset:16384
    v_smfmac_f32_16x16x64_bf16 v[36:39], v[8:11], v[144:151], v92
    ds_read_b128 v[68:71], v94 offset:17408
    v_smfmac_f32_16x16x64_bf16 v[36:39], v[12:15], v[160:167], v92
    s_barrier
    s_waitcnt lgkmcnt(3)
    v_smfmac_f32_16x16x64_bf16 v[32:35], v[16:19], v[56:63], v92
    ds_read_b128 v[24:27], v93 offset:6144
    buffer_load_dwordx4 v[116:119], v93, s[4:7], s56 offen offset:3072 sc1
    s_waitcnt lgkmcnt(3)
    v_smfmac_f32_16x16x64_bf16 v[32:35], v[20:23], v[168:175], v92
    ds_read_b128 v[28:31], v93 offset:7168
C_go2_s0:
    v_smfmac_f32_16x16x64_bf16 v[36:39], v[20:23], v[176:183], v92
    ds_read_b128 v[56:59], v94 offset:22528
    s_waitcnt lgkmcnt(3)
    v_smfmac_f32_16x16x64_bf16 v[36:39], v[16:19], v[64:71], v92
    ds_read_b128 v[60:63], v94 offset:23552
    s_waitcnt lgkmcnt(3)
    v_smfmac_f32_16x16x64_bf16 v[32:35], v[24:27], v[184:191], v92
    ds_read_b128 v[64:67], v94 offset:24576
    global_store_dword v54, v55, s[26:27] offset:768 sc1
    s_waitcnt lgkmcnt(3)
    v_smfmac_f32_16x16x64_bf16 v[32:35], v[28:31], v[200:207], v92
    ds_read_b128 v[68:71], v94 offset:25600
    v_mov_b64 v[48:49], 0
    v_smfmac_f32_16x16x64_bf16 v[36:39], v[24:27], v[192:199], v92
    global_store_dword v54, v55, s[26:27] offset:1024 sc1
    v_mov_b64 v[50:51], 0
    v_smfmac_f32_16x16x64_bf16 v[36:39], v[28:31], v[208:215], v92
    global_store_dword v54, v55, s[26:27] offset:1280 sc1
    s_waitcnt lgkmcnt(2)
    v_mul_f32 v33, s62, v33
    v_mul_f32 v35, s62, v35
    v_smfmac_f32_16x16x64_bf16 v[40:43], v[16:19], v[56:63], v92
    global_store_dword v54, v55, s[26:27] offset:1536 sc1
    v_fma_f32 v32, v32, s62, v33
    v_fma_f32 v34, v34, s62, v35
    v_smfmac_f32_16x16x64_bf16 v[40:43], v[8:11], v[248:255], v92
    ds_read_b128 v[56:59], v94 offset:26624
    v_mul_f32 v37, s62, v37
    v_mul_f32 v39, s62, v39
    v_smfmac_f32_16x16x64_bf16 v[40:43], v[12:15], a[8:15], v92
    ds_read_b128 v[60:63], v94 offset:27648
    v_fma_f32 v36, v36, s62, v37
    v_fma_f32 v38, v38, s62, v39
    v_smfmac_f32_16x16x64_bf16 v[40:43], v[24:27], a[24:31], v92
    global_store_dword v54, v55, s[26:27] offset:1792 sc1
    s_waitcnt lgkmcnt(2)
    v_cvt_pk_bf16_f32 v32, v32, v36
    v_cvt_pk_bf16_f32 v33, v34, v38
    v_smfmac_f32_16x16x64_bf16 v[44:47], v[16:19], v[64:71], v92
    ds_write2_b32 v96, v32, v33 offset0:0 offset1:72
    v_smfmac_f32_16x16x64_bf16 v[40:43], v[28:31], a[40:47], v92
    ds_read_b128 v[64:67], v94 offset:28672
    v_cmp_u_f32 vcc, v36, v38
    v_smfmac_f32_16x16x64_bf16 v[44:47], v[8:11], a[0:7], v92
    ds_read_b128 v[68:71], v94 offset:29696
    s_waitcnt lgkmcnt(3)
    v_mov_b64 v[32:33], 0
    v_smfmac_f32_16x16x64_bf16 v[40:43], v[20:23], v[56:63], v92
    buffer_store_dword v55, v103, s[4:7], s54 offen sc1
    v_smfmac_f32_16x16x64_bf16 v[44:47], v[12:15], a[16:23], v92
    s_cbranch_vccnz C_retry2_s0
C_ok2_s0:
    v_mov_b64 v[34:35], 0
    v_mov_b64 v[54:55], 0
    v_smfmac_f32_16x16x64_bf16 v[44:47], v[24:27], a[32:39], v92
    s_waitcnt lgkmcnt(2)
    s_barrier
    ds_read_b128 v[56:59], v98 offset:0
    v_smfmac_f32_16x16x64_bf16 v[44:47], v[28:31], a[48:55], v92
    ds_read_b128 v[60:63], v98 offset:64
    s_waitcnt lgkmcnt(2)
    v_add_f32 v40, v40, v41
    v_smfmac_f32_16x16x64_bf16 v[44:47], v[20:23], v[64:71], v92
    ds_read_b128 v[64:67], v98 offset:128
    v_add_f32 v42, v42, v43
    v_smfmac_f32_16x16x64_bf16 v[48:51], v[0:3], a[56:63], v92
    ds_read_b128 v[68:71], v98 offset:192
    v_smfmac_f32_16x16x64_bf16 v[48:51], v[4:7], a[72:79], v92
    v_add_f32 v44, v44, v45
    v_add_f32 v46, v46, v47
    v_smfmac_f32_16x16x64_bf16 v[52:55], v[0:3], a[64:71], v92
    s_waitcnt lgkmcnt(2)
    v_cvt_pk_bf16_f32 v40, v40, v44
    v_cvt_pk_bf16_f32 v41, v42, v46
    v_smfmac_f32_16x16x64_bf16 v[32:35], v[72:75], v[56:63], v92
    ds_write2_b32 v97, v40, v41 offset0:0 offset1:80
    s_waitcnt lgkmcnt(1)
    v_smfmac_f32_16x16x64_bf16 v[32:35], v[76:79], v[64:71], v92
    ds_read_b128 v[0:3], v94 offset:18432
    v_mov_b64 v[36:37], 0
    v_smfmac_f32_16x16x64_bf16 v[52:55], v[4:7], a[80:87], v92
    ds_read_b128 v[4:7], v94 offset:19456
    v_mov_b64 v[38:39], 0
    v_smfmac_f32_16x16x64_bf16 v[48:51], v[8:11], a[88:95], v92
    v_add_f32 v32, v32, v33
    v_add_f32 v33, v34, v35
    v_smfmac_f32_16x16x64_bf16 v[48:51], v[12:15], a[104:111], v92
    s_waitcnt lgkmcnt(2)
    s_barrier
    v_exp_f32 v34, v32
    v_smfmac_f32_16x16x64_bf16 v[48:51], v[16:19], a[120:127], v92
    ds_read_b128 v[72:75], v99
    s_waitcnt lgkmcnt(1)
    v_smfmac_f32_16x16x64_bf16 v[48:51], v[28:31], v[0:7], v92
    ds_read_b128 v[76:79], v99 offset:128
    v_exp_f32 v35, v33
    v_smfmac_f32_16x16x64_bf16 v[48:51], v[20:23], a[136:143], v92
    v_cvt_pk_bf16_f32 v34, v34, v35
    v_smfmac_f32_16x16x64_bf16 v[48:51], v[24:27], a[152:159], v92
    ds_write_b32 v100, v34
    s_waitcnt lgkmcnt(2)
    v_smfmac_f32_16x16x64_bf16 v[36:39], v[72:75], v[56:63], v92
    s_waitcnt lgkmcnt(1)
    v_mov_b64 v[0:1], 0
    v_smfmac_f32_16x16x64_bf16 v[36:39], v[76:79], v[64:71], v92
    ds_read_b128 v[56:59], v94 offset:20480
    v_cvt_pk_bf16_f32 v48, v48, v50
    v_smfmac_f32_16x16x64_bf16 v[52:55], v[8:11], a[96:103], v92
    ds_read_b128 v[60:63], v94 offset:21504
    v_cvt_pk_bf16_f32 v49, v49, v51
    v_smfmac_f32_16x16x64_bf16 v[52:55], v[12:15], a[112:119], v92
    s_waitcnt lgkmcnt(2)
    s_barrier
    ds_read_b128 v[40:43], v93 offset:13056
    v_add_f32 v36, v36, v37
    v_smfmac_f32_16x16x64_bf16 v[52:55], v[16:19], a[128:135], v92
    ds_read_b128 v[64:67], v94 offset:0
    ds_read_b128 v[68:71], v94 offset:1024
    v_add_f32 v37, v38, v39
    v_smfmac_f32_16x16x64_bf16 v[52:55], v[20:23], a[144:151], v92
    s_waitcnt lgkmcnt(3)
    v_exp_f32 v38, v36
    v_smfmac_f32_16x16x64_bf16 v[52:55], v[28:31], v[56:63], v92
    ds_read_b128 v[8:11], v94 offset:2048
    v_exp_f32 v39, v37
    v_smfmac_f32_16x16x64_bf16 v[52:55], v[24:27], a[160:167], v92
    ds_read_b128 v[12:15], v94 offset:3072
    s_waitcnt lgkmcnt(4)
    v_mfma_f32_16x16x32_bf16 v[72:75], v[80:83], v[40:43], 0
    v_cvt_pk_bf16_f32 v17, v38, v39
    v_mov_b64 v[2:3], 0
    v_mfma_f32_16x16x32_bf16 v[76:79], v[84:87], v[40:43], 0
    v_cvt_pk_bf16_f32 v16, v38, v39
    v_cvt_pk_bf16_f32 v52, v52, v54
    v_cvt_pk_bf16_f32 v53, v53, v55
    v_mfma_f32_16x16x16_bf16 v[72:75], v[48:49], v[16:17], v[72:75]
    v_cvt_pk_bf16_f32 v18, v38, v39
    v_mov_b32 v19, 0
    v_mfma_f32_16x16x16_bf16 v[76:79], v[52:53], v[16:17], v[76:79]
    v_mov_b64 v[4:5], 0
    v_mov_b64 v[6:7], 0
    v_mfma_f32_16x16x32_bf16 v[44:47], v[40:43], v[88:91], 0
    v_cvt_pk_bf16_f32 v20, v72, v73
    v_cvt_pk_bf16_f32 v21, v74, v75
    s_mov_b64 exec, s[30:31]
    v_cvt_pk_bf16_f32 v20, v76, v77
    v_cvt_pk_bf16_f32 v21, v78, v79
    s_mov_b64 exec, -1
    ds_write_b64 v95, v[20:21] offset:14080
    v_mfma_f32_16x16x16_bf16 v[44:47], v[18:19], v[88:89], v[44:47]
    v_cvt_pk_bf16_f32 v72, v72, v73
    v_cvt_pk_bf16_f32 v73, v74, v75
    v_cvt_pk_bf16_f32 v74, v76, v77
    v_cvt_pk_bf16_f32 v75, v78, v79
    v_mov_b64 v[56:57], 0
    v_mov_b64 v[58:59], 0
    v_smfmac_f32_16x16x64_bf16 v[0:3], v[72:75], a[168:175], v92
    v_and_b32 v50, 0x1f0, v95
    v_smfmac_f32_16x16x64_bf16 v[4:7], v[72:75], a[184:191], v92
    s_waitcnt lgkmcnt(0)
    s_barrier
    ds_read_b128 v[20:23], v50 offset:14592
    v_mov_b64 v[60:61], 0
    v_mov_b64 v[62:63], 0
    v_smfmac_f32_16x16x64_bf16 v[56:59], v[72:75], a[216:223], v92
    ds_read_b128 v[24:27], v50 offset:15104
    v_lshrrev_b32 v54, 2, v93
    v_smfmac_f32_16x16x64_bf16 v[60:63], v[72:75], a[232:239], v92
    ds_read_b128 v[28:31], v50 offset:15616
    v_rcp_f32 v34, v44
    v_rcp_f32 v35, v46
    s_nop 0
    s_waitcnt lgkmcnt(2)
    v_smfmac_f32_16x16x64_bf16 v[0:3], v[20:23], v[64:71], v92
    ds_read_b128 v[72:75], v94 offset:4096
    s_waitcnt lgkmcnt(2)
    v_max3_f32 v39, v44, v46, v34
    v_smfmac_f32_16x16x64_bf16 v[0:3], v[24:27], v[8:15], v92
    ds_read_b128 v[76:79], v94 offset:5120
    s_waitcnt lgkmcnt(2)
    v_max_f32 v39, v39, v35
    v_smfmac_f32_16x16x64_bf16 v[0:3], v[28:31], a[176:183], v92
    ds_read_b128 v[40:43], v94 offset:6144
    v_cmp_lt_f32 vcc, s64, v39
    v_smfmac_f32_16x16x64_bf16 v[4:7], v[20:23], a[192:199], v92
    ds_read_b128 v[44:47], v94 offset:7168
    v_smfmac_f32_16x16x64_bf16 v[4:7], v[24:27], a[200:207], v92
    s_cbranch_vccnz C_slow_s0
C_after_s0:
    v_mul_f32 v0, v0, v34
    v_mul_f32 v1, v1, v34
    v_mul_f32 v2, v2, v35
    v_mul_f32 v3, v3, v35
    v_cvt_pk_bf16_f32 v0, v0, v1
    v_cvt_pk_bf16_f32 v1, v2, v3
    v_smfmac_f32_16x16x64_bf16 v[4:7], v[28:31], a[208:215], v92
    global_store_dword v101, v0, s[16:17] sc1
    global_store_dword v101, v1, s[16:17] offset:2048 sc1
    s_waitcnt lgkmcnt(2)
    v_smfmac_f32_16x16x64_bf16 v[56:59], v[20:23], v[72:79], v92
    ds_read_b128 v[80:83], v94 offset:8192
    v_mov_b64 v[16:17], 0
    v_smfmac_f32_16x16x64_bf16 v[56:59], v[24:27], a[224:231], v92
    ds_read_b128 v[84:87], v94 offset:9216
    s_waitcnt lgkmcnt(2)
    v_mul_f32 v4, v4, v34
    v_mul_f32 v5, v5, v34
    v_mul_f32 v6, v6, v35
    v_mul_f32 v7, v7, v35
    v_cvt_pk_bf16_f32 v4, v4, v5
    v_cvt_pk_bf16_f32 v5, v6, v7
    v_smfmac_f32_16x16x64_bf16 v[56:59], v[28:31], v[40:47], v92
    global_store_dword v101, v4, s[18:19] sc1
    global_store_dword v101, v5, s[18:19] offset:2048 sc1
    v_smfmac_f32_16x16x64_bf16 v[60:63], v[20:23], a[240:247], v92
    v_mov_b64 v[18:19], 0
    v_smfmac_f32_16x16x64_bf16 v[60:63], v[24:27], a[248:255], v92
    s_waitcnt lgkmcnt(0)
    v_mul_f32 v56, v56, v34
    v_mul_f32 v57, v57, v34
    v_mul_f32 v58, v58, v35
    v_mul_f32 v59, v59, v35
    v_cvt_pk_bf16_f32 v56, v56, v57
    v_cvt_pk_bf16_f32 v57, v58, v59
    v_smfmac_f32_16x16x64_bf16 v[60:63], v[28:31], v[80:87], v92
    global_store_dword v101, v56, s[20:21] sc1
    global_store_dword v101, v57, s[20:21] offset:2048 sc1
    v_mov_b64 v[4:5], 0
    v_mov_b64 v[6:7], 0
    v_and_b32 v51, 0x80, v54
    v_lshl_add_u32 v51, v51, 23, v54
    v_mov_b32 v49, -1
    s_nop 0
    v_mul_f32 v60, v60, v34
    v_mul_f32 v61, v61, v34
    v_mul_f32 v62, v62, v35
    v_mul_f32 v63, v63, v35
    v_cvt_pk_bf16_f32 v60, v60, v61
    v_cvt_pk_bf16_f32 v61, v62, v63
    global_store_dword v101, v60, s[22:23] sc1
    global_store_dword v101, v61, s[22:23] offset:2048 sc1
    s_add_u32 s55, s55, 16384
    s_add_u32 s72, s51, s73
    s_add_u32 s52, s51, 0
    s_mov_b32 s26, s24
    s_waitcnt vmcnt(6)
C_ld1_s0:
    global_load_dword v8, v54, s[24:25] offset:0 sc1
    global_load_dword v9, v54, s[24:25] offset:256 sc1
    global_load_dword v10, v54, s[24:25] offset:512 sc1
    global_load_dword v11, v54, s[24:25] offset:768 sc1
    global_load_dword v12, v54, s[24:25] offset:1024 sc1
    global_load_dword v13, v54, s[24:25] offset:1280 sc1
    global_load_dword v14, v54, s[24:25] offset:1536 sc1
    global_load_dword v15, v54, s[24:25] offset:1792 sc1
C_red_s0:
    s_waitcnt vmcnt(0)
    v_smfmac_f32_16x16x64_bf16 v[16:19], v[88:91], v[8:15], v92 abid:1
    s_mov_b64 exec, s[28:29]
    s_nop 6
    buffer_store_dword v16, v103, s[4:7], s51 offen sc1
    s_mov_b64 exec, 0xffff
    v_cvt_pk_bf16_f32 v28, v16, v17
    buffer_store_dword v28, v103, s[4:7], s51 offen sc1
    v_cmp_u_f32 vcc, v16, v17
    s_mov_b64 exec, -1
    s_cbranch_vccnz C_retry0_s0
C_ok1_s0:
    s_add_u32 s60, s60, 1
    s_cmp_eq_u32 s60, 63
    s_cbranch_scc1 C_done
C_flagok_s0:
    v_mov_b32 v55, -1
    v_mov_b64 v[40:41], 0
    buffer_load_dword v49, v51, s[4:7], s72 offen sc1
    v_mov_b64 v[42:43], 0
    v_mov_b64 v[44:45], 0
    v_mov_b64 v[46:47], 0
    v_mov_b64 v[52:53], 0
    v_mov_b64 v[32:33], 0
    v_mov_b64 v[34:35], 0
    v_mov_b64 v[36:37], 0
    buffer_load_dword v49, v51, s[4:7], s72 offen sc1
    v_mov_b64 v[38:39], 0
    s_xor_b32 s16, s16, 0x80000
    s_xor_b32 s18, s18, 0x80000
    s_xor_b32 s20, s20, 0x80000
    s_xor_b32 s22, s22, 0x80000
    s_add_u32 s56, s56, 0x80000
    ds_read_b128 v[56:59], v94 offset:10240
    buffer_load_dword v49, v51, s[4:7], s72 offen sc1
    s_mov_b32 s67, s51
    s_add_u32 s51, s51, 16384
    ds_read_b128 v[60:63], v94 offset:11264
    s_bitset0_b32 s51, 16
    s_xor_b32 s54, s51, 32768
    ds_read_b128 v[64:67], v94 offset:12288
    s_xor_b32 s24, s24, 0x80000
    buffer_load_dword v49, v51, s[4:7], s72 offen sc1
    ds_read_b128 v[68:71], v94 offset:13312
    buffer_load_dword v49, v51, s[4:7], s72 offen sc1
C_tr_s0:
    s_waitcnt vmcnt(4)
    v_cmp_le_u32 vcc, s63, v49
    buffer_load_dword v49, v51, s[4:7], s72 offen sc1
    s_cbranch_vccz C_trok_s0
    s_waitcnt vmcnt(4)
    v_cmp_le_u32 vcc, s63, v49
    buffer_load_dword v49, v51, s[4:7], s72 offen sc1
    s_cbranch_vccz C_trok_s0
    s_waitcnt vmcnt(4)
    v_cmp_le_u32 vcc, s63, v49
    buffer_load_dword v49, v51, s[4:7], s72 offen sc1
    s_cbranch_vccz C_trok_s0
    s_waitcnt vmcnt(4)
    v_cmp_le_u32 vcc, s63, v49
    buffer_load_dword v49, v51, s[4:7], s72 offen sc1
    s_cbranch_vccz C_trok_s0
    s_waitcnt vmcnt(4)
    v_cmp_le_u32 vcc, s63, v49
    buffer_load_dword v49, v51, s[4:7], s72 offen sc1
    s_cbranch_vccz C_trok_s0
    s_waitcnt vmcnt(4)
    v_cmp_le_u32 vcc, s63, v49
    buffer_load_dword v49, v51, s[4:7], s72 offen sc1
    s_cbranch_vccz C_trok_s0
    s_sub_u32 s69, s69, 1
    s_cbranch_scc0 C_tr_s0
    s_branch C_fail
C_retry2_s0:
    v_max_u32 v37, v0, v1
    v_max3_u32 v37, v37, v2, v3
    v_max3_u32 v37, v37, v4, v5
    v_max3_u32 v37, v37, v6, v7
    v_max3_u32 v37, v37, v8, v9
    v_max3_u32 v37, v37, v10, v11
    v_max3_u32 v37, v37, v12, v13
    v_max3_u32 v37, v37, v14, v15
    v_max3_u32 v37, v37, v16, v17
    v_max3_u32 v37, v37, v18, v19
    v_max3_u32 v37, v37, v20, v21
    v_max3_u32 v37, v37, v22, v23
    v_max3_u32 v37, v37, v24, v25
    v_max3_u32 v37, v37, v26, v27
    v_max3_u32 v37, v37, v28, v29
    v_max3_u32 v37, v37, v30, v31
    v_cmp_le_u32 vcc, s61, v37
    s_cbranch_vccz C_ok2_s0
C_rr_s0:
    s_mov_b32 m0, 0
    s_add_u32 s65, s67, 0
    buffer_load_dwordx4 v93, s[4:7], s65 offen offset:0 sc1 lds
    buffer_load_dwordx4 v93, s[4:7], s65 offen offset:1024 sc1 lds
    buffer_load_dwordx4 v93, s[4:7], s65 offen offset:2048 sc1 lds
    buffer_load_dwordx4 v93, s[4:7], s65 offen offset:3072 sc1 lds
    s_mov_b32 m0, 4096
    s_add_u32 s65, s67, 4096
    buffer_load_dwordx4 v93, s[4:7], s65 offen offset:0 sc1 lds
    buffer_load_dwordx4 v93, s[4:7], s65 offen offset:1024 sc1 lds
    buffer_load_dwordx4 v93, s[4:7], s65 offen offset:2048 sc1 lds
    buffer_load_dwordx4 v93, s[4:7], s65 offen offset:3072 sc1 lds
    s_sub_u32 s69, s69, 1
    s_cbranch_scc1 C_fail
    s_waitcnt vmcnt(0) lgkmcnt(0)
    ds_read_b128 v[0:3], v93 offset:0
    ds_read_b128 v[4:7], v93 offset:1024
    ds_read_b128 v[8:11], v93 offset:2048
    ds_read_b128 v[12:15], v93 offset:3072
    ds_read_b128 v[16:19], v93 offset:4096
    ds_read_b128 v[20:23], v93 offset:5120
    ds_read_b128 v[24:27], v93 offset:6144
    ds_read_b128 v[28:31], v93 offset:7168
    s_waitcnt lgkmcnt(0)
    v_max_u32 v37, v0, v1
    v_max3_u32 v37, v37, v2, v3
    v_max3_u32 v37, v37, v4, v5
    v_max3_u32 v37, v37, v6, v7
    v_max3_u32 v37, v37, v8, v9
    v_max3_u32 v37, v37, v10, v11
    v_max3_u32 v37, v37, v12, v13
    v_max3_u32 v37, v37, v14, v15
    v_max3_u32 v37, v37, v16, v17
    v_max3_u32 v37, v37, v18, v19
    v_max3_u32 v37, v37, v20, v21
    v_max3_u32 v37, v37, v22, v23
    v_max3_u32 v37, v37, v24, v25
    v_max3_u32 v37, v37, v26, v27
    v_max3_u32 v37, v37, v28, v29
    v_max3_u32 v37, v37, v30, v31
    v_cmp_le_u32 vcc, s61, v37
    s_cbranch_vccz C_rg_s0
    s_branch C_rr_s0
C_rg_s0:
    v_mov_b64 v[32:33], 0
    v_mov_b64 v[34:35], 0
    v_mov_b64 v[36:37], 0
    v_mov_b64 v[38:39], 0
    v_mov_b64 v[40:41], 0
    v_mov_b64 v[42:43], 0
    v_mov_b64 v[44:45], 0
    v_mov_b64 v[46:47], 0
    s_mov_b32 m0, 0
    ds_read_b128 v[56:59], v94 offset:10240
    ds_read_b128 v[60:63], v94 offset:11264
    s_waitcnt lgkmcnt(0)
    v_smfmac_f32_16x16x64_bf16 v[32:35], v[0:3], v[56:63], v92
    ds_read_b128 v[64:67], v94 offset:12288
    ds_read_b128 v[68:71], v94 offset:13312
    s_waitcnt lgkmcnt(0)
    v_smfmac_f32_16x16x64_bf16 v[36:39], v[0:3], v[64:71], v92
    v_smfmac_f32_16x16x64_bf16 v[32:35], v[4:7], v[120:127], v92
    v_smfmac_f32_16x16x64_bf16 v[36:39], v[4:7], v[128:135], v92
    v_smfmac_f32_16x16x64_bf16 v[40:43], v[0:3], v[216:223], v92
    v_smfmac_f32_16x16x64_bf16 v[40:43], v[4:7], v[232:239], v92
    v_smfmac_f32_16x16x64_bf16 v[44:47], v[0:3], v[224:231], v92
    v_smfmac_f32_16x16x64_bf16 v[44:47], v[4:7], v[240:247], v92
    v_smfmac_f32_16x16x64_bf16 v[32:35], v[8:11], v[136:143], v92
    v_smfmac_f32_16x16x64_bf16 v[32:35], v[12:15], v[152:159], v92
    v_smfmac_f32_16x16x64_bf16 v[36:39], v[8:11], v[144:151], v92
    v_smfmac_f32_16x16x64_bf16 v[36:39], v[12:15], v[160:167], v92
    ds_read_b128 v[56:59], v94 offset:14336
    ds_read_b128 v[60:63], v94 offset:15360
    s_waitcnt lgkmcnt(0)
    v_smfmac_f32_16x16x64_bf16 v[32:35], v[16:19], v[56:63], v92
    v_smfmac_f32_16x16x64_bf16 v[32:35], v[20:23], v[168:175], v92
    ds_read_b128 v[64:67], v94 offset:16384
    ds_read_b128 v[68:71], v94 offset:17408
    s_waitcnt lgkmcnt(0)
    s_branch C_go2_s0
C_retry0_s0:
    global_load_dword v20, v54, s[24:25] offset:0 sc1
    global_load_dword v21, v54, s[24:25] offset:256 sc1
    global_load_dword v22, v54, s[24:25] offset:512 sc1
    global_load_dword v23, v54, s[24:25] offset:768 sc1
    global_load_dword v24, v54, s[24:25] offset:1024 sc1
    global_load_dword v25, v54, s[24:25] offset:1280 sc1
    global_load_dword v26, v54, s[24:25] offset:1536 sc1
    global_load_dword v27, v54, s[24:25] offset:1792 sc1
    s_waitcnt vmcnt(0)
C_retry1_s0:
    s_waitcnt vmcnt(1)
C_r1b_s0:
    v_smfmac_f32_16x16x64_bf16 v[4:7], v[88:91], v[20:27], v92 abid:1
    global_load_dword v8, v54, s[24:25] offset:0 sc1
    global_load_dword v9, v54, s[24:25] offset:256 sc1
    global_load_dword v10, v54, s[24:25] offset:512 sc1
    global_load_dword v11, v54, s[24:25] offset:768 sc1
    global_load_dword v12, v54, s[24:25] offset:1024 sc1
    global_load_dword v13, v54, s[24:25] offset:1280 sc1
    global_load_dword v14, v54, s[24:25] offset:1536 sc1
    global_load_dword v15, v54, s[24:25] offset:1792 sc1
    v_mov_b64 v[16:17], 0
    v_mov_b64 v[18:19], 0
    v_cvt_pk_bf16_f32 v28, v4, v5
    buffer_store_dword v28, v103, s[4:7], s51 offen sc1
    v_cmp_u_f32 vcc, v4, v5
    s_cbranch_vccz C_ok1_s0
    v_max3_u32 v6, v20, v21, v22
    v_max3_u32 v7, v23, v24, v25
    v_max3_u32 v6, v6, v26, v27
    v_max_u32 v6, v6, v7
    v_cmp_eq_u32 vcc, -1, v6
    global_load_dword v20, v54, s[24:25] offset:0 sc1
    global_load_dword v21, v54, s[24:25] offset:256 sc1
    global_load_dword v22, v54, s[24:25] offset:512 sc1
    global_load_dword v23, v54, s[24:25] offset:768 sc1
    global_load_dword v24, v54, s[24:25] offset:1024 sc1
    global_load_dword v25, v54, s[24:25] offset:1280 sc1
    global_load_dword v26, v54, s[24:25] offset:1536 sc1
    global_load_dword v27, v54, s[24:25] offset:1792 sc1
    s_cbranch_vccz C_nan1_s0
    v_mov_b64 v[4:5], 0
    v_mov_b64 v[6:7], 0
    s_sub_u32 s69, s69, 1
    s_cbranch_scc1 C_fail
    s_waitcnt vmcnt(9)
    v_smfmac_f32_16x16x64_bf16 v[16:19], v[88:91], v[8:15], v92 abid:1
    s_nop 7
    v_cvt_pk_bf16_f32 v28, v16, v17
    buffer_store_dword v28, v103, s[4:7], s51 offen sc1
    v_cmp_u_f32 vcc, v16, v17
    s_cbranch_vccz C_ok1_s0
    s_branch C_retry1_s0
C_nan1_s0:
    v_cmp_le_u32 vcc, s63, v28
    v_and_b32 v6, 0x7fffffff, v28
    s_nop 0
    v_cndmask_b32 v28, v28, v6, vcc
    buffer_store_dword v28, v103, s[4:7], s51 offen sc1
    s_waitcnt vmcnt(0)
    s_branch C_ok1_s0
C_flag_s0:
    buffer_load_dword v102, off, s[4:7], s58 sc1
    s_sub_u32 s69, s69, 1
    s_cbranch_scc1 C_fail
    s_waitcnt vmcnt(0)
    v_readfirstlane_b32 s70, v102
    s_nop 3
    s_cmp_le_u32 s70, s59
    s_cbranch_scc1 C_flag_s0
    s_branch C_flagok_s0
C_slow_s0:
    s_waitcnt lgkmcnt(0)
    s_nop 7
    v_max3_f32 v77, v32, v33, v36
    v_max_f32 v77, v77, v37
    v_bfe_u32 v76, v93, 4, 4
    v_lshlrev_b32 v76, 6, v76
    v_lshrrev_b32 v78, 8, v93
    v_lshl_add_u32 v78, v78, 2, v76
    ds_write_b32 v78, v77 offset:8192
    s_waitcnt lgkmcnt(0)
    s_barrier
    ds_read_b128 v[20:23], v76 offset:8192
    ds_read_b128 v[24:27], v76 offset:8208
    ds_read_b128 v[28:31], v76 offset:8224
    ds_read_b128 v[72:75], v76 offset:8240
    s_waitcnt lgkmcnt(3)
    v_max3_f32 v77, v77, v20, v21
    v_max3_f32 v77, v77, v22, v23
    s_waitcnt lgkmcnt(2)
    v_max3_f32 v77, v77, v24, v25
    v_max3_f32 v77, v77, v26, v27
    s_waitcnt lgkmcnt(1)
    v_max3_f32 v77, v77, v28, v29
    v_max3_f32 v77, v77, v30, v31
    s_waitcnt lgkmcnt(0)
    v_max3_f32 v77, v77, v72, v73
    v_max3_f32 v77, v77, v74, v75
    v_sub_f32 v34, v32, v77
    v_sub_f32 v35, v33, v77
    v_sub_f32 v38, v36, v77
    v_sub_f32 v39, v37, v77
    v_exp_f32 v34, v34
    v_exp_f32 v35, v35
    v_exp_f32 v38, v38
    v_exp_f32 v39, v39
    v_cvt_pk_bf16_f32 v34, v34, v35
    v_cvt_pk_bf16_f32 v16, v38, v39
    v_cvt_pk_bf16_f32 v17, v38, v39
    v_cvt_pk_bf16_f32 v18, v38, v39
    ds_write_b32 v100, v34
    s_waitcnt lgkmcnt(0)
    s_barrier
    ds_read_b128 v[40:43], v93 offset:13056
    v_mov_b64 v[0:1], 0
    v_mov_b64 v[2:3], 0
    v_mov_b64 v[4:5], 0
    v_mov_b64 v[6:7], 0
    v_mov_b64 v[56:57], 0
    v_mov_b64 v[58:59], 0
    v_mov_b64 v[60:61], 0
    v_mov_b64 v[62:63], 0
    s_waitcnt lgkmcnt(0)
    v_mfma_f32_16x16x32_bf16 v[44:47], v[40:43], v[88:91], 0
    v_mfma_f32_16x16x32_bf16 v[72:75], v[80:83], v[40:43], 0
    v_mfma_f32_16x16x32_bf16 v[76:79], v[84:87], v[40:43], 0
    v_mfma_f32_16x16x16_bf16 v[44:47], v[18:19], v[88:89], v[44:47]
    v_mfma_f32_16x16x16_bf16 v[72:75], v[48:49], v[16:17], v[72:75]
    v_mfma_f32_16x16x16_bf16 v[76:79], v[52:53], v[16:17], v[76:79]
    s_nop 7
    v_cvt_pk_bf16_f32 v20, v72, v73
    v_cvt_pk_bf16_f32 v21, v74, v75
    s_mov_b64 exec, s[30:31]
    v_cvt_pk_bf16_f32 v20, v76, v77
    v_cvt_pk_bf16_f32 v21, v78, v79
    s_mov_b64 exec, -1
    ds_write_b64 v95, v[20:21] offset:14080
    v_cvt_pk_bf16_f32 v72, v72, v73
    v_cvt_pk_bf16_f32 v73, v74, v75
    v_cvt_pk_bf16_f32 v74, v76, v77
    v_cvt_pk_bf16_f32 v75, v78, v79
    s_nop 1
    v_smfmac_f32_16x16x64_bf16 v[0:3], v[72:75], a[168:175], v92
    v_and_b32 v50, 0x1f0, v95
    v_smfmac_f32_16x16x64_bf16 v[4:7], v[72:75], a[184:191], v92
    s_waitcnt lgkmcnt(0)
    s_barrier
    ds_read_b128 v[20:23], v50 offset:14592
    v_mov_b64 v[60:61], 0
    v_mov_b64 v[62:63], 0
    v_smfmac_f32_16x16x64_bf16 v[56:59], v[72:75], a[216:223], v92
    ds_read_b128 v[24:27], v50 offset:15104
    v_lshrrev_b32 v54, 2, v93
    v_smfmac_f32_16x16x64_bf16 v[60:63], v[72:75], a[232:239], v92
    ds_read_b128 v[28:31], v50 offset:15616
    v_rcp_f32 v34, v44
    v_rcp_f32 v35, v46
    s_nop 0
    s_waitcnt lgkmcnt(2)
    v_smfmac_f32_16x16x64_bf16 v[0:3], v[20:23], v[64:71], v92
    ds_read_b128 v[72:75], v94 offset:4096
    v_max3_f32 v39, v44, v46, v34
    s_waitcnt lgkmcnt(2)
    v_smfmac_f32_16x16x64_bf16 v[0:3], v[24:27], v[8:15], v92
    ds_read_b128 v[76:79], v94 offset:5120
    v_max_f32 v39, v39, v35
    s_waitcnt lgkmcnt(2)
    v_smfmac_f32_16x16x64_bf16 v[0:3], v[28:31], a[176:183], v92
    ds_read_b128 v[40:43], v94 offset:6144
    v_cmp_lt_f32 vcc, s64, v39
    v_smfmac_f32_16x16x64_bf16 v[4:7], v[20:23], a[192:199], v92
    ds_read_b128 v[44:47], v94 offset:7168
    v_smfmac_f32_16x16x64_bf16 v[4:7], v[24:27], a[200:207], v92
    s_waitcnt lgkmcnt(0)
    s_branch C_after_s0
.p2align 6
C_base_s1:
    s_nop 0
    s_nop 0
    s_nop 0
C_trok_s1:
    buffer_load_dwordx4 v93, s[4:7], s52 offen offset:0 sc1 lds
    buffer_load_dwordx4 v93, s[4:7], s52 offen offset:1024 sc1 lds
    v_mov_b64 v[82:83], v[114:115]
    v_mov_b64 v[84:85], v[116:117]
    v_mov_b64 v[86:87], v[118:119]
C_poll2_s1:
    s_barrier
    ds_read_b128 v[0:3], v93 offset:0
    ds_read_b128 v[4:7], v93 offset:1024
    global_store_dword v54, v55, s[26:27] offset:0 sc1
    global_store_dword v54, v55, s[26:27] offset:256 sc1
    global_store_dword v54, v55, s[26:27] offset:512 sc1
C_go1_s1:
    s_waitcnt lgkmcnt(1)
    v_smfmac_f32_16x16x64_bf16 v[32:35], v[0:3], v[56:63], v92
    buffer_load_dword v102, off, s[4:7], s58 sc1
    s_waitcnt lgkmcnt(0)
    v_smfmac_f32_16x16x64_bf16 v[32:35], v[4:7], v[120:127], v92
    s_waitcnt vmcnt(4)
    s_barrier
    buffer_load_dwordx4 v[104:107], v93, s[4:7], s56 offen offset:0 sc1
    v_smfmac_f32_16x16x64_bf16 v[36:39], v[0:3], v[64:71], v92
    v_smfmac_f32_16x16x64_bf16 v[40:43], v[0:3], v[216:223], v92
    ds_read_b128 v[8:11], v93 offset:2048
    v_smfmac_f32_16x16x64_bf16 v[36:39], v[4:7], v[128:135], v92
    ds_read_b128 v[12:15], v93 offset:3072
    v_smfmac_f32_16x16x64_bf16 v[40:43], v[4:7], v[232:239], v92
    ds_read_b128 v[56:59], v94 offset:14336
    buffer_load_dwordx4 v[108:111], v93, s[4:7], s56 offen offset:1024 sc1
    v_smfmac_f32_16x16x64_bf16 v[44:47], v[0:3], v[224:231], v92
    ds_read_b128 v[60:63], v94 offset:15360
    v_smfmac_f32_16x16x64_bf16 v[44:47], v[4:7], v[240:247], v92
    s_barrier
    ds_read_b128 v[16:19], v93 offset:4096
    s_waitcnt lgkmcnt(4)
    v_smfmac_f32_16x16x64_bf16 v[32:35], v[8:11], v[136:143], v92
    ds_read_b128 v[20:23], v93 offset:5120
    s_waitcnt lgkmcnt(4)
    v_smfmac_f32_16x16x64_bf16 v[32:35], v[12:15], v[152:159], v92
    ds_read_b128 v[64:67], v94 offset:16384
    buffer_load_dwordx4 v[112:115], v93, s[4:7], s56 offen offset:2048 sc1
    v_smfmac_f32_16x16x64_bf16 v[36:39], v[8:11], v[144:151], v92
    ds_read_b128 v[68:71], v94 offset:17408
    v_smfmac_f32_16x16x64_bf16 v[36:39], v[12:15], v[160:167], v92
    s_barrier
    s_waitcnt lgkmcnt(3)
    v_smfmac_f32_16x16x64_bf16 v[32:35], v[16:19], v[56:63], v92
    ds_read_b128 v[24:27], v93 offset:6144
    s_waitcnt lgkmcnt(3)
    v_smfmac_f32_16x16x64_bf16 v[32:35], v[20:23], v[168:175], v92
    ds_read_b128 v[28:31], v93 offset:7168
    buffer_load_dwordx4 v[116:119], v93, s[4:7], s56 offen offset:3072 sc1
C_go2_s1:
    v_smfmac_f32_16x16x64_bf16 v[36:39], v[20:23], v[176:183], v92
    ds_read_b128 v[56:59], v94 offset:22528
    s_waitcnt lgkmcnt(3)
    v_smfmac_f32_16x16x64_bf16 v[36:39], v[16:19], v[64:71], v92
    ds_read_b128 v[60:63], v94 offset:23552
    s_waitcnt lgkmcnt(3)
    v_smfmac_f32_16x16x64_bf16 v[32:35], v[24:27], v[184:191], v92
    ds_read_b128 v[64:67], v94 offset:24576
    global_store_dword v54, v55, s[26:27] offset:768 sc1
    s_waitcnt lgkmcnt(3)
    v_smfmac_f32_16x16x64_bf16 v[32:35], v[28:31], v[200:207], v92
    ds_read_b128 v[68:71], v94 offset:25600
    v_mov_b64 v[48:49], 0
    v_smfmac_f32_16x16x64_bf16 v[36:39], v[24:27], v[192:199], v92
    global_store_dword v54, v55, s[26:27] offset:1024 sc1
    v_mov_b64 v[50:51], 0
    v_smfmac_f32_16x16x64_bf16 v[36:39], v[28:31], v[208:215], v92
    global_store_dword v54, v55, s[26:27] offset:1280 sc1
    s_waitcnt lgkmcnt(2)
    v_mul_f32 v33, s62, v33
    v_mul_f32 v35, s62, v35
    v_smfmac_f32_16x16x64_bf16 v[40:43], v[16:19], v[56:63], v92
    global_store_dword v54, v55, s[26:27] offset:1536 sc1
    v_fma_f32 v32, v32, s62, v33
    v_fma_f32 v34, v34, s62, v35
    v_smfmac_f32_16x16x64_bf16 v[40:43], v[8:11], v[248:255], v92
    ds_read_b128 v[56:59], v94 offset:26624
    v_mul_f32 v37, s62, v37
    v_mul_f32 v39, s62, v39
    v_smfmac_f32_16x16x64_bf16 v[40:43], v[12:15], a[8:15], v92
    ds_read_b128 v[60:63], v94 offset:27648
    v_fma_f32 v36, v36, s62, v37
    v_fma_f32 v38, v38, s62, v39
    v_smfmac_f32_16x16x64_bf16 v[40:43], v[24:27], a[24:31], v92
    global_store_dword v54, v55, s[26:27] offset:1792 sc1
    s_waitcnt lgkmcnt(2)
    v_cvt_pk_bf16_f32 v32, v32, v36
    v_cvt_pk_bf16_f32 v33, v34, v38
    v_smfmac_f32_16x16x64_bf16 v[44:47], v[16:19], v[64:71], v92
    ds_write2_b32 v96, v32, v33 offset0:0 offset1:72
    v_smfmac_f32_16x16x64_bf16 v[40:43], v[28:31], a[40:47], v92
    ds_read_b128 v[64:67], v94 offset:28672
    v_cmp_u_f32 vcc, v36, v38
    v_smfmac_f32_16x16x64_bf16 v[44:47], v[8:11], a[0:7], v92
    ds_read_b128 v[68:71], v94 offset:29696
    s_waitcnt lgkmcnt(3)
    v_mov_b64 v[32:33], 0
    v_smfmac_f32_16x16x64_bf16 v[40:43], v[20:23], v[56:63], v92
    buffer_store_dword v55, v103, s[4:7], s54 offen sc1
    v_smfmac_f32_16x16x64_bf16 v[44:47], v[12:15], a[16:23], v92
    s_cbranch_vccnz C_retry2_s1
C_ok2_s1:
    v_mov_b64 v[34:35], 0
    v_mov_b64 v[54:55], 0
    v_smfmac_f32_16x16x64_bf16 v[44:47], v[24:27], a[32:39], v92
    s_waitcnt lgkmcnt(2)
    s_barrier
    ds_read_b128 v[56:59], v98 offset:0
    v_smfmac_f32_16x16x64_bf16 v[44:47], v[28:31], a[48:55], v92
    ds_read_b128 v[60:63], v98 offset:64
    s_waitcnt lgkmcnt(2)
    v_add_f32 v40, v40, v41
    v_smfmac_f32_16x16x64_bf16 v[44:47], v[20:23], v[64:71], v92
    ds_read_b128 v[64:67], v98 offset:128
    v_add_f32 v42, v42, v43
    v_smfmac_f32_16x16x64_bf16 v[48:51], v[0:3], a[56:63], v92
    ds_read_b128 v[68:71], v98 offset:192
    v_smfmac_f32_16x16x64_bf16 v[48:51], v[4:7], a[72:79], v92
    v_add_f32 v44, v44, v45
    v_add_f32 v46, v46, v47
    v_smfmac_f32_16x16x64_bf16 v[52:55], v[0:3], a[64:71], v92
    s_waitcnt lgkmcnt(2)
    v_cvt_pk_bf16_f32 v40, v40, v44
    v_cvt_pk_bf16_f32 v41, v42, v46
    v_smfmac_f32_16x16x64_bf16 v[32:35], v[72:75], v[56:63], v92
    ds_write2_b32 v97, v40, v41 offset0:0 offset1:80
    s_waitcnt lgkmcnt(1)
    v_smfmac_f32_16x16x64_bf16 v[32:35], v[76:79], v[64:71], v92
    ds_read_b128 v[0:3], v94 offset:18432
    v_mov_b64 v[36:37], 0
    v_smfmac_f32_16x16x64_bf16 v[52:55], v[4:7], a[80:87], v92
    ds_read_b128 v[4:7], v94 offset:19456
    v_mov_b64 v[38:39], 0
    v_smfmac_f32_16x16x64_bf16 v[48:51], v[8:11], a[88:95], v92
    v_add_f32 v32, v32, v33
    v_add_f32 v33, v34, v35
    v_smfmac_f32_16x16x64_bf16 v[48:51], v[12:15], a[104:111], v92
    s_waitcnt lgkmcnt(2)
    s_barrier
    v_exp_f32 v34, v32
    v_smfmac_f32_16x16x64_bf16 v[48:51], v[16:19], a[120:127], v92
    ds_read_b128 v[72:75], v99
    s_waitcnt lgkmcnt(1)
    v_smfmac_f32_16x16x64_bf16 v[48:51], v[28:31], v[0:7], v92
    ds_read_b128 v[76:79], v99 offset:128
    v_exp_f32 v35, v33
    v_smfmac_f32_16x16x64_bf16 v[48:51], v[20:23], a[136:143], v92
    v_cvt_pk_bf16_f32 v34, v34, v35
    v_smfmac_f32_16x16x64_bf16 v[48:51], v[24:27], a[152:159], v92
    ds_write_b32 v100, v34
    s_waitcnt lgkmcnt(2)
    v_smfmac_f32_16x16x64_bf16 v[36:39], v[72:75], v[56:63], v92
    s_waitcnt lgkmcnt(1)
    v_mov_b64 v[0:1], 0
    v_smfmac_f32_16x16x64_bf16 v[36:39], v[76:79], v[64:71], v92
    ds_read_b128 v[56:59], v94 offset:20480
    v_cvt_pk_bf16_f32 v48, v48, v50
    v_smfmac_f32_16x16x64_bf16 v[52:55], v[8:11], a[96:103], v92
    ds_read_b128 v[60:63], v94 offset:21504
    v_cvt_pk_bf16_f32 v49, v49, v51
    v_smfmac_f32_16x16x64_bf16 v[52:55], v[12:15], a[112:119], v92
    s_waitcnt lgkmcnt(2)
    s_barrier
    ds_read_b128 v[40:43], v93 offset:13056
    v_add_f32 v36, v36, v37
    v_smfmac_f32_16x16x64_bf16 v[52:55], v[16:19], a[128:135], v92
    ds_read_b128 v[64:67], v94 offset:0
    ds_read_b128 v[68:71], v94 offset:1024
    v_add_f32 v37, v38, v39
    v_smfmac_f32_16x16x64_bf16 v[52:55], v[20:23], a[144:151], v92
    s_waitcnt lgkmcnt(3)
    v_exp_f32 v38, v36
    v_smfmac_f32_16x16x64_bf16 v[52:55], v[28:31], v[56:63], v92
    ds_read_b128 v[8:11], v94 offset:2048
    v_exp_f32 v39, v37
    v_smfmac_f32_16x16x64_bf16 v[52:55], v[24:27], a[160:167], v92
    ds_read_b128 v[12:15], v94 offset:3072
    s_waitcnt lgkmcnt(4)
    v_mfma_f32_16x16x32_bf16 v[72:75], v[80:83], v[40:43], 0
    v_cvt_pk_bf16_f32 v17, v38, v39
    v_mov_b64 v[2:3], 0
    v_mfma_f32_16x16x32_bf16 v[76:79], v[84:87], v[40:43], 0
    v_cvt_pk_bf16_f32 v16, v38, v39
    v_cvt_pk_bf16_f32 v52, v52, v54
    v_cvt_pk_bf16_f32 v53, v53, v55
    v_mfma_f32_16x16x16_bf16 v[72:75], v[48:49], v[16:17], v[72:75]
    v_cvt_pk_bf16_f32 v18, v38, v39
    v_mov_b32 v19, 0
    v_mfma_f32_16x16x16_bf16 v[76:79], v[52:53], v[16:17], v[76:79]
    v_mov_b64 v[4:5], 0
    v_mov_b64 v[6:7], 0
    v_mfma_f32_16x16x32_bf16 v[44:47], v[40:43], v[88:91], 0
    v_cvt_pk_bf16_f32 v20, v72, v73
    v_cvt_pk_bf16_f32 v21, v74, v75
    s_mov_b64 exec, s[30:31]
    v_cvt_pk_bf16_f32 v20, v76, v77
    v_cvt_pk_bf16_f32 v21, v78, v79
    s_mov_b64 exec, -1
    ds_write_b64 v95, v[20:21] offset:14592
    v_mfma_f32_16x16x16_bf16 v[44:47], v[18:19], v[88:89], v[44:47]
    v_cvt_pk_bf16_f32 v72, v72, v73
    v_cvt_pk_bf16_f32 v73, v74, v75
    v_cvt_pk_bf16_f32 v74, v76, v77
    v_cvt_pk_bf16_f32 v75, v78, v79
    v_mov_b64 v[56:57], 0
    v_mov_b64 v[58:59], 0
    v_smfmac_f32_16x16x64_bf16 v[0:3], v[72:75], a[168:175], v92
    v_and_b32 v50, 0x1f0, v95
    v_smfmac_f32_16x16x64_bf16 v[4:7], v[72:75], a[184:191], v92
    s_waitcnt lgkmcnt(0)
    s_barrier
    ds_read_b128 v[20:23], v50 offset:14080
    v_mov_b64 v[60:61], 0
    v_mov_b64 v[62:63], 0
    v_smfmac_f32_16x16x64_bf16 v[56:59], v[72:75], a[216:223], v92
    ds_read_b128 v[24:27], v50 offset:15616
    v_lshrrev_b32 v54, 2, v93
    v_smfmac_f32_16x16x64_bf16 v[60:63], v[72:75], a[232:239], v92
    ds_read_b128 v[28:31], v50 offset:15104
    v_rcp_f32 v34, v44
    v_rcp_f32 v35, v46
    s_nop 0
    s_waitcnt lgkmcnt(2)
    v_smfmac_f32_16x16x64_bf16 v[0:3], v[20:23], v[64:71], v92
    ds_read_b128 v[72:75], v94 offset:4096
    s_waitcnt lgkmcnt(2)
    v_max3_f32 v39, v44, v46, v34
    v_smfmac_f32_16x16x64_bf16 v[0:3], v[24:27], v[8:15], v92
    ds_read_b128 v[76:79], v94 offset:5120
    s_waitcnt lgkmcnt(2)
    v_max_f32 v39, v39, v35
    v_smfmac_f32_16x16x64_bf16 v[0:3], v[28:31], a[176:183], v92
    ds_read_b128 v[40:43], v94 offset:6144
    v_cmp_lt_f32 vcc, s64, v39
    v_smfmac_f32_16x16x64_bf16 v[4:7], v[20:23], a[192:199], v92
    ds_read_b128 v[44:47], v94 offset:7168
    v_smfmac_f32_16x16x64_bf16 v[4:7], v[24:27], a[200:207], v92
    s_cbranch_vccnz C_slow_s1
C_after_s1:
    v_mul_f32 v0, v0, v34
    v_mul_f32 v1, v1, v34
    v_mul_f32 v2, v2, v35
    v_mul_f32 v3, v3, v35
    v_cvt_pk_bf16_f32 v0, v0, v1
    v_cvt_pk_bf16_f32 v1, v2, v3
    v_smfmac_f32_16x16x64_bf16 v[4:7], v[28:31], a[208:215], v92
    global_store_dword v101, v0, s[16:17] sc1
    global_store_dword v101, v1, s[16:17] offset:2048 sc1
    s_waitcnt lgkmcnt(2)
    v_smfmac_f32_16x16x64_bf16 v[56:59], v[20:23], v[72:79], v92
    ds_read_b128 v[80:83], v94 offset:8192
    v_mov_b64 v[16:17], 0
    v_smfmac_f32_16x16x64_bf16 v[56:59], v[24:27], a[224:231], v92
    ds_read_b128 v[84:87], v94 offset:9216
    s_waitcnt lgkmcnt(2)
    v_mul_f32 v4, v4, v34
    v_mul_f32 v5, v5, v34
    v_mul_f32 v6, v6, v35
    v_mul_f32 v7, v7, v35
    v_cvt_pk_bf16_f32 v4, v4, v5
    v_cvt_pk_bf16_f32 v5, v6, v7
    v_smfmac_f32_16x16x64_bf16 v[56:59], v[28:31], v[40:47], v92
    global_store_dword v101, v4, s[18:19] sc1
    global_store_dword v101, v5, s[18:19] offset:2048 sc1
    v_smfmac_f32_16x16x64_bf16 v[60:63], v[20:23], a[240:247], v92
    v_mov_b64 v[18:19], 0
    v_smfmac_f32_16x16x64_bf16 v[60:63], v[24:27], a[248:255], v92
    s_waitcnt lgkmcnt(0)
    v_mul_f32 v56, v56, v34
    v_mul_f32 v57, v57, v34
    v_mul_f32 v58, v58, v35
    v_mul_f32 v59, v59, v35
    v_cvt_pk_bf16_f32 v56, v56, v57
    v_cvt_pk_bf16_f32 v57, v58, v59
    v_smfmac_f32_16x16x64_bf16 v[60:63], v[28:31], v[80:87], v92
    global_store_dword v101, v56, s[20:21] sc1
    global_store_dword v101, v57, s[20:21] offset:2048 sc1
    v_mov_b64 v[4:5], 0
    v_mov_b64 v[6:7], 0
    v_and_b32 v51, 0x80, v54
    v_lshl_add_u32 v51, v51, 23, v54
    v_mov_b32 v49, -1
    s_nop 0
    v_mul_f32 v60, v60, v34
    v_mul_f32 v61, v61, v34
    v_mul_f32 v62, v62, v35
    v_mul_f32 v63, v63, v35
    v_cvt_pk_bf16_f32 v60, v60, v61
    v_cvt_pk_bf16_f32 v61, v62, v63
    global_store_dword v101, v60, s[22:23] sc1
    global_store_dword v101, v61, s[22:23] offset:2048 sc1
    s_add_u32 s55, s55, 16384
    s_add_u32 s72, s51, s73
    s_add_u32 s52, s51, 2048
    s_mov_b32 s26, s24
    s_waitcnt vmcnt(4)
    v_mov_b32 v55, -1
    v_mov_b64 v[40:41], 0
    v_mov_b64 v[42:43], 0
    v_mov_b64 v[44:45], 0
    v_mov_b64 v[46:47], 0
C_ld1_s1:
    global_load_dword v8, v54, s[24:25] offset:0 sc1
    global_load_dword v9, v54, s[24:25] offset:256 sc1
    global_load_dword v10, v54, s[24:25] offset:512 sc1
    global_load_dword v11, v54, s[24:25] offset:768 sc1
    global_load_dword v12, v54, s[24:25] offset:1024 sc1
    global_load_dword v13, v54, s[24:25] offset:1280 sc1
    global_load_dword v14, v54, s[24:25] offset:1536 sc1
    global_load_dword v15, v54, s[24:25] offset:1792 sc1
C_red_s1:
    s_waitcnt vmcnt(0)
    v_smfmac_f32_16x16x64_bf16 v[16:19], v[88:91], v[8:15], v92 abid:1
    v_readfirstlane_b32 s70, v102
    s_mov_b64 exec, s[28:29]
    s_nop 3
    buffer_store_dword v16, v103, s[4:7], s51 offen sc1
    s_mov_b64 exec, 0xffff
    v_cvt_pk_bf16_f32 v28, v16, v17
    buffer_store_dword v28, v103, s[4:7], s51 offen sc1
    v_cmp_u_f32 vcc, v16, v17
    s_mov_b64 exec, -1
    s_cbranch_vccnz C_retry0_s1
C_ok1_s1:
    s_add_u32 s60, s60, 1
    s_cmp_eq_u32 s60, 63
    s_cbranch_scc1 C_done
    s_cmp_le_u32 s70, s59
    s_cbranch_scc1 C_flag_s1
C_flagok_s1:
    v_mov_b64 v[52:53], 0
    v_mov_b64 v[32:33], 0
    buffer_load_dword v49, v51, s[4:7], s72 offen sc1
    v_mov_b64 v[34:35], 0
    v_mov_b64 v[36:37], 0
    v_mov_b64 v[38:39], 0
    s_xor_b32 s16, s16, 0x80000
    s_xor_b32 s18, s18, 0x80000
    s_xor_b32 s20, s20, 0x80000
    s_xor_b32 s22, s22, 0x80000
    buffer_load_dword v49, v51, s[4:7], s72 offen sc1
    s_add_u32 s56, s56, 0x80000
    ds_read_b128 v[56:59], v94 offset:10240
    s_mov_b32 s67, s51
    s_add_u32 s51, s51, 16384
    ds_read_b128 v[60:63], v94 offset:11264
    s_bitset0_b32 s51, 16
    s_xor_b32 s54, s51, 32768
    buffer_load_dword v49, v51, s[4:7], s72 offen sc1
    ds_read_b128 v[64:67], v94 offset:12288
    s_xor_b32 s24, s24, 0x80000
    s_add_u32 s65, s60, 2
    ds_read_b128 v[68:71], v94 offset:13312
    s_lshr_b32 s59, s65, 2
    s_and_b32 s65, s65, 3
    s_lshl_b32 s65, s65, 2
    buffer_load_dword v49, v51, s[4:7], s72 offen sc1
    s_andn2_b32 s58, s58, 15
    s_or_b32 s58, s58, s65
    v_mov_b64 v[72:73], v[104:105]
    v_mov_b64 v[74:75], v[106:107]
    v_mov_b64 v[76:77], v[108:109]
    v_mov_b64 v[78:79], v[110:111]
    v_mov_b64 v[80:81], v[112:113]
    buffer_load_dword v49, v51, s[4:7], s72 offen sc1
C_tr_s1:
    s_waitcnt vmcnt(4)
    v_cmp_le_u32 vcc, s63, v49
    buffer_load_dword v49, v51, s[4:7], s72 offen sc1
    s_cbranch_vccz C_trok_s1
    s_waitcnt vmcnt(4)
    v_cmp_le_u32 vcc, s63, v49
    buffer_load_dword v49, v51, s[4:7], s72 offen sc1
    s_cbranch_vccz C_trok_s1
    s_waitcnt vmcnt(4)
    v_cmp_le_u32 vcc, s63, v49
    buffer_load_dword v49, v51, s[4:7], s72 offen sc1
    s_cbranch_vccz C_trok_s1
    s_waitcnt vmcnt(4)
    v_cmp_le_u32 vcc, s63, v49
    buffer_load_dword v49, v51, s[4:7], s72 offen sc1
    s_cbranch_vccz C_trok_s1
    s_waitcnt vmcnt(4)
    v_cmp_le_u32 vcc, s63, v49
    buffer_load_dword v49, v51, s[4:7], s72 offen sc1
    s_cbranch_vccz C_trok_s1
    s_waitcnt vmcnt(4)
    v_cmp_le_u32 vcc, s63, v49
    buffer_load_dword v49, v51, s[4:7], s72 offen sc1
    s_cbranch_vccz C_trok_s1
    s_sub_u32 s69, s69, 1
    s_cbranch_scc0 C_tr_s1
    s_branch C_fail
C_retry2_s1:
    v_max_u32 v37, v0, v1
    v_max3_u32 v37, v37, v2, v3
    v_max3_u32 v37, v37, v4, v5
    v_max3_u32 v37, v37, v6, v7
    v_max3_u32 v37, v37, v8, v9
    v_max3_u32 v37, v37, v10, v11
    v_max3_u32 v37, v37, v12, v13
    v_max3_u32 v37, v37, v14, v15
    v_max3_u32 v37, v37, v16, v17
    v_max3_u32 v37, v37, v18, v19
    v_max3_u32 v37, v37, v20, v21
    v_max3_u32 v37, v37, v22, v23
    v_max3_u32 v37, v37, v24, v25
    v_max3_u32 v37, v37, v26, v27
    v_max3_u32 v37, v37, v28, v29
    v_max3_u32 v37, v37, v30, v31
    v_cmp_le_u32 vcc, s61, v37
    s_cbranch_vccz C_ok2_s1
C_rr_s1:
    s_mov_b32 m0, 0
    s_add_u32 s65, s67, 0
    buffer_load_dwordx4 v93, s[4:7], s65 offen offset:0 sc1 lds
    buffer_load_dwordx4 v93, s[4:7], s65 offen offset:1024 sc1 lds
    buffer_load_dwordx4 v93, s[4:7], s65 offen offset:2048 sc1 lds
    buffer_load_dwordx4 v93, s[4:7], s65 offen offset:3072 sc1 lds
    s_mov_b32 m0, 4096
    s_add_u32 s65, s67, 4096
    buffer_load_dwordx4 v93, s[4:7], s65 offen offset:0 sc1 lds
    buffer_load_dwordx4 v93, s[4:7], s65 offen offset:1024 sc1 lds
    buffer_load_dwordx4 v93, s[4:7], s65 offen offset:2048 sc1 lds
    buffer_load_dwordx4 v93, s[4:7], s65 offen offset:3072 sc1 lds
    s_sub_u32 s69, s69, 1
    s_cbranch_scc1 C_fail
    s_waitcnt vmcnt(0) lgkmcnt(0)
    ds_read_b128 v[0:3], v93 offset:0
    ds_read_b128 v[4:7], v93 offset:1024
    ds_read_b128 v[8:11], v93 offset:2048
    ds_read_b128 v[12:15], v93 offset:3072
    ds_read_b128 v[16:19], v93 offset:4096
    ds_read_b128 v[20:23], v93 offset:5120
    ds_read_b128 v[24:27], v93 offset:6144
    ds_read_b128 v[28:31], v93 offset:7168
    s_waitcnt lgkmcnt(0)
    v_max_u32 v37, v0, v1
    v_max3_u32 v37, v37, v2, v3
    v_max3_u32 v37, v37, v4, v5
    v_max3_u32 v37, v37, v6, v7
    v_max3_u32 v37, v37, v8, v9
    v_max3_u32 v37, v37, v10, v11
    v_max3_u32 v37, v37, v12, v13
    v_max3_u32 v37, v37, v14, v15
    v_max3_u32 v37, v37, v16, v17
    v_max3_u32 v37, v37, v18, v19
    v_max3_u32 v37, v37, v20, v21
    v_max3_u32 v37, v37, v22, v23
    v_max3_u32 v37, v37, v24, v25
    v_max3_u32 v37, v37, v26, v27
    v_max3_u32 v37, v37, v28, v29
    v_max3_u32 v37, v37, v30, v31
    v_cmp_le_u32 vcc, s61, v37
    s_cbranch_vccz C_rg_s1
    s_branch C_rr_s1
C_rg_s1:
    v_mov_b64 v[32:33], 0
    v_mov_b64 v[34:35], 0
    v_mov_b64 v[36:37], 0
    v_mov_b64 v[38:39], 0
    v_mov_b64 v[40:41], 0
    v_mov_b64 v[42:43], 0
    v_mov_b64 v[44:45], 0
    v_mov_b64 v[46:47], 0
    s_mov_b32 m0, 2048
    ds_read_b128 v[56:59], v94 offset:10240
    ds_read_b128 v[60:63], v94 offset:11264
    s_waitcnt lgkmcnt(0)
    v_smfmac_f32_16x16x64_bf16 v[32:35], v[0:3], v[56:63], v92
    ds_read_b128 v[64:67], v94 offset:12288
    ds_read_b128 v[68:71], v94 offset:13312
    s_waitcnt lgkmcnt(0)
    v_smfmac_f32_16x16x64_bf16 v[36:39], v[0:3], v[64:71], v92
    v_smfmac_f32_16x16x64_bf16 v[32:35], v[4:7], v[120:127], v92
    v_smfmac_f32_16x16x64_bf16 v[36:39], v[4:7], v[128:135], v92
    v_smfmac_f32_16x16x64_bf16 v[40:43], v[0:3], v[216:223], v92
    v_smfmac_f32_16x16x64_bf16 v[40:43], v[4:7], v[232:239], v92
    v_smfmac_f32_16x16x64_bf16 v[44:47], v[0:3], v[224:231], v92
    v_smfmac_f32_16x16x64_bf16 v[44:47], v[4:7], v[240:247], v92
    v_smfmac_f32_16x16x64_bf16 v[32:35], v[8:11], v[136:143], v92
    v_smfmac_f32_16x16x64_bf16 v[32:35], v[12:15], v[152:159], v92
    v_smfmac_f32_16x16x64_bf16 v[36:39], v[8:11], v[144:151], v92
    v_smfmac_f32_16x16x64_bf16 v[36:39], v[12:15], v[160:167], v92
    ds_read_b128 v[56:59], v94 offset:14336
    ds_read_b128 v[60:63], v94 offset:15360
    s_waitcnt lgkmcnt(0)
    v_smfmac_f32_16x16x64_bf16 v[32:35], v[16:19], v[56:63], v92
    v_smfmac_f32_16x16x64_bf16 v[32:35], v[20:23], v[168:175], v92
    ds_read_b128 v[64:67], v94 offset:16384
    ds_read_b128 v[68:71], v94 offset:17408
    s_waitcnt lgkmcnt(0)
    s_branch C_go2_s1
C_retry0_s1:
    global_load_dword v20, v54, s[24:25] offset:0 sc1
    global_load_dword v21, v54, s[24:25] offset:256 sc1
    global_load_dword v22, v54, s[24:25] offset:512 sc1
    global_load_dword v23, v54, s[24:25] offset:768 sc1
    global_load_dword v24, v54, s[24:25] offset:1024 sc1
    global_load_dword v25, v54, s[24:25] offset:1280 sc1
    global_load_dword v26, v54, s[24:25] offset:1536 sc1
    global_load_dword v27, v54, s[24:25] offset:1792 sc1
    s_waitcnt vmcnt(0)
C_retry1_s1:
    s_waitcnt vmcnt(1)
C_r1b_s1:
    v_smfmac_f32_16x16x64_bf16 v[4:7], v[88:91], v[20:27], v92 abid:1
    global_load_dword v8, v54, s[24:25] offset:0 sc1
    global_load_dword v9, v54, s[24:25] offset:256 sc1
    global_load_dword v10, v54, s[24:25] offset:512 sc1
    global_load_dword v11, v54, s[24:25] offset:768 sc1
    global_load_dword v12, v54, s[24:25] offset:1024 sc1
    global_load_dword v13, v54, s[24:25] offset:1280 sc1
    global_load_dword v14, v54, s[24:25] offset:1536 sc1
    global_load_dword v15, v54, s[24:25] offset:1792 sc1
    v_mov_b64 v[16:17], 0
    v_mov_b64 v[18:19], 0
    v_cvt_pk_bf16_f32 v28, v4, v5
    buffer_store_dword v28, v103, s[4:7], s51 offen sc1
    v_cmp_u_f32 vcc, v4, v5
    s_cbranch_vccz C_ok1_s1
    v_max3_u32 v6, v20, v21, v22
    v_max3_u32 v7, v23, v24, v25
    v_max3_u32 v6, v6, v26, v27
    v_max_u32 v6, v6, v7
    v_cmp_eq_u32 vcc, -1, v6
    global_load_dword v20, v54, s[24:25] offset:0 sc1
    global_load_dword v21, v54, s[24:25] offset:256 sc1
    global_load_dword v22, v54, s[24:25] offset:512 sc1
    global_load_dword v23, v54, s[24:25] offset:768 sc1
    global_load_dword v24, v54, s[24:25] offset:1024 sc1
    global_load_dword v25, v54, s[24:25] offset:1280 sc1
    global_load_dword v26, v54, s[24:25] offset:1536 sc1
    global_load_dword v27, v54, s[24:25] offset:1792 sc1
    s_cbranch_vccz C_nan1_s1
    v_mov_b64 v[4:5], 0
    v_mov_b64 v[6:7], 0
    s_sub_u32 s69, s69, 1
    s_cbranch_scc1 C_fail
    s_waitcnt vmcnt(9)
    v_smfmac_f32_16x16x64_bf16 v[16:19], v[88:91], v[8:15], v92 abid:1
    s_nop 7
    v_cvt_pk_bf16_f32 v28, v16, v17
    buffer_store_dword v28, v103, s[4:7], s51 offen sc1
    v_cmp_u_f32 vcc, v16, v17
    s_cbranch_vccz C_ok1_s1
    s_branch C_retry1_s1
C_nan1_s1:
    v_cmp_le_u32 vcc, s63, v28
    v_and_b32 v6, 0x7fffffff, v28
    s_nop 0
    v_cndmask_b32 v28, v28, v6, vcc
    buffer_store_dword v28, v103, s[4:7], s51 offen sc1
    s_waitcnt vmcnt(0)
    s_branch C_ok1_s1
C_flag_s1:
    buffer_load_dword v102, off, s[4:7], s58 sc1
    s_sub_u32 s69, s69, 1
    s_cbranch_scc1 C_fail
    s_waitcnt vmcnt(0)
    v_readfirstlane_b32 s70, v102
    s_nop 3
    s_cmp_le_u32 s70, s59
    s_cbranch_scc1 C_flag_s1
    s_branch C_flagok_s1
C_slow_s1:
    s_waitcnt lgkmcnt(0)
    s_nop 7
    v_max3_f32 v77, v32, v33, v36
    v_max_f32 v77, v77, v37
    v_bfe_u32 v76, v93, 4, 4
    v_lshlrev_b32 v76, 6, v76
    v_lshrrev_b32 v78, 8, v93
    v_lshl_add_u32 v78, v78, 2, v76
    ds_write_b32 v78, v77 offset:8208
    s_waitcnt lgkmcnt(0)
    s_barrier
    ds_read_b128 v[20:23], v76 offset:8192
    ds_read_b128 v[24:27], v76 offset:8208
    ds_read_b128 v[28:31], v76 offset:8224
    ds_read_b128 v[72:75], v76 offset:8240
    s_waitcnt lgkmcnt(3)
    v_max3_f32 v77, v77, v20, v21
    v_max3_f32 v77, v77, v22, v23
    s_waitcnt lgkmcnt(2)
    v_max3_f32 v77, v77, v24, v25
    v_max3_f32 v77, v77, v26, v27
    s_waitcnt lgkmcnt(1)
    v_max3_f32 v77, v77, v28, v29
    v_max3_f32 v77, v77, v30, v31
    s_waitcnt lgkmcnt(0)
    v_max3_f32 v77, v77, v72, v73
    v_max3_f32 v77, v77, v74, v75
    v_sub_f32 v34, v32, v77
    v_sub_f32 v35, v33, v77
    v_sub_f32 v38, v36, v77
    v_sub_f32 v39, v37, v77
    v_exp_f32 v34, v34
    v_exp_f32 v35, v35
    v_exp_f32 v38, v38
    v_exp_f32 v39, v39
    v_cvt_pk_bf16_f32 v34, v34, v35
    v_cvt_pk_bf16_f32 v16, v38, v39
    v_cvt_pk_bf16_f32 v17, v38, v39
    v_cvt_pk_bf16_f32 v18, v38, v39
    ds_write_b32 v100, v34
    s_waitcnt lgkmcnt(0)
    s_barrier
    ds_read_b128 v[40:43], v93 offset:13056
    v_mov_b64 v[0:1], 0
    v_mov_b64 v[2:3], 0
    v_mov_b64 v[4:5], 0
    v_mov_b64 v[6:7], 0
    v_mov_b64 v[56:57], 0
    v_mov_b64 v[58:59], 0
    v_mov_b64 v[60:61], 0
    v_mov_b64 v[62:63], 0
    s_waitcnt lgkmcnt(0)
    v_mfma_f32_16x16x32_bf16 v[44:47], v[40:43], v[88:91], 0
    v_mfma_f32_16x16x32_bf16 v[72:75], v[80:83], v[40:43], 0
    v_mfma_f32_16x16x32_bf16 v[76:79], v[84:87], v[40:43], 0
    v_mfma_f32_16x16x16_bf16 v[44:47], v[18:19], v[88:89], v[44:47]
    v_mfma_f32_16x16x16_bf16 v[72:75], v[48:49], v[16:17], v[72:75]
    v_mfma_f32_16x16x16_bf16 v[76:79], v[52:53], v[16:17], v[76:79]
    s_nop 7
    v_cvt_pk_bf16_f32 v20, v72, v73
    v_cvt_pk_bf16_f32 v21, v74, v75
    s_mov_b64 exec, s[30:31]
    v_cvt_pk_bf16_f32 v20, v76, v77
    v_cvt_pk_bf16_f32 v21, v78, v79
    s_mov_b64 exec, -1
    ds_write_b64 v95, v[20:21] offset:14592
    v_cvt_pk_bf16_f32 v72, v72, v73
    v_cvt_pk_bf16_f32 v73, v74, v75
    v_cvt_pk_bf16_f32 v74, v76, v77
    v_cvt_pk_bf16_f32 v75, v78, v79
    s_nop 1
    v_smfmac_f32_16x16x64_bf16 v[0:3], v[72:75], a[168:175], v92
    v_and_b32 v50, 0x1f0, v95
    v_smfmac_f32_16x16x64_bf16 v[4:7], v[72:75], a[184:191], v92
    s_waitcnt lgkmcnt(0)
    s_barrier
    ds_read_b128 v[20:23], v50 offset:14080
    v_mov_b64 v[60:61], 0
    v_mov_b64 v[62:63], 0
    v_smfmac_f32_16x16x64_bf16 v[56:59], v[72:75], a[216:223], v92
    ds_read_b128 v[24:27], v50 offset:15616
    v_lshrrev_b32 v54, 2, v93
    v_smfmac_f32_16x16x64_bf16 v[60:63], v[72:75], a[232:239], v92
    ds_read_b128 v[28:31], v50 offset:15104
    v_rcp_f32 v34, v44
    v_rcp_f32 v35, v46
    s_nop 0
    s_waitcnt lgkmcnt(2)
    v_smfmac_f32_16x16x64_bf16 v[0:3], v[20:23], v[64:71], v92
    ds_read_b128 v[72:75], v94 offset:4096
    v_max3_f32 v39, v44, v46, v34
    s_waitcnt lgkmcnt(2)
    v_smfmac_f32_16x16x64_bf16 v[0:3], v[24:27], v[8:15], v92
    ds_read_b128 v[76:79], v94 offset:5120
    v_max_f32 v39, v39, v35
    s_waitcnt lgkmcnt(2)
    v_smfmac_f32_16x16x64_bf16 v[0:3], v[28:31], a[176:183], v92
    ds_read_b128 v[40:43], v94 offset:6144
    v_cmp_lt_f32 vcc, s64, v39
    v_smfmac_f32_16x16x64_bf16 v[4:7], v[20:23], a[192:199], v92
    ds_read_b128 v[44:47], v94 offset:7168
    v_smfmac_f32_16x16x64_bf16 v[4:7], v[24:27], a[200:207], v92
    s_waitcnt lgkmcnt(0)
    s_branch C_after_s1
.p2align 6
C_base_s2:
    s_nop 0
    s_nop 0
C_trok_s2:
    buffer_load_dwordx4 v93, s[4:7], s52 offen offset:0 sc1 lds
    buffer_load_dwordx4 v93, s[4:7], s52 offen offset:1024 sc1 lds
    v_mov_b64 v[82:83], v[114:115]
    v_mov_b64 v[84:85], v[116:117]
    v_mov_b64 v[86:87], v[118:119]
C_poll2_s2:
    s_barrier
    ds_read_b128 v[0:3], v93 offset:0
    ds_read_b128 v[4:7], v93 offset:1024
    global_store_dword v54, v55, s[26:27] offset:0 sc1
    global_store_dword v54, v55, s[26:27] offset:256 sc1
    global_store_dword v54, v55, s[26:27] offset:512 sc1
C_go1_s2:
    s_waitcnt lgkmcnt(1)
    v_smfmac_f32_16x16x64_bf16 v[32:35], v[0:3], v[56:63], v92
    s_waitcnt lgkmcnt(0)
    v_smfmac_f32_16x16x64_bf16 v[32:35], v[4:7], v[120:127], v92
    s_barrier
    v_smfmac_f32_16x16x64_bf16 v[36:39], v[0:3], v[64:71], v92
    buffer_load_dwordx4 v[104:107], v93, s[4:7], s56 offen offset:0 sc1
    v_smfmac_f32_16x16x64_bf16 v[40:43], v[0:3], v[216:223], v92
    ds_read_b128 v[8:11], v93 offset:2048
    v_smfmac_f32_16x16x64_bf16 v[36:39], v[4:7], v[128:135], v92
    ds_read_b128 v[12:15], v93 offset:3072
    v_smfmac_f32_16x16x64_bf16 v[40:43], v[4:7], v[232:239], v92
    ds_read_b128 v[56:59], v94 offset:14336
    v_smfmac_f32_16x16x64_bf16 v[44:47], v[0:3], v[224:231], v92
    ds_read_b128 v[60:63], v94 offset:15360
    buffer_load_dwordx4 v[108:111], v93, s[4:7], s56 offen offset:1024 sc1
    v_smfmac_f32_16x16x64_bf16 v[44:47], v[4:7], v[240:247], v92
    s_waitcnt vmcnt(5)
    s_barrier
    ds_read_b128 v[16:19], v93 offset:4096
    s_waitcnt lgkmcnt(4)
    v_smfmac_f32_16x16x64_bf16 v[32:35], v[8:11], v[136:143], v92
    ds_read_b128 v[20:23], v93 offset:5120
    s_waitcnt lgkmcnt(4)
    v_smfmac_f32_16x16x64_bf16 v[32:35], v[12:15], v[152:159], v92
    ds_read_b128 v[64:67], v94 offset:16384
    v_smfmac_f32_16x16x64_bf16 v[36:39], v[8:11], v[144:151], v92
    ds_read_b128 v[68:71], v94 offset:17408
    buffer_load_dwordx4 v[112:115], v93, s[4:7], s56 offen offset:2048 sc1
    v_smfmac_f32_16x16x64_bf16 v[36:39], v[12:15], v[160:167], v92
    s_barrier
    s_waitcnt lgkmcnt(3)
    v_smfmac_f32_16x16x64_bf16 v[32:35], v[16:19], v[56:63], v92
    ds_read_b128 v[24:27], v93 offset:6144
    s_waitcnt lgkmcnt(3)
    v_smfmac_f32_16x16x64_bf16 v[32:35], v[20:23], v[168:175], v92
    ds_read_b128 v[28:31], v93 offset:7168
C_go2_s2:
    v_smfmac_f32_16x16x64_bf16 v[36:39], v[20:23], v[176:183], v92
    ds_read_b128 v[56:59], v94 offset:22528
    buffer_load_dwordx4 v[116:119], v93, s[4:7], s56 offen offset:3072 sc1
    s_waitcnt lgkmcnt(3)
    v_smfmac_f32_16x16x64_bf16 v[36:39], v[16:19], v[64:71], v92
    ds_read_b128 v[60:63], v94 offset:23552
    s_waitcnt lgkmcnt(3)
    v_smfmac_f32_16x16x64_bf16 v[32:35], v[24:27], v[184:191], v92
    ds_read_b128 v[64:67], v94 offset:24576
    global_store_dword v54, v55, s[26:27] offset:768 sc1
    s_waitcnt lgkmcnt(3)
    v_smfmac_f32_16x16x64_bf16 v[32:35], v[28:31], v[200:207], v92
    ds_read_b128 v[68:71], v94 offset:25600
    v_mov_b64 v[48:49], 0
    v_smfmac_f32_16x16x64_bf16 v[36:39], v[24:27], v[192:199], v92
    global_store_dword v54, v55, s[26:27] offset:1024 sc1
    v_mov_b64 v[50:51], 0
    v_smfmac_f32_16x16x64_bf16 v[36:39], v[28:31], v[208:215], v92
    global_store_dword v54, v55, s[26:27] offset:1280 sc1
    s_waitcnt lgkmcnt(2)
    v_mul_f32 v33, s62, v33
    v_mul_f32 v35, s62, v35
    v_smfmac_f32_16x16x64_bf16 v[40:43], v[16:19], v[56:63], v92
    global_store_dword v54, v55, s[26:27] offset:1536 sc1
    v_fma_f32 v32, v32, s62, v33
    v_fma_f32 v34, v34, s62, v35
    v_smfmac_f32_16x16x64_bf16 v[40:43], v[8:11], v[248:255], v92
    ds_read_b128 v[56:59], v94 offset:26624
    v_mul_f32 v37, s62, v37
    v_mul_f32 v39, s62, v39
    v_smfmac_f32_16x16x64_bf16 v[40:43], v[12:15], a[8:15], v92
    ds_read_b128 v[60:63], v94 offset:27648
    v_fma_f32 v36, v36, s62, v37
    v_fma_f32 v38, v38, s62, v39
    v_smfmac_f32_16x16x64_bf16 v[40:43], v[24:27], a[24:31], v92
    global_store_dword v54, v55, s[26:27] offset:1792 sc1
    s_waitcnt lgkmcnt(2)
    v_cvt_pk_bf16_f32 v32, v32, v36
    v_cvt_pk_bf16_f32 v33, v34, v38
    v_smfmac_f32_16x16x64_bf16 v[44:47], v[16:19], v[64:71], v92
    ds_write2_b32 v96, v32, v33 offset0:0 offset1:72
    v_smfmac_f32_16x16x64_bf16 v[40:43], v[28:31], a[40:47], v92
    ds_read_b128 v[64:67], v94 offset:28672
    v_cmp_u_f32 vcc, v36, v38
    v_smfmac_f32_16x16x64_bf16 v[44:47], v[8:11], a[0:7], v92
    ds_read_b128 v[68:71], v94 offset:29696
    s_waitcnt lgkmcnt(3)
    v_mov_b64 v[32:33], 0
    v_smfmac_f32_16x16x64_bf16 v[40:43], v[20:23], v[56:63], v92
    buffer_store_dword v55, v103, s[4:7], s54 offen sc1
    v_smfmac_f32_16x16x64_bf16 v[44:47], v[12:15], a[16:23], v92
    s_cbranch_vccnz C_retry2_s2
C_ok2_s2:
    v_mov_b64 v[34:35], 0
    v_mov_b64 v[54:55], 0
    v_smfmac_f32_16x16x64_bf16 v[44:47], v[24:27], a[32:39], v92
    s_waitcnt lgkmcnt(2)
    s_barrier
    ds_read_b128 v[56:59], v98 offset:0
    v_smfmac_f32_16x16x64_bf16 v[44:47], v[28:31], a[48:55], v92
    ds_read_b128 v[60:63], v98 offset:64
    s_waitcnt lgkmcnt(2)
    v_add_f32 v40, v40, v41
    v_smfmac_f32_16x16x64_bf16 v[44:47], v[20:23], v[64:71], v92
    ds_read_b128 v[64:67], v98 offset:128
    v_add_f32 v42, v42, v43
    v_smfmac_f32_16x16x64_bf16 v[48:51], v[0:3], a[56:63], v92
    ds_read_b128 v[68:71], v98 offset:192
    v_smfmac_f32_16x16x64_bf16 v[48:51], v[4:7], a[72:79], v92
    v_add_f32 v44, v44, v45
    v_add_f32 v46, v46, v47
    v_smfmac_f32_16x16x64_bf16 v[52:55], v[0:3], a[64:71], v92
    s_waitcnt lgkmcnt(2)
    v_cvt_pk_bf16_f32 v40, v40, v44
    v_cvt_pk_bf16_f32 v41, v42, v46
    v_smfmac_f32_16x16x64_bf16 v[32:35], v[72:75], v[56:63], v92
    ds_write2_b32 v97, v40, v41 offset0:0 offset1:80
    s_waitcnt lgkmcnt(1)
    v_smfmac_f32_16x16x64_bf16 v[32:35], v[76:79], v[64:71], v92
    ds_read_b128 v[0:3], v94 offset:18432
    v_mov_b64 v[36:37], 0
    v_smfmac_f32_16x16x64_bf16 v[52:55], v[4:7], a[80:87], v92
    ds_read_b128 v[4:7], v94 offset:19456
    v_mov_b64 v[38:39], 0
    v_smfmac_f32_16x16x64_bf16 v[48:51], v[8:11], a[88:95], v92
    v_add_f32 v32, v32, v33
    v_add_f32 v33, v34, v35
    v_smfmac_f32_16x16x64_bf16 v[48:51], v[12:15], a[104:111], v92
    s_waitcnt lgkmcnt(2)
    s_barrier
    v_exp_f32 v34, v32
    v_smfmac_f32_16x16x64_bf16 v[48:51], v[16:19], a[120:127], v92
    ds_read_b128 v[72:75], v99
    s_waitcnt lgkmcnt(1)
    v_smfmac_f32_16x16x64_bf16 v[48:51], v[28:31], v[0:7], v92
    ds_read_b128 v[76:79], v99 offset:128
    v_exp_f32 v35, v33
    v_smfmac_f32_16x16x64_bf16 v[48:51], v[20:23], a[136:143], v92
    v_cvt_pk_bf16_f32 v34, v34, v35
    v_smfmac_f32_16x16x64_bf16 v[48:51], v[24:27], a[152:159], v92
    ds_write_b32 v100, v34
    s_waitcnt lgkmcnt(2)
    v_smfmac_f32_16x16x64_bf16 v[36:39], v[72:75], v[56:63], v92
    s_waitcnt lgkmcnt(1)
    v_mov_b64 v[0:1], 0
    v_smfmac_f32_16x16x64_bf16 v[36:39], v[76:79], v[64:71], v92
    ds_read_b128 v[56:59], v94 offset:20480
    v_cvt_pk_bf16_f32 v48, v48, v50
    v_smfmac_f32_16x16x64_bf16 v[52:55], v[8:11], a[96:103], v92
    ds_read_b128 v[60:63], v94 offset:21504
    v_cvt_pk_bf16_f32 v49, v49, v51
    v_smfmac_f32_16x16x64_bf16 v[52:55], v[12:15], a[112:119], v92
    s_waitcnt lgkmcnt(2)
    s_barrier
    ds_read_b128 v[40:43], v93 offset:13056
    v_add_f32 v36, v36, v37
    v_smfmac_f32_16x16x64_bf16 v[52:55], v[16:19], a[128:135], v92
    ds_read_b128 v[64:67], v94 offset:0
    ds_read_b128 v[68:71], v94 offset:1024
    v_add_f32 v37, v38, v39
    v_smfmac_f32_16x16x64_bf16 v[52:55], v[20:23], a[144:151], v92
    s_waitcnt lgkmcnt(3)
    v_exp_f32 v38, v36
    v_smfmac_f32_16x16x64_bf16 v[52:55], v[28:31], v[56:63], v92
    ds_read_b128 v[8:11], v94 offset:2048
    v_exp_f32 v39, v37
    v_smfmac_f32_16x16x64_bf16 v[52:55], v[24:27], a[160:167], v92
    ds_read_b128 v[12:15], v94 offset:3072
    s_waitcnt lgkmcnt(4)
    v_mfma_f32_16x16x32_bf16 v[72:75], v[80:83], v[40:43], 0
    v_cvt_pk_bf16_f32 v17, v38, v39
    v_mov_b64 v[2:3], 0
    v_mfma_f32_16x16x32_bf16 v[76:79], v[84:87], v[40:43], 0
    v_cvt_pk_bf16_f32 v16, v38, v39
    v_cvt_pk_bf16_f32 v52, v52, v54
    v_cvt_pk_bf16_f32 v53, v53, v55
    v_mfma_f32_16x16x16_bf16 v[72:75], v[48:49], v[16:17], v[72:75]
    v_cvt_pk_bf16_f32 v18, v38, v39
    v_mov_b32 v19, 0
    v_mfma_f32_16x16x16_bf16 v[76:79], v[52:53], v[16:17], v[76:79]
    v_mov_b64 v[4:5], 0
    v_mov_b64 v[6:7], 0
    v_mfma_f32_16x16x32_bf16 v[44:47], v[40:43], v[88:91], 0
    v_cvt_pk_bf16_f32 v20, v72, v73
    v_cvt_pk_bf16_f32 v21, v74, v75
    s_mov_b64 exec, s[30:31]
    v_cvt_pk_bf16_f32 v20, v76, v77
    v_cvt_pk_bf16_f32 v21, v78, v79
    s_mov_b64 exec, -1
    ds_write_b64 v95, v[20:21] offset:15104
    v_mfma_f32_16x16x16_bf16 v[44:47], v[18:19], v[88:89], v[44:47]
    v_cvt_pk_bf16_f32 v72, v72, v73
    v_cvt_pk_bf16_f32 v73, v74, v75
    v_cvt_pk_bf16_f32 v74, v76, v77
    v_cvt_pk_bf16_f32 v75, v78, v79
    v_mov_b64 v[56:57], 0
    v_mov_b64 v[58:59], 0
    v_smfmac_f32_16x16x64_bf16 v[0:3], v[72:75], a[168:175], v92
    v_and_b32 v50, 0x1f0, v95
    v_smfmac_f32_16x16x64_bf16 v[4:7], v[72:75], a[184:191], v92
    s_waitcnt lgkmcnt(0)
    s_barrier
    ds_read_b128 v[20:23], v50 offset:15616
    v_mov_b64 v[60:61], 0
    v_mov_b64 v[62:63], 0
    v_smfmac_f32_16x16x64_bf16 v[56:59], v[72:75], a[216:223], v92
    ds_read_b128 v[24:27], v50 offset:14080
    v_lshrrev_b32 v54, 2, v93
    v_smfmac_f32_16x16x64_bf16 v[60:63], v[72:75], a[232:239], v92
    ds_read_b128 v[28:31], v50 offset:14592
    v_rcp_f32 v34, v44
    v_rcp_f32 v35, v46
    s_nop 0
    s_waitcnt lgkmcnt(2)
    v_smfmac_f32_16x16x64_bf16 v[0:3], v[20:23], v[64:71], v92
    ds_read_b128 v[72:75], v94 offset:4096
    s_waitcnt lgkmcnt(2)
    v_max3_f32 v39, v44, v46, v34
    v_smfmac_f32_16x16x64_bf16 v[0:3], v[24:27], v[8:15], v92
    ds_read_b128 v[76:79], v94 offset:5120
    s_waitcnt lgkmcnt(2)
    v_max_f32 v39, v39, v35
    v_smfmac_f32_16x16x64_bf16 v[0:3], v[28:31], a[176:183], v92
    ds_read_b128 v[40:43], v94 offset:6144
    v_cmp_lt_f32 vcc, s64, v39
    v_smfmac_f32_16x16x64_bf16 v[4:7], v[20:23], a[192:199], v92
    ds_read_b128 v[44:47], v94 offset:7168
    v_smfmac_f32_16x16x64_bf16 v[4:7], v[24:27], a[200:207], v92
    s_cbranch_vccnz C_slow_s2
C_after_s2:
    v_mul_f32 v0, v0, v34
    v_mul_f32 v1, v1, v34
    v_mul_f32 v2, v2, v35
    v_mul_f32 v3, v3, v35
    v_cvt_pk_bf16_f32 v0, v0, v1
    v_cvt_pk_bf16_f32 v1, v2, v3
    v_smfmac_f32_16x16x64_bf16 v[4:7], v[28:31], a[208:215], v92
    global_store_dword v101, v0, s[16:17] sc1
    global_store_dword v101, v1, s[16:17] offset:2048 sc1
    s_waitcnt lgkmcnt(2)
    v_smfmac_f32_16x16x64_bf16 v[56:59], v[20:23], v[72:79], v92
    ds_read_b128 v[80:83], v94 offset:8192
    v_mov_b64 v[16:17], 0
    v_smfmac_f32_16x16x64_bf16 v[56:59], v[24:27], a[224:231], v92
    ds_read_b128 v[84:87], v94 offset:9216
    s_waitcnt lgkmcnt(2)
    v_mul_f32 v4, v4, v34
    v_mul_f32 v5, v5, v34
    v_mul_f32 v6, v6, v35
    v_mul_f32 v7, v7, v35
    v_cvt_pk_bf16_f32 v4, v4, v5
    v_cvt_pk_bf16_f32 v5, v6, v7
    v_smfmac_f32_16x16x64_bf16 v[56:59], v[28:31], v[40:47], v92
    global_store_dword v101, v4, s[18:19] sc1
    global_store_dword v101, v5, s[18:19] offset:2048 sc1
    v_smfmac_f32_16x16x64_bf16 v[60:63], v[20:23], a[240:247], v92
    v_mov_b64 v[18:19], 0
    v_smfmac_f32_16x16x64_bf16 v[60:63], v[24:27], a[248:255], v92
    s_waitcnt lgkmcnt(0)
    v_mul_f32 v56, v56, v34
    v_mul_f32 v57, v57, v34
    v_mul_f32 v58, v58, v35
    v_mul_f32 v59, v59, v35
    v_cvt_pk_bf16_f32 v56, v56, v57
    v_cvt_pk_bf16_f32 v57, v58, v59
    v_smfmac_f32_16x16x64_bf16 v[60:63], v[28:31], v[80:87], v92
    global_store_dword v101, v56, s[20:21] sc1
    global_store_dword v101, v57, s[20:21] offset:2048 sc1
    v_mov_b64 v[4:5], 0
    v_mov_b64 v[6:7], 0
    v_and_b32 v51, 0x80, v54
    v_lshl_add_u32 v51, v51, 23, v54
    v_mov_b32 v49, -1
    s_nop 0
    v_mul_f32 v60, v60, v34
    v_mul_f32 v61, v61, v34
    v_mul_f32 v62, v62, v35
    v_mul_f32 v63, v63, v35
    v_cvt_pk_bf16_f32 v60, v60, v61
    v_cvt_pk_bf16_f32 v61, v62, v63
    global_store_dword v101, v60, s[22:23] sc1
    global_store_dword v101, v61, s[22:23] offset:2048 sc1
    s_add_u32 s55, s55, 16384
    s_add_u32 s72, s51, s73
    s_add_u32 s52, s51, 4096
    s_mov_b32 s26, s24
    s_waitcnt vmcnt(2)
    v_mov_b32 v55, -1
    v_mov_b64 v[40:41], 0
    v_mov_b64 v[42:43], 0
    v_mov_b64 v[44:45], 0
    v_mov_b64 v[46:47], 0
C_ld1_s2:
    global_load_dword v8, v54, s[24:25] offset:0 sc1
    global_load_dword v9, v54, s[24:25] offset:256 sc1
    global_load_dword v10, v54, s[24:25] offset:512 sc1
    global_load_dword v11, v54, s[24:25] offset:768 sc1
    global_load_dword v12, v54, s[24:25] offset:1024 sc1
    global_load_dword v13, v54, s[24:25] offset:1280 sc1
    global_load_dword v14, v54, s[24:25] offset:1536 sc1
    global_load_dword v15, v54, s[24:25] offset:1792 sc1
C_red_s2:
    s_waitcnt vmcnt(0)
    v_smfmac_f32_16x16x64_bf16 v[16:19], v[88:91], v[8:15], v92 abid:1
    s_mov_b64 exec, s[28:29]
    s_nop 6
    buffer_store_dword v16, v103, s[4:7], s51 offen sc1
    s_mov_b64 exec, 0xffff
    v_cvt_pk_bf16_f32 v28, v16, v17
    buffer_store_dword v28, v103, s[4:7], s51 offen sc1
    v_cmp_u_f32 vcc, v16, v17
    s_mov_b64 exec, -1
    s_cbranch_vccnz C_retry0_s2
C_ok1_s2:
    s_add_u32 s60, s60, 1
    s_cmp_eq_u32 s60, 63
    s_cbranch_scc1 C_done
C_flagok_s2:
    v_mov_b64 v[52:53], 0
    v_mov_b64 v[32:33], 0
    buffer_load_dword v49, v51, s[4:7], s72 offen sc1
    v_mov_b64 v[34:35], 0
    v_mov_b64 v[36:37], 0
    v_mov_b64 v[38:39], 0
    s_xor_b32 s16, s16, 0x80000
    s_xor_b32 s18, s18, 0x80000
    s_xor_b32 s20, s20, 0x80000
    s_xor_b32 s22, s22, 0x80000
    buffer_load_dword v49, v51, s[4:7], s72 offen sc1
    s_add_u32 s56, s56, 0x80000
    ds_read_b128 v[56:59], v94 offset:10240
    s_mov_b32 s67, s51
    s_add_u32 s51, s51, 16384
    ds_read_b128 v[60:63], v94 offset:11264
    s_bitset0_b32 s51, 16
    s_xor_b32 s54, s51, 32768
    buffer_load_dword v49, v51, s[4:7], s72 offen sc1
    ds_read_b128 v[64:67], v94 offset:12288
    s_xor_b32 s24, s24, 0x80000
    ds_read_b128 v[68:71], v94 offset:13312
    buffer_load_dword v49, v51, s[4:7], s72 offen sc1
    v_mov_b64 v[72:73], v[104:105]
    v_mov_b64 v[74:75], v[106:107]
    v_mov_b64 v[76:77], v[108:109]
    v_mov_b64 v[78:79], v[110:111]
    v_mov_b64 v[80:81], v[112:113]
    buffer_load_dword v49, v51, s[4:7], s72 offen sc1
C_tr_s2:
    s_waitcnt vmcnt(4)
    v_cmp_le_u32 vcc, s63, v49
    buffer_load_dword v49, v51, s[4:7], s72 offen sc1
    s_cbranch_vccz C_trok_s2
    s_waitcnt vmcnt(4)
    v_cmp_le_u32 vcc, s63, v49
    buffer_load_dword v49, v51, s[4:7], s72 offen sc1
    s_cbranch_vccz C_trok_s2
    s_waitcnt vmcnt(4)
    v_cmp_le_u32 vcc, s63, v49
    buffer_load_dword v49, v51, s[4:7], s72 offen sc1
    s_cbranch_vccz C_trok_s2
    s_waitcnt vmcnt(4)
    v_cmp_le_u32 vcc, s63, v49
    buffer_load_dword v49, v51, s[4:7], s72 offen sc1
    s_cbranch_vccz C_trok_s2
    s_waitcnt vmcnt(4)
    v_cmp_le_u32 vcc, s63, v49
    buffer_load_dword v49, v51, s[4:7], s72 offen sc1
    s_cbranch_vccz C_trok_s2
    s_waitcnt vmcnt(4)
    v_cmp_le_u32 vcc, s63, v49
    buffer_load_dword v49, v51, s[4:7], s72 offen sc1
    s_cbranch_vccz C_trok_s2
    s_sub_u32 s69, s69, 1
    s_cbranch_scc0 C_tr_s2
    s_branch C_fail
C_retry2_s2:
    v_max_u32 v37, v0, v1
    v_max3_u32 v37, v37, v2, v3
    v_max3_u32 v37, v37, v4, v5
    v_max3_u32 v37, v37, v6, v7
    v_max3_u32 v37, v37, v8, v9
    v_max3_u32 v37, v37, v10, v11
    v_max3_u32 v37, v37, v12, v13
    v_max3_u32 v37, v37, v14, v15
    v_max3_u32 v37, v37, v16, v17
    v_max3_u32 v37, v37, v18, v19
    v_max3_u32 v37, v37, v20, v21
    v_max3_u32 v37, v37, v22, v23
    v_max3_u32 v37, v37, v24, v25
    v_max3_u32 v37, v37, v26, v27
    v_max3_u32 v37, v37, v28, v29
    v_max3_u32 v37, v37, v30, v31
    v_cmp_le_u32 vcc, s61, v37
    s_cbranch_vccz C_ok2_s2
C_rr_s2:
    s_mov_b32 m0, 0
    s_add_u32 s65, s67, 0
    buffer_load_dwordx4 v93, s[4:7], s65 offen offset:0 sc1 lds
    buffer_load_dwordx4 v93, s[4:7], s65 offen offset:1024 sc1 lds
    buffer_load_dwordx4 v93, s[4:7], s65 offen offset:2048 sc1 lds
    buffer_load_dwordx4 v93, s[4:7], s65 offen offset:3072 sc1 lds
    s_mov_b32 m0, 4096
    s_add_u32 s65, s67, 4096
    buffer_load_dwordx4 v93, s[4:7], s65 offen offset:0 sc1 lds
    buffer_load_dwordx4 v93, s[4:7], s65 offen offset:1024 sc1 lds
    buffer_load_dwordx4 v93, s[4:7], s65 offen offset:2048 sc1 lds
    buffer_load_dwordx4 v93, s[4:7], s65 offen offset:3072 sc1 lds
    s_sub_u32 s69, s69, 1
    s_cbranch_scc1 C_fail
    s_waitcnt vmcnt(0) lgkmcnt(0)
    ds_read_b128 v[0:3], v93 offset:0
    ds_read_b128 v[4:7], v93 offset:1024
    ds_read_b128 v[8:11], v93 offset:2048
    ds_read_b128 v[12:15], v93 offset:3072
    ds_read_b128 v[16:19], v93 offset:4096
    ds_read_b128 v[20:23], v93 offset:5120
    ds_read_b128 v[24:27], v93 offset:6144
    ds_read_b128 v[28:31], v93 offset:7168
    s_waitcnt lgkmcnt(0)
    v_max_u32 v37, v0, v1
    v_max3_u32 v37, v37, v2, v3
    v_max3_u32 v37, v37, v4, v5
    v_max3_u32 v37, v37, v6, v7
    v_max3_u32 v37, v37, v8, v9
    v_max3_u32 v37, v37, v10, v11
    v_max3_u32 v37, v37, v12, v13
    v_max3_u32 v37, v37, v14, v15
    v_max3_u32 v37, v37, v16, v17
    v_max3_u32 v37, v37, v18, v19
    v_max3_u32 v37, v37, v20, v21
    v_max3_u32 v37, v37, v22, v23
    v_max3_u32 v37, v37, v24, v25
    v_max3_u32 v37, v37, v26, v27
    v_max3_u32 v37, v37, v28, v29
    v_max3_u32 v37, v37, v30, v31
    v_cmp_le_u32 vcc, s61, v37
    s_cbranch_vccz C_rg_s2
    s_branch C_rr_s2
C_rg_s2:
    v_mov_b64 v[32:33], 0
    v_mov_b64 v[34:35], 0
    v_mov_b64 v[36:37], 0
    v_mov_b64 v[38:39], 0
    v_mov_b64 v[40:41], 0
    v_mov_b64 v[42:43], 0
    v_mov_b64 v[44:45], 0
    v_mov_b64 v[46:47], 0
    s_mov_b32 m0, 4096
    ds_read_b128 v[56:59], v94 offset:10240
    ds_read_b128 v[60:63], v94 offset:11264
    s_waitcnt lgkmcnt(0)
    v_smfmac_f32_16x16x64_bf16 v[32:35], v[0:3], v[56:63], v92
    ds_read_b128 v[64:67], v94 offset:12288
    ds_read_b128 v[68:71], v94 offset:13312
    s_waitcnt lgkmcnt(0)
    v_smfmac_f32_16x16x64_bf16 v[36:39], v[0:3], v[64:71], v92
    v_smfmac_f32_16x16x64_bf16 v[32:35], v[4:7], v[120:127], v92
    v_smfmac_f32_16x16x64_bf16 v[36:39], v[4:7], v[128:135], v92
    v_smfmac_f32_16x16x64_bf16 v[40:43], v[0:3], v[216:223], v92
    v_smfmac_f32_16x16x64_bf16 v[40:43], v[4:7], v[232:239], v92
    v_smfmac_f32_16x16x64_bf16 v[44:47], v[0:3], v[224:231], v92
    v_smfmac_f32_16x16x64_bf16 v[44:47], v[4:7], v[240:247], v92
    v_smfmac_f32_16x16x64_bf16 v[32:35], v[8:11], v[136:143], v92
    v_smfmac_f32_16x16x64_bf16 v[32:35], v[12:15], v[152:159], v92
    v_smfmac_f32_16x16x64_bf16 v[36:39], v[8:11], v[144:151], v92
    v_smfmac_f32_16x16x64_bf16 v[36:39], v[12:15], v[160:167], v92
    ds_read_b128 v[56:59], v94 offset:14336
    ds_read_b128 v[60:63], v94 offset:15360
    s_waitcnt lgkmcnt(0)
    v_smfmac_f32_16x16x64_bf16 v[32:35], v[16:19], v[56:63], v92
    v_smfmac_f32_16x16x64_bf16 v[32:35], v[20:23], v[168:175], v92
    ds_read_b128 v[64:67], v94 offset:16384
    ds_read_b128 v[68:71], v94 offset:17408
    s_waitcnt lgkmcnt(0)
    s_branch C_go2_s2
C_retry0_s2:
    global_load_dword v20, v54, s[24:25] offset:0 sc1
    global_load_dword v21, v54, s[24:25] offset:256 sc1
    global_load_dword v22, v54, s[24:25] offset:512 sc1
    global_load_dword v23, v54, s[24:25] offset:768 sc1
    global_load_dword v24, v54, s[24:25] offset:1024 sc1
    global_load_dword v25, v54, s[24:25] offset:1280 sc1
    global_load_dword v26, v54, s[24:25] offset:1536 sc1
    global_load_dword v27, v54, s[24:25] offset:1792 sc1
    s_waitcnt vmcnt(0)
C_retry1_s2:
    s_waitcnt vmcnt(1)
C_r1b_s2:
    v_smfmac_f32_16x16x64_bf16 v[4:7], v[88:91], v[20:27], v92 abid:1
    global_load_dword v8, v54, s[24:25] offset:0 sc1
    global_load_dword v9, v54, s[24:25] offset:256 sc1
    global_load_dword v10, v54, s[24:25] offset:512 sc1
    global_load_dword v11, v54, s[24:25] offset:768 sc1
    global_load_dword v12, v54, s[24:25] offset:1024 sc1
    global_load_dword v13, v54, s[24:25] offset:1280 sc1
    global_load_dword v14, v54, s[24:25] offset:1536 sc1
    global_load_dword v15, v54, s[24:25] offset:1792 sc1
    v_mov_b64 v[16:17], 0
    v_mov_b64 v[18:19], 0
    v_cvt_pk_bf16_f32 v28, v4, v5
    buffer_store_dword v28, v103, s[4:7], s51 offen sc1
    v_cmp_u_f32 vcc, v4, v5
    s_cbranch_vccz C_ok1_s2
    v_max3_u32 v6, v20, v21, v22
    v_max3_u32 v7, v23, v24, v25
    v_max3_u32 v6, v6, v26, v27
    v_max_u32 v6, v6, v7
    v_cmp_eq_u32 vcc, -1, v6
    global_load_dword v20, v54, s[24:25] offset:0 sc1
    global_load_dword v21, v54, s[24:25] offset:256 sc1
    global_load_dword v22, v54, s[24:25] offset:512 sc1
    global_load_dword v23, v54, s[24:25] offset:768 sc1
    global_load_dword v24, v54, s[24:25] offset:1024 sc1
    global_load_dword v25, v54, s[24:25] offset:1280 sc1
    global_load_dword v26, v54, s[24:25] offset:1536 sc1
    global_load_dword v27, v54, s[24:25] offset:1792 sc1
    s_cbranch_vccz C_nan1_s2
    v_mov_b64 v[4:5], 0
    v_mov_b64 v[6:7], 0
    s_sub_u32 s69, s69, 1
    s_cbranch_scc1 C_fail
    s_waitcnt vmcnt(9)
    v_smfmac_f32_16x16x64_bf16 v[16:19], v[88:91], v[8:15], v92 abid:1
    s_nop 7
    v_cvt_pk_bf16_f32 v28, v16, v17
    buffer_store_dword v28, v103, s[4:7], s51 offen sc1
    v_cmp_u_f32 vcc, v16, v17
    s_cbranch_vccz C_ok1_s2
    s_branch C_retry1_s2
C_nan1_s2:
    v_cmp_le_u32 vcc, s63, v28
    v_and_b32 v6, 0x7fffffff, v28
    s_nop 0
    v_cndmask_b32 v28, v28, v6, vcc
    buffer_store_dword v28, v103, s[4:7], s51 offen sc1
    s_waitcnt vmcnt(0)
    s_branch C_ok1_s2
C_flag_s2:
    buffer_load_dword v102, off, s[4:7], s58 sc1
    s_sub_u32 s69, s69, 1
    s_cbranch_scc1 C_fail
    s_waitcnt vmcnt(0)
    v_readfirstlane_b32 s70, v102
    s_nop 3
    s_cmp_le_u32 s70, s59
    s_cbranch_scc1 C_flag_s2
    s_branch C_flagok_s2
C_slow_s2:
    s_waitcnt lgkmcnt(0)
    s_nop 7
    v_max3_f32 v77, v32, v33, v36
    v_max_f32 v77, v77, v37
    v_bfe_u32 v76, v93, 4, 4
    v_lshlrev_b32 v76, 6, v76
    v_lshrrev_b32 v78, 8, v93
    v_lshl_add_u32 v78, v78, 2, v76
    ds_write_b32 v78, v77 offset:8224
    s_waitcnt lgkmcnt(0)
    s_barrier
    ds_read_b128 v[20:23], v76 offset:8192
    ds_read_b128 v[24:27], v76 offset:8208
    ds_read_b128 v[28:31], v76 offset:8224
    ds_read_b128 v[72:75], v76 offset:8240
    s_waitcnt lgkmcnt(3)
    v_max3_f32 v77, v77, v20, v21
    v_max3_f32 v77, v77, v22, v23
    s_waitcnt lgkmcnt(2)
    v_max3_f32 v77, v77, v24, v25
    v_max3_f32 v77, v77, v26, v27
    s_waitcnt lgkmcnt(1)
    v_max3_f32 v77, v77, v28, v29
    v_max3_f32 v77, v77, v30, v31
    s_waitcnt lgkmcnt(0)
    v_max3_f32 v77, v77, v72, v73
    v_max3_f32 v77, v77, v74, v75
    v_sub_f32 v34, v32, v77
    v_sub_f32 v35, v33, v77
    v_sub_f32 v38, v36, v77
    v_sub_f32 v39, v37, v77
    v_exp_f32 v34, v34
    v_exp_f32 v35, v35
    v_exp_f32 v38, v38
    v_exp_f32 v39, v39
    v_cvt_pk_bf16_f32 v34, v34, v35
    v_cvt_pk_bf16_f32 v16, v38, v39
    v_cvt_pk_bf16_f32 v17, v38, v39
    v_cvt_pk_bf16_f32 v18, v38, v39
    ds_write_b32 v100, v34
    s_waitcnt lgkmcnt(0)
    s_barrier
    ds_read_b128 v[40:43], v93 offset:13056
    v_mov_b64 v[0:1], 0
    v_mov_b64 v[2:3], 0
    v_mov_b64 v[4:5], 0
    v_mov_b64 v[6:7], 0
    v_mov_b64 v[56:57], 0
    v_mov_b64 v[58:59], 0
    v_mov_b64 v[60:61], 0
    v_mov_b64 v[62:63], 0
    s_waitcnt lgkmcnt(0)
    v_mfma_f32_16x16x32_bf16 v[44:47], v[40:43], v[88:91], 0
    v_mfma_f32_16x16x32_bf16 v[72:75], v[80:83], v[40:43], 0
    v_mfma_f32_16x16x32_bf16 v[76:79], v[84:87], v[40:43], 0
    v_mfma_f32_16x16x16_bf16 v[44:47], v[18:19], v[88:89], v[44:47]
    v_mfma_f32_16x16x16_bf16 v[72:75], v[48:49], v[16:17], v[72:75]
    v_mfma_f32_16x16x16_bf16 v[76:79], v[52:53], v[16:17], v[76:79]
    s_nop 7
    v_cvt_pk_bf16_f32 v20, v72, v73
    v_cvt_pk_bf16_f32 v21, v74, v75
    s_mov_b64 exec, s[30:31]
    v_cvt_pk_bf16_f32 v20, v76, v77
    v_cvt_pk_bf16_f32 v21, v78, v79
    s_mov_b64 exec, -1
    ds_write_b64 v95, v[20:21] offset:15104
    v_cvt_pk_bf16_f32 v72, v72, v73
    v_cvt_pk_bf16_f32 v73, v74, v75
    v_cvt_pk_bf16_f32 v74, v76, v77
    v_cvt_pk_bf16_f32 v75, v78, v79
    s_nop 1
    v_smfmac_f32_16x16x64_bf16 v[0:3], v[72:75], a[168:175], v92
    v_and_b32 v50, 0x1f0, v95
    v_smfmac_f32_16x16x64_bf16 v[4:7], v[72:75], a[184:191], v92
    s_waitcnt lgkmcnt(0)
    s_barrier
    ds_read_b128 v[20:23], v50 offset:15616
    v_mov_b64 v[60:61], 0
    v_mov_b64 v[62:63], 0
    v_smfmac_f32_16x16x64_bf16 v[56:59], v[72:75], a[216:223], v92
    ds_read_b128 v[24:27], v50 offset:14080
    v_lshrrev_b32 v54, 2, v93
    v_smfmac_f32_16x16x64_bf16 v[60:63], v[72:75], a[232:239], v92
    ds_read_b128 v[28:31], v50 offset:14592
    v_rcp_f32 v34, v44
    v_rcp_f32 v35, v46
    s_nop 0
    s_waitcnt lgkmcnt(2)
    v_smfmac_f32_16x16x64_bf16 v[0:3], v[20:23], v[64:71], v92
    ds_read_b128 v[72:75], v94 offset:4096
    v_max3_f32 v39, v44, v46, v34
    s_waitcnt lgkmcnt(2)
    v_smfmac_f32_16x16x64_bf16 v[0:3], v[24:27], v[8:15], v92
    ds_read_b128 v[76:79], v94 offset:5120
    v_max_f32 v39, v39, v35
    s_waitcnt lgkmcnt(2)
    v_smfmac_f32_16x16x64_bf16 v[0:3], v[28:31], a[176:183], v92
    ds_read_b128 v[40:43], v94 offset:6144
    v_cmp_lt_f32 vcc, s64, v39
    v_smfmac_f32_16x16x64_bf16 v[4:7], v[20:23], a[192:199], v92
    ds_read_b128 v[44:47], v94 offset:7168
    v_smfmac_f32_16x16x64_bf16 v[4:7], v[24:27], a[200:207], v92
    s_waitcnt lgkmcnt(0)
    s_branch C_after_s2
.p2align 6
C_base_s3:
    s_nop 0
    s_nop 0
C_trok_s3:
    buffer_load_dwordx4 v93, s[4:7], s52 offen offset:0 sc1 lds
    buffer_load_dwordx4 v93, s[4:7], s52 offen offset:1024 sc1 lds
    v_mov_b64 v[78:79], v[110:111]
    v_mov_b64 v[80:81], v[112:113]
    v_mov_b64 v[82:83], v[114:115]
    v_mov_b64 v[84:85], v[116:117]
    v_mov_b64 v[86:87], v[118:119]
C_poll2_s3:
    s_barrier
    ds_read_b128 v[0:3], v93 offset:0
    ds_read_b128 v[4:7], v93 offset:1024
    global_store_dword v54, v55, s[26:27] offset:0 sc1
    global_store_dword v54, v55, s[26:27] offset:256 sc1
    global_store_dword v54, v55, s[26:27] offset:512 sc1
C_go1_s3:
    s_waitcnt lgkmcnt(1)
    v_smfmac_f32_16x16x64_bf16 v[32:35], v[0:3], v[56:63], v92
    s_waitcnt lgkmcnt(0)
    v_smfmac_f32_16x16x64_bf16 v[32:35], v[4:7], v[120:127], v92
    s_barrier
    v_smfmac_f32_16x16x64_bf16 v[36:39], v[0:3], v[64:71], v92
    v_smfmac_f32_16x16x64_bf16 v[40:43], v[0:3], v[216:223], v92
    ds_read_b128 v[8:11], v93 offset:2048
    buffer_load_dwordx4 v[104:107], v93, s[4:7], s56 offen offset:0 sc1
    v_smfmac_f32_16x16x64_bf16 v[36:39], v[4:7], v[128:135], v92
    ds_read_b128 v[12:15], v93 offset:3072
    v_smfmac_f32_16x16x64_bf16 v[40:43], v[4:7], v[232:239], v92
    ds_read_b128 v[56:59], v94 offset:14336
    v_smfmac_f32_16x16x64_bf16 v[44:47], v[0:3], v[224:231], v92
    ds_read_b128 v[60:63], v94 offset:15360
    v_smfmac_f32_16x16x64_bf16 v[44:47], v[4:7], v[240:247], v92
    s_barrier
    ds_read_b128 v[16:19], v93 offset:4096
    buffer_load_dwordx4 v[108:111], v93, s[4:7], s56 offen offset:1024 sc1
    s_waitcnt lgkmcnt(4)
    v_smfmac_f32_16x16x64_bf16 v[32:35], v[8:11], v[136:143], v92
    ds_read_b128 v[20:23], v93 offset:5120
    s_waitcnt lgkmcnt(4)
    v_smfmac_f32_16x16x64_bf16 v[32:35], v[12:15], v[152:159], v92
    ds_read_b128 v[64:67], v94 offset:16384
    v_smfmac_f32_16x16x64_bf16 v[36:39], v[8:11], v[144:151], v92
    ds_read_b128 v[68:71], v94 offset:17408
    v_smfmac_f32_16x16x64_bf16 v[36:39], v[12:15], v[160:167], v92
    s_waitcnt vmcnt(5)
    s_barrier
    buffer_load_dwordx4 v[112:115], v93, s[4:7], s56 offen offset:2048 sc1
    s_waitcnt lgkmcnt(3)
    v_smfmac_f32_16x16x64_bf16 v[32:35], v[16:19], v[56:63], v92
    ds_read_b128 v[24:27], v93 offset:6144
    s_waitcnt lgkmcnt(3)
    v_smfmac_f32_16x16x64_bf16 v[32:35], v[20:23], v[168:175], v92
    ds_read_b128 v[28:31], v93 offset:7168
    v_add_u32 v52, s45, v54
C_go2_s3:
    v_smfmac_f32_16x16x64_bf16 v[36:39], v[20:23], v[176:183], v92
    ds_read_b128 v[56:59], v94 offset:22528
    s_waitcnt lgkmcnt(3)
    v_smfmac_f32_16x16x64_bf16 v[36:39], v[16:19], v[64:71], v92
    ds_read_b128 v[60:63], v94 offset:23552
    buffer_load_dwordx4 v[116:119], v93, s[4:7], s56 offen offset:3072 sc1
    s_waitcnt lgkmcnt(3)
    v_smfmac_f32_16x16x64_bf16 v[32:35], v[24:27], v[184:191], v92
    ds_read_b128 v[64:67], v94 offset:24576
    global_store_dword v54, v55, s[26:27] offset:768 sc1
    s_waitcnt lgkmcnt(3)
    v_smfmac_f32_16x16x64_bf16 v[32:35], v[28:31], v[200:207], v92
    ds_read_b128 v[68:71], v94 offset:25600
    v_mov_b64 v[48:49], 0
    v_smfmac_f32_16x16x64_bf16 v[36:39], v[24:27], v[192:199], v92
    global_store_dword v54, v55, s[26:27] offset:1024 sc1
    ds_read_b32 v53, v52 offset:0
    v_mov_b64 v[50:51], 0
    v_smfmac_f32_16x16x64_bf16 v[36:39], v[28:31], v[208:215], v92
    global_store_dword v54, v55, s[26:27] offset:1280 sc1
    s_waitcnt lgkmcnt(3)
    v_mul_f32 v33, s62, v33
    v_mul_f32 v35, s62, v35
    v_smfmac_f32_16x16x64_bf16 v[40:43], v[16:19], v[56:63], v92
    global_store_dword v54, v55, s[26:27] offset:1536 sc1
    v_fma_f32 v32, v32, s62, v33
    v_fma_f32 v34, v34, s62, v35
    v_smfmac_f32_16x16x64_bf16 v[40:43], v[8:11], v[248:255], v92
    ds_read_b128 v[56:59], v94 offset:26624
    v_mul_f32 v37, s62, v37
    v_mul_f32 v39, s62, v39
    v_smfmac_f32_16x16x64_bf16 v[40:43], v[12:15], a[8:15], v92
    ds_read_b128 v[60:63], v94 offset:27648
    v_fma_f32 v36, v36, s62, v37
    v_fma_f32 v38, v38, s62, v39
    v_smfmac_f32_16x16x64_bf16 v[40:43], v[24:27], a[24:31], v92
    global_store_dword v54, v55, s[26:27] offset:1792 sc1
    s_waitcnt lgkmcnt(2)
    buffer_store_dword v53, v52, s[4:7], s55 offen sc1
    v_cvt_pk_bf16_f32 v32, v32, v36
    v_cvt_pk_bf16_f32 v33, v34, v38
    v_smfmac_f32_16x16x64_bf16 v[44:47], v[16:19], v[64:71], v92
    ds_write2_b32 v96, v32, v33 offset0:0 offset1:72
    v_smfmac_f32_16x16x64_bf16 v[40:43], v[28:31], a[40:47], v92
    ds_read_b128 v[64:67], v94 offset:28672
    v_cmp_u_f32 vcc, v36, v38
    v_smfmac_f32_16x16x64_bf16 v[44:47], v[8:11], a[0:7], v92
    ds_read_b128 v[68:71], v94 offset:29696
    s_waitcnt lgkmcnt(3)
    v_mov_b64 v[32:33], 0
    v_smfmac_f32_16x16x64_bf16 v[40:43], v[20:23], v[56:63], v92
    buffer_store_dword v55, v103, s[4:7], s54 offen sc1
    v_smfmac_f32_16x16x64_bf16 v[44:47], v[12:15], a[16:23], v92
    s_cbranch_vccnz C_retry2_s3
C_ok2_s3:
    v_mov_b64 v[34:35], 0
    v_mov_b64 v[54:55], 0
    v_smfmac_f32_16x16x64_bf16 v[44:47], v[24:27], a[32:39], v92
    s_waitcnt lgkmcnt(2)
    s_barrier
    ds_read_b128 v[56:59], v98 offset:0
    v_smfmac_f32_16x16x64_bf16 v[44:47], v[28:31], a[48:55], v92
    ds_read_b128 v[60:63], v98 offset:64
    s_waitcnt lgkmcnt(2)
    v_add_f32 v40, v40, v41
    v_smfmac_f32_16x16x64_bf16 v[44:47], v[20:23], v[64:71], v92
    ds_read_b128 v[64:67], v98 offset:128
    v_add_f32 v42, v42, v43
    v_smfmac_f32_16x16x64_bf16 v[48:51], v[0:3], a[56:63], v92
    ds_read_b128 v[68:71], v98 offset:192
    v_mov_b64 v[52:53], 0
    v_smfmac_f32_16x16x64_bf16 v[48:51], v[4:7], a[72:79], v92
    v_add_f32 v44, v44, v45
    v_add_f32 v46, v46, v47
    v_smfmac_f32_16x16x64_bf16 v[52:55], v[0:3], a[64:71], v92
    s_waitcnt lgkmcnt(2)
    v_cvt_pk_bf16_f32 v40, v40, v44
    v_cvt_pk_bf16_f32 v41, v42, v46
    v_smfmac_f32_16x16x64_bf16 v[32:35], v[72:75], v[56:63], v92
    ds_write2_b32 v97, v40, v41 offset0:0 offset1:80
    s_waitcnt lgkmcnt(1)
    v_smfmac_f32_16x16x64_bf16 v[32:35], v[76:79], v[64:71], v92
    ds_read_b128 v[0:3], v94 offset:18432
    v_mov_b64 v[36:37], 0
    v_smfmac_f32_16x16x64_bf16 v[52:55], v[4:7], a[80:87], v92
    ds_read_b128 v[4:7], v94 offset:19456
    v_mov_b64 v[38:39], 0
    v_smfmac_f32_16x16x64_bf16 v[48:51], v[8:11], a[88:95], v92
    v_add_f32 v32, v32, v33
    v_add_f32 v33, v34, v35
    v_smfmac_f32_16x16x64_bf16 v[48:51], v[12:15], a[104:111], v92
    s_waitcnt lgkmcnt(2)
    s_barrier
    v_exp_f32 v34, v32
    v_smfmac_f32_16x16x64_bf16 v[48:51], v[16:19], a[120:127], v92
    ds_read_b128 v[72:75], v99
    s_waitcnt lgkmcnt(1)
    v_smfmac_f32_16x16x64_bf16 v[48:51], v[28:31], v[0:7], v92
    ds_read_b128 v[76:79], v99 offset:128
    v_exp_f32 v35, v33
    v_smfmac_f32_16x16x64_bf16 v[48:51], v[20:23], a[136:143], v92
    v_cvt_pk_bf16_f32 v34, v34, v35
    v_smfmac_f32_16x16x64_bf16 v[48:51], v[24:27], a[152:159], v92
    ds_write_b32 v100, v34
    s_waitcnt lgkmcnt(2)
    v_smfmac_f32_16x16x64_bf16 v[36:39], v[72:75], v[56:63], v92
    s_waitcnt lgkmcnt(1)
    v_mov_b64 v[0:1], 0
    v_smfmac_f32_16x16x64_bf16 v[36:39], v[76:79], v[64:71], v92
    ds_read_b128 v[56:59], v94 offset:20480
    v_cvt_pk_bf16_f32 v48, v48, v50
    v_smfmac_f32_16x16x64_bf16 v[52:55], v[8:11], a[96:103], v92
    ds_read_b128 v[60:63], v94 offset:21504
    v_cvt_pk_bf16_f32 v49, v49, v51
    v_smfmac_f32_16x16x64_bf16 v[52:55], v[12:15], a[112:119], v92
    s_waitcnt lgkmcnt(2)
    s_barrier
    ds_read_b128 v[40:43], v93 offset:13056
    v_add_f32 v36, v36, v37
    v_smfmac_f32_16x16x64_bf16 v[52:55], v[16:19], a[128:135], v92
    ds_read_b128 v[64:67], v94 offset:0
    ds_read_b128 v[68:71], v94 offset:1024
    v_add_f32 v37, v38, v39
    v_smfmac_f32_16x16x64_bf16 v[52:55], v[20:23], a[144:151], v92
    s_waitcnt lgkmcnt(3)
    v_exp_f32 v38, v36
    v_smfmac_f32_16x16x64_bf16 v[52:55], v[28:31], v[56:63], v92
    ds_read_b128 v[8:11], v94 offset:2048
    v_exp_f32 v39, v37
    v_smfmac_f32_16x16x64_bf16 v[52:55], v[24:27], a[160:167], v92
    ds_read_b128 v[12:15], v94 offset:3072
    s_waitcnt lgkmcnt(4)
    v_mfma_f32_16x16x32_bf16 v[72:75], v[80:83], v[40:43], 0
    v_cvt_pk_bf16_f32 v17, v38, v39
    v_mov_b64 v[2:3], 0
    v_mfma_f32_16x16x32_bf16 v[76:79], v[84:87], v[40:43], 0
    v_cvt_pk_bf16_f32 v16, v38, v39
    v_cvt_pk_bf16_f32 v52, v52, v54
    v_cvt_pk_bf16_f32 v53, v53, v55
    v_mfma_f32_16x16x16_bf16 v[72:75], v[48:49], v[16:17], v[72:75]
    v_cvt_pk_bf16_f32 v18, v38, v39
    v_mov_b32 v19, 0
    v_mfma_f32_16x16x16_bf16 v[76:79], v[52:53], v[16:17], v[76:79]
    v_mov_b64 v[4:5], 0
    v_mov_b64 v[6:7], 0
    v_mfma_f32_16x16x32_bf16 v[44:47], v[40:43], v[88:91], 0
    v_cvt_pk_bf16_f32 v20, v72, v73
    v_cvt_pk_bf16_f32 v21, v74, v75
    s_mov_b64 exec, s[30:31]
    v_cvt_pk_bf16_f32 v20, v76, v77
    v_cvt_pk_bf16_f32 v21, v78, v79
    s_mov_b64 exec, -1
    ds_write_b64 v95, v[20:21] offset:15616
    v_mfma_f32_16x16x16_bf16 v[44:47], v[18:19], v[88:89], v[44:47]
    v_cvt_pk_bf16_f32 v72, v72, v73
    v_cvt_pk_bf16_f32 v73, v74, v75
    v_cvt_pk_bf16_f32 v74, v76, v77
    v_cvt_pk_bf16_f32 v75, v78, v79
    v_mov_b64 v[56:57], 0
    v_mov_b64 v[58:59], 0
    v_smfmac_f32_16x16x64_bf16 v[0:3], v[72:75], a[168:175], v92
    v_and_b32 v50, 0x1f0, v95
    v_smfmac_f32_16x16x64_bf16 v[4:7], v[72:75], a[184:191], v92
    s_waitcnt lgkmcnt(0)
    s_barrier
    ds_read_b128 v[20:23], v50 offset:15104
    v_mov_b64 v[60:61], 0
    v_mov_b64 v[62:63], 0
    v_smfmac_f32_16x16x64_bf16 v[56:59], v[72:75], a[216:223], v92
    ds_read_b128 v[24:27], v50 offset:14592
    v_lshrrev_b32 v54, 2, v93
    v_smfmac_f32_16x16x64_bf16 v[60:63], v[72:75], a[232:239], v92
    ds_read_b128 v[28:31], v50 offset:14080
    v_rcp_f32 v34, v44
    v_rcp_f32 v35, v46
    s_nop 0
    s_waitcnt lgkmcnt(2)
    v_smfmac_f32_16x16x64_bf16 v[0:3], v[20:23], v[64:71], v92
    ds_read_b128 v[72:75], v94 offset:4096
    s_waitcnt lgkmcnt(2)
    v_max3_f32 v39, v44, v46, v34
    v_smfmac_f32_16x16x64_bf16 v[0:3], v[24:27], v[8:15], v92
    ds_read_b128 v[76:79], v94 offset:5120
    s_waitcnt lgkmcnt(2)
    v_max_f32 v39, v39, v35
    v_smfmac_f32_16x16x64_bf16 v[0:3], v[28:31], a[176:183], v92
    ds_read_b128 v[40:43], v94 offset:6144
    v_cmp_lt_f32 vcc, s64, v39
    v_smfmac_f32_16x16x64_bf16 v[4:7], v[20:23], a[192:199], v92
    ds_read_b128 v[44:47], v94 offset:7168
    v_smfmac_f32_16x16x64_bf16 v[4:7], v[24:27], a[200:207], v92
    s_cbranch_vccnz C_slow_s3
C_after_s3:
    v_mul_f32 v0, v0, v34
    v_mul_f32 v1, v1, v34
    v_mul_f32 v2, v2, v35
    v_mul_f32 v3, v3, v35
    v_cvt_pk_bf16_f32 v0, v0, v1
    v_cvt_pk_bf16_f32 v1, v2, v3
    v_smfmac_f32_16x16x64_bf16 v[4:7], v[28:31], a[208:215], v92
    global_store_dword v101, v0, s[16:17] sc1
    global_store_dword v101, v1, s[16:17] offset:2048 sc1
    s_waitcnt lgkmcnt(2)
    v_smfmac_f32_16x16x64_bf16 v[56:59], v[20:23], v[72:79], v92
    ds_read_b128 v[80:83], v94 offset:8192
    v_mov_b64 v[16:17], 0
    v_smfmac_f32_16x16x64_bf16 v[56:59], v[24:27], a[224:231], v92
    ds_read_b128 v[84:87], v94 offset:9216
    s_waitcnt lgkmcnt(2)
    v_mul_f32 v4, v4, v34
    v_mul_f32 v5, v5, v34
    v_mul_f32 v6, v6, v35
    v_mul_f32 v7, v7, v35
    v_cvt_pk_bf16_f32 v4, v4, v5
    v_cvt_pk_bf16_f32 v5, v6, v7
    v_smfmac_f32_16x16x64_bf16 v[56:59], v[28:31], v[40:47], v92
    global_store_dword v101, v4, s[18:19] sc1
    global_store_dword v101, v5, s[18:19] offset:2048 sc1
    v_smfmac_f32_16x16x64_bf16 v[60:63], v[20:23], a[240:247], v92
    v_mov_b64 v[18:19], 0
    v_smfmac_f32_16x16x64_bf16 v[60:63], v[24:27], a[248:255], v92
    s_waitcnt lgkmcnt(0)
    v_mul_f32 v56, v56, v34
    v_mul_f32 v57, v57, v34
    v_mul_f32 v58, v58, v35
    v_mul_f32 v59, v59, v35
    v_cvt_pk_bf16_f32 v56, v56, v57
    v_cvt_pk_bf16_f32 v57, v58, v59
    v_smfmac_f32_16x16x64_bf16 v[60:63], v[28:31], v[80:87], v92
    global_store_dword v101, v56, s[20:21] sc1
    global_store_dword v101, v57, s[20:21] offset:2048 sc1
    v_mov_b64 v[4:5], 0
    v_mov_b64 v[6:7], 0
    v_and_b32 v51, 0x80, v54
    v_lshl_add_u32 v51, v51, 23, v54
    v_mov_b32 v49, -1
    s_nop 0
    v_mul_f32 v60, v60, v34
    v_mul_f32 v61, v61, v34
    v_mul_f32 v62, v62, v35
    v_mul_f32 v63, v63, v35
    v_cvt_pk_bf16_f32 v60, v60, v61
    v_cvt_pk_bf16_f32 v61, v62, v63
    global_store_dword v101, v60, s[22:23] sc1
    global_store_dword v101, v61, s[22:23] offset:2048 sc1
    s_add_u32 s55, s55, 16384
    s_add_u32 s72, s51, s73
    s_add_u32 s52, s51, 6144
    s_mov_b32 s26, s24
    s_waitcnt vmcnt(0)
    v_mov_b32 v55, -1
    v_mov_b64 v[40:41], 0
    v_mov_b64 v[42:43], 0
C_ld1_s3:
    global_load_dword v8, v54, s[24:25] offset:0 sc1
    global_load_dword v9, v54, s[24:25] offset:256 sc1
    global_load_dword v10, v54, s[24:25] offset:512 sc1
    global_load_dword v11, v54, s[24:25] offset:768 sc1
    global_load_dword v12, v54, s[24:25] offset:1024 sc1
    global_load_dword v13, v54, s[24:25] offset:1280 sc1
    global_load_dword v14, v54, s[24:25] offset:1536 sc1
    global_load_dword v15, v54, s[24:25] offset:1792 sc1
C_red_s3:
    s_waitcnt vmcnt(0)
    v_smfmac_f32_16x16x64_bf16 v[16:19], v[88:91], v[8:15], v92 abid:1
    s_mov_b64 exec, s[28:29]
    s_nop 6
    buffer_store_dword v16, v103, s[4:7], s51 offen sc1
    s_mov_b64 exec, 0xffff
    v_cvt_pk_bf16_f32 v28, v16, v17
    buffer_store_dword v28, v103, s[4:7], s51 offen sc1
    v_cmp_u_f32 vcc, v16, v17
    s_mov_b64 exec, -1
    s_cbranch_vccnz C_retry0_s3
C_ok1_s3:
    s_add_u32 s60, s60, 1
    s_cmp_eq_u32 s60, 63
    s_cbranch_scc1 C_done
C_flagok_s3:
    v_mov_b64 v[44:45], 0
    v_mov_b64 v[46:47], 0
    buffer_load_dword v49, v51, s[4:7], s72 offen sc1
    v_mov_b64 v[52:53], 0
    v_mov_b64 v[32:33], 0
    v_mov_b64 v[34:35], 0
    v_mov_b64 v[36:37], 0
    v_mov_b64 v[38:39], 0
    s_xor_b32 s16, s16, 0x80000
    s_xor_b32 s18, s18, 0x80000
    buffer_load_dword v49, v51, s[4:7], s72 offen sc1
    s_xor_b32 s20, s20, 0x80000
    s_xor_b32 s22, s22, 0x80000
    s_add_u32 s56, s56, 0x80000
    ds_read_b128 v[56:59], v94 offset:10240
    s_mov_b32 s67, s51
    s_add_u32 s51, s51, 16384
    ds_read_b128 v[60:63], v94 offset:11264
    buffer_load_dword v49, v51, s[4:7], s72 offen sc1
    s_bitset0_b32 s51, 16
    s_xor_b32 s54, s51, 32768
    ds_read_b128 v[64:67], v94 offset:12288
    s_xor_b32 s24, s24, 0x80000
    ds_read_b128 v[68:71], v94 offset:13312
    buffer_load_dword v49, v51, s[4:7], s72 offen sc1
    v_mov_b64 v[72:73], v[104:105]
    v_mov_b64 v[74:75], v[106:107]
    v_mov_b64 v[76:77], v[108:109]
    buffer_load_dword v49, v51, s[4:7], s72 offen sc1
C_tr_s3:
    s_waitcnt vmcnt(4)
    v_cmp_le_u32 vcc, s63, v49
    buffer_load_dword v49, v51, s[4:7], s72 offen sc1
    s_cbranch_vccz C_trok_s3
    s_waitcnt vmcnt(4)
    v_cmp_le_u32 vcc, s63, v49
    buffer_load_dword v49, v51, s[4:7], s72 offen sc1
    s_cbranch_vccz C_trok_s3
    s_waitcnt vmcnt(4)
    v_cmp_le_u32 vcc, s63, v49
    buffer_load_dword v49, v51, s[4:7], s72 offen sc1
    s_cbranch_vccz C_trok_s3
    s_waitcnt vmcnt(4)
    v_cmp_le_u32 vcc, s63, v49
    buffer_load_dword v49, v51, s[4:7], s72 offen sc1
    s_cbranch_vccz C_trok_s3
    s_waitcnt vmcnt(4)
    v_cmp_le_u32 vcc, s63, v49
    buffer_load_dword v49, v51, s[4:7], s72 offen sc1
    s_cbranch_vccz C_trok_s3
    s_waitcnt vmcnt(4)
    v_cmp_le_u32 vcc, s63, v49
    buffer_load_dword v49, v51, s[4:7], s72 offen sc1
    s_cbranch_vccz C_trok_s3
    s_sub_u32 s69, s69, 1
    s_cbranch_scc0 C_tr_s3
    s_branch C_fail
C_retry2_s3:
    v_max_u32 v37, v0, v1
    v_max3_u32 v37, v37, v2, v3
    v_max3_u32 v37, v37, v4, v5
    v_max3_u32 v37, v37, v6, v7
    v_max3_u32 v37, v37, v8, v9
    v_max3_u32 v37, v37, v10, v11
    v_max3_u32 v37, v37, v12, v13
    v_max3_u32 v37, v37, v14, v15
    v_max3_u32 v37, v37, v16, v17
    v_max3_u32 v37, v37, v18, v19
    v_max3_u32 v37, v37, v20, v21
    v_max3_u32 v37, v37, v22, v23
    v_max3_u32 v37, v37, v24, v25
    v_max3_u32 v37, v37, v26, v27
    v_max3_u32 v37, v37, v28, v29
    v_max3_u32 v37, v37, v30, v31
    v_cmp_le_u32 vcc, s61, v37
    s_cbranch_vccz C_ok2_s3
C_rr_s3:
    s_mov_b32 m0, 0
    s_add_u32 s65, s67, 0
    buffer_load_dwordx4 v93, s[4:7], s65 offen offset:0 sc1 lds
    buffer_load_dwordx4 v93, s[4:7], s65 offen offset:1024 sc1 lds
    buffer_load_dwordx4 v93, s[4:7], s65 offen offset:2048 sc1 lds
    buffer_load_dwordx4 v93, s[4:7], s65 offen offset:3072 sc1 lds
    s_mov_b32 m0, 4096
    s_add_u32 s65, s67, 4096
    buffer_load_dwordx4 v93, s[4:7], s65 offen offset:0 sc1 lds
    buffer_load_dwordx4 v93, s[4:7], s65 offen offset:1024 sc1 lds
    buffer_load_dwordx4 v93, s[4:7], s65 offen offset:2048 sc1 lds
    buffer_load_dwordx4 v93, s[4:7], s65 offen offset:3072 sc1 lds
    s_sub_u32 s69, s69, 1
    s_cbranch_scc1 C_fail
    s_waitcnt vmcnt(0) lgkmcnt(0)
    ds_read_b128 v[0:3], v93 offset:0
    ds_read_b128 v[4:7], v93 offset:1024
    ds_read_b128 v[8:11], v93 offset:2048
    ds_read_b128 v[12:15], v93 offset:3072
    ds_read_b128 v[16:19], v93 offset:4096
    ds_read_b128 v[20:23], v93 offset:5120
    ds_read_b128 v[24:27], v93 offset:6144
    ds_read_b128 v[28:31], v93 offset:7168
    s_waitcnt lgkmcnt(0)
    v_max_u32 v37, v0, v1
    v_max3_u32 v37, v37, v2, v3
    v_max3_u32 v37, v37, v4, v5
    v_max3_u32 v37, v37, v6, v7
    v_max3_u32 v37, v37, v8, v9
    v_max3_u32 v37, v37, v10, v11
    v_max3_u32 v37, v37, v12, v13
    v_max3_u32 v37, v37, v14, v15
    v_max3_u32 v37, v37, v16, v17
    v_max3_u32 v37, v37, v18, v19
    v_max3_u32 v37, v37, v20, v21
    v_max3_u32 v37, v37, v22, v23
    v_max3_u32 v37, v37, v24, v25
    v_max3_u32 v37, v37, v26, v27
    v_max3_u32 v37, v37, v28, v29
    v_max3_u32 v37, v37, v30, v31
    v_cmp_le_u32 vcc, s61, v37
    s_cbranch_vccz C_rg_s3
    s_branch C_rr_s3
C_rg_s3:
    v_mov_b64 v[32:33], 0
    v_mov_b64 v[34:35], 0
    v_mov_b64 v[36:37], 0
    v_mov_b64 v[38:39], 0
    v_mov_b64 v[40:41], 0
    v_mov_b64 v[42:43], 0
    v_mov_b64 v[44:45], 0
    v_mov_b64 v[46:47], 0
    s_mov_b32 m0, 6144
    ds_read_b128 v[56:59], v94 offset:10240
    ds_read_b128 v[60:63], v94 offset:11264
    s_waitcnt lgkmcnt(0)
    v_smfmac_f32_16x16x64_bf16 v[32:35], v[0:3], v[56:63], v92
    ds_read_b128 v[64:67], v94 offset:12288
    ds_read_b128 v[68:71], v94 offset:13312
    s_waitcnt lgkmcnt(0)
    v_smfmac_f32_16x16x64_bf16 v[36:39], v[0:3], v[64:71], v92
    v_smfmac_f32_16x16x64_bf16 v[32:35], v[4:7], v[120:127], v92
    v_smfmac_f32_16x16x64_bf16 v[36:39], v[4:7], v[128:135], v92
    v_smfmac_f32_16x16x64_bf16 v[40:43], v[0:3], v[216:223], v92
    v_smfmac_f32_16x16x64_bf16 v[40:43], v[4:7], v[232:239], v92
    v_smfmac_f32_16x16x64_bf16 v[44:47], v[0:3], v[224:231], v92
    v_smfmac_f32_16x16x64_bf16 v[44:47], v[4:7], v[240:247], v92
    v_smfmac_f32_16x16x64_bf16 v[32:35], v[8:11], v[136:143], v92
    v_smfmac_f32_16x16x64_bf16 v[32:35], v[12:15], v[152:159], v92
    v_smfmac_f32_16x16x64_bf16 v[36:39], v[8:11], v[144:151], v92
    v_smfmac_f32_16x16x64_bf16 v[36:39], v[12:15], v[160:167], v92
    ds_read_b128 v[56:59], v94 offset:14336
    ds_read_b128 v[60:63], v94 offset:15360
    s_waitcnt lgkmcnt(0)
    v_smfmac_f32_16x16x64_bf16 v[32:35], v[16:19], v[56:63], v92
    v_smfmac_f32_16x16x64_bf16 v[32:35], v[20:23], v[168:175], v92
    ds_read_b128 v[64:67], v94 offset:16384
    ds_read_b128 v[68:71], v94 offset:17408
    s_waitcnt lgkmcnt(0)
    s_branch C_go2_s3
C_retry0_s3:
    global_load_dword v20, v54, s[24:25] offset:0 sc1
    global_load_dword v21, v54, s[24:25] offset:256 sc1
    global_load_dword v22, v54, s[24:25] offset:512 sc1
    global_load_dword v23, v54, s[24:25] offset:768 sc1
    global_load_dword v24, v54, s[24:25] offset:1024 sc1
    global_load_dword v25, v54, s[24:25] offset:1280 sc1
    global_load_dword v26, v54, s[24:25] offset:1536 sc1
    global_load_dword v27, v54, s[24:25] offset:1792 sc1
    s_waitcnt vmcnt(0)
C_retry1_s3:
    s_waitcnt vmcnt(1)
C_r1b_s3:
    v_smfmac_f32_16x16x64_bf16 v[4:7], v[88:91], v[20:27], v92 abid:1
    global_load_dword v8, v54, s[24:25] offset:0 sc1
    global_load_dword v9, v54, s[24:25] offset:256 sc1
    global_load_dword v10, v54, s[24:25] offset:512 sc1
    global_load_dword v11, v54, s[24:25] offset:768 sc1
    global_load_dword v12, v54, s[24:25] offset:1024 sc1
    global_load_dword v13, v54, s[24:25] offset:1280 sc1
    global_load_dword v14, v54, s[24:25] offset:1536 sc1
    global_load_dword v15, v54, s[24:25] offset:1792 sc1
    v_mov_b64 v[16:17], 0
    v_mov_b64 v[18:19], 0
    v_cvt_pk_bf16_f32 v28, v4, v5
    buffer_store_dword v28, v103, s[4:7], s51 offen sc1
    v_cmp_u_f32 vcc, v4, v5
    s_cbranch_vccz C_ok1_s3
    v_max3_u32 v6, v20, v21, v22
    v_max3_u32 v7, v23, v24, v25
    v_max3_u32 v6, v6, v26, v27
    v_max_u32 v6, v6, v7
    v_cmp_eq_u32 vcc, -1, v6
    global_load_dword v20, v54, s[24:25] offset:0 sc1
    global_load_dword v21, v54, s[24:25] offset:256 sc1
    global_load_dword v22, v54, s[24:25] offset:512 sc1
    global_load_dword v23, v54, s[24:25] offset:768 sc1
    global_load_dword v24, v54, s[24:25] offset:1024 sc1
    global_load_dword v25, v54, s[24:25] offset:1280 sc1
    global_load_dword v26, v54, s[24:25] offset:1536 sc1
    global_load_dword v27, v54, s[24:25] offset:1792 sc1
    s_cbranch_vccz C_nan1_s3
    v_mov_b64 v[4:5], 0
    v_mov_b64 v[6:7], 0
    s_sub_u32 s69, s69, 1
    s_cbranch_scc1 C_fail
    s_waitcnt vmcnt(9)
    v_smfmac_f32_16x16x64_bf16 v[16:19], v[88:91], v[8:15], v92 abid:1
    s_nop 7
    v_cvt_pk_bf16_f32 v28, v16, v17
    buffer_store_dword v28, v103, s[4:7], s51 offen sc1
    v_cmp_u_f32 vcc, v16, v17
    s_cbranch_vccz C_ok1_s3
    s_branch C_retry1_s3
C_nan1_s3:
    v_cmp_le_u32 vcc, s63, v28
    v_and_b32 v6, 0x7fffffff, v28
    s_nop 0
    v_cndmask_b32 v28, v28, v6, vcc
    buffer_store_dword v28, v103, s[4:7], s51 offen sc1
    s_waitcnt vmcnt(0)
    s_branch C_ok1_s3
C_flag_s3:
    buffer_load_dword v102, off, s[4:7], s58 sc1
    s_sub_u32 s69, s69, 1
    s_cbranch_scc1 C_fail
    s_waitcnt vmcnt(0)
    v_readfirstlane_b32 s70, v102
    s_nop 3
    s_cmp_le_u32 s70, s59
    s_cbranch_scc1 C_flag_s3
    s_branch C_flagok_s3
C_slow_s3:
    s_waitcnt lgkmcnt(0)
    s_nop 7
    v_max3_f32 v77, v32, v33, v36
    v_max_f32 v77, v77, v37
    v_bfe_u32 v76, v93, 4, 4
    v_lshlrev_b32 v76, 6, v76
    v_lshrrev_b32 v78, 8, v93
    v_lshl_add_u32 v78, v78, 2, v76
    ds_write_b32 v78, v77 offset:8240
    s_waitcnt lgkmcnt(0)
    s_barrier
    ds_read_b128 v[20:23], v76 offset:8192
    ds_read_b128 v[24:27], v76 offset:8208
    ds_read_b128 v[28:31], v76 offset:8224
    ds_read_b128 v[72:75], v76 offset:8240
    s_waitcnt lgkmcnt(3)
    v_max3_f32 v77, v77, v20, v21
    v_max3_f32 v77, v77, v22, v23
    s_waitcnt lgkmcnt(2)
    v_max3_f32 v77, v77, v24, v25
    v_max3_f32 v77, v77, v26, v27
    s_waitcnt lgkmcnt(1)
    v_max3_f32 v77, v77, v28, v29
    v_max3_f32 v77, v77, v30, v31
    s_waitcnt lgkmcnt(0)
    v_max3_f32 v77, v77, v72, v73
    v_max3_f32 v77, v77, v74, v75
    v_sub_f32 v34, v32, v77
    v_sub_f32 v35, v33, v77
    v_sub_f32 v38, v36, v77
    v_sub_f32 v39, v37, v77
    v_exp_f32 v34, v34
    v_exp_f32 v35, v35
    v_exp_f32 v38, v38
    v_exp_f32 v39, v39
    v_cvt_pk_bf16_f32 v34, v34, v35
    v_cvt_pk_bf16_f32 v16, v38, v39
    v_cvt_pk_bf16_f32 v17, v38, v39
    v_cvt_pk_bf16_f32 v18, v38, v39
    ds_write_b32 v100, v34
    s_waitcnt lgkmcnt(0)
    s_barrier
    ds_read_b128 v[40:43], v93 offset:13056
    v_mov_b64 v[0:1], 0
    v_mov_b64 v[2:3], 0
    v_mov_b64 v[4:5], 0
    v_mov_b64 v[6:7], 0
    v_mov_b64 v[56:57], 0
    v_mov_b64 v[58:59], 0
    v_mov_b64 v[60:61], 0
    v_mov_b64 v[62:63], 0
    s_waitcnt lgkmcnt(0)
    v_mfma_f32_16x16x32_bf16 v[44:47], v[40:43], v[88:91], 0
    v_mfma_f32_16x16x32_bf16 v[72:75], v[80:83], v[40:43], 0
    v_mfma_f32_16x16x32_bf16 v[76:79], v[84:87], v[40:43], 0
    v_mfma_f32_16x16x16_bf16 v[44:47], v[18:19], v[88:89], v[44:47]
    v_mfma_f32_16x16x16_bf16 v[72:75], v[48:49], v[16:17], v[72:75]
    v_mfma_f32_16x16x16_bf16 v[76:79], v[52:53], v[16:17], v[76:79]
    s_nop 7
    v_cvt_pk_bf16_f32 v20, v72, v73
    v_cvt_pk_bf16_f32 v21, v74, v75
    s_mov_b64 exec, s[30:31]
    v_cvt_pk_bf16_f32 v20, v76, v77
    v_cvt_pk_bf16_f32 v21, v78, v79
    s_mov_b64 exec, -1
    ds_write_b64 v95, v[20:21] offset:15616
    v_cvt_pk_bf16_f32 v72, v72, v73
    v_cvt_pk_bf16_f32 v73, v74, v75
    v_cvt_pk_bf16_f32 v74, v76, v77
    v_cvt_pk_bf16_f32 v75, v78, v79
    s_nop 1
    v_smfmac_f32_16x16x64_bf16 v[0:3], v[72:75], a[168:175], v92
    v_and_b32 v50, 0x1f0, v95
    v_smfmac_f32_16x16x64_bf16 v[4:7], v[72:75], a[184:191], v92
    s_waitcnt lgkmcnt(0)
    s_barrier
    ds_read_b128 v[20:23], v50 offset:15104
    v_mov_b64 v[60:61], 0
    v_mov_b64 v[62:63], 0
    v_smfmac_f32_16x16x64_bf16 v[56:59], v[72:75], a[216:223], v92
    ds_read_b128 v[24:27], v50 offset:14592
    v_lshrrev_b32 v54, 2, v93
    v_smfmac_f32_16x16x64_bf16 v[60:63], v[72:75], a[232:239], v92
    ds_read_b128 v[28:31], v50 offset:14080
    v_rcp_f32 v34, v44
    v_rcp_f32 v35, v46
    s_nop 0
    s_waitcnt lgkmcnt(2)
    v_smfmac_f32_16x16x64_bf16 v[0:3], v[20:23], v[64:71], v92
    ds_read_b128 v[72:75], v94 offset:4096
    v_max3_f32 v39, v44, v46, v34
    s_waitcnt lgkmcnt(2)
    v_smfmac_f32_16x16x64_bf16 v[0:3], v[24:27], v[8:15], v92
    ds_read_b128 v[76:79], v94 offset:5120
    v_max_f32 v39, v39, v35
    s_waitcnt lgkmcnt(2)
    v_smfmac_f32_16x16x64_bf16 v[0:3], v[28:31], a[176:183], v92
    ds_read_b128 v[40:43], v94 offset:6144
    v_cmp_lt_f32 vcc, s64, v39
    v_smfmac_f32_16x16x64_bf16 v[4:7], v[20:23], a[192:199], v92
    ds_read_b128 v[44:47], v94 offset:7168
    v_smfmac_f32_16x16x64_bf16 v[4:7], v[24:27], a[200:207], v92
    s_waitcnt lgkmcnt(0)
    s_branch C_after_s3
L_end:
.section .rodata,"a"
.p2align 6
.amdhsa_kernel parallel_sum__memory_aug_recurrent_mem_tr__glu_gated_swiglu__prompt_kernel
  .amdhsa_next_free_vgpr 512
  .amdhsa_next_free_sgpr 102
  .amdhsa_accum_offset 256
  .amdhsa_group_segment_fixed_size 0
  .amdhsa_kernarg_size 112
  .amdhsa_user_sgpr_count 2
  .amdhsa_user_sgpr_kernarg_segment_ptr 1
  .amdhsa_system_sgpr_workgroup_id_x 1
.end_amdhsa_kernel
```
